```python
import torch

def _softmax(x, axis=-1):
    return torch.softmax(x, dim=axis)
def _gelu(x):
    return torch.nn.functional.gelu(x, approximate="tanh")
def _silu(x):
    return torch.nn.functional.silu(x)
def _sigmoid(x):
    return torch.sigmoid(x)
def _layernorm(x, axis=-1, eps=1e-5):
    m = x.mean(dim=axis, keepdim=True)
    v = x.var(dim=axis, keepdim=True, unbiased=False)
    return (x - m) / torch.sqrt(v + eps)
def _scatter_add(tgt, idx, src, axis=0):
    return tgt.clone().index_add_(axis, idx, src)
def _segment_sum(src, seg, n):
    out = torch.zeros((n,) + src.shape[1:], dtype=src.dtype)
    return out.index_add_(0, seg, src)
def _pad(x, pw):
    flat = tuple(v for pair in reversed(pw) for v in pair)
    return torch.nn.functional.pad(x, flat)

kernel_name = 'interleave_layers__spectral_fnet__swiglu_ffn__prompt'

def setup_inputs():

    _w = (lambda a: (lambda t: t.to(torch.bfloat16) if t.is_floating_point() else t)(torch.as_tensor(a)))
    def _A_setup():
        B, S, D = 1, 2048, 640
        ns = torch.arange(S)[:, None] * torch.arange(S)[None, :]
        nd = torch.arange(D)[:, None] * torch.arange(D)[None, :]
        Ws_re = torch.cos(-2.0 * torch.pi * ns / S).to(float)
        Ws_im = torch.sin(-2.0 * torch.pi * ns / S).to(float)
        Wd_re = torch.cos(-2.0 * torch.pi * nd / D).to(float)
        Wd_im = torch.sin(-2.0 * torch.pi * nd / D).to(float)
        return {
            "x": _w((lambda *s: torch.randn(*s, dtype=torch.bfloat16) * 0.05)(B, S, D)),
            "dft_seq_re": _w(Ws_re),
            "dft_seq_im": _w(Ws_im),
            "dft_hid_re": _w(Wd_re),
            "dft_hid_im": _w(Wd_im),
        }
    _A_in = _A_setup()

    def _B_setup():
        B, S, D, F = 1, 2048, 640, 1728
        return {
            "x": _w((lambda *s: torch.randn(*s, dtype=torch.bfloat16) * 0.05)(B, S, D)),
            "w_gate": _w((lambda *s: torch.randn(*s, dtype=torch.bfloat16) * 0.4)(D, F)),
            "w_up": _w((lambda *s: torch.randn(*s, dtype=torch.bfloat16) * 0.4)(D, F)),
            "w_down": _w((lambda *s: torch.randn(*s, dtype=torch.bfloat16) * 0.4)(F, D)),
        }
    _B_in = _B_setup()

    return {
        "A_x": _A_in["x"],
        "A_dft_seq_re": _A_in["dft_seq_re"],
        "A_dft_seq_im": _A_in["dft_seq_im"],
        "A_dft_hid_re": _A_in["dft_hid_re"],
        "A_dft_hid_im": _A_in["dft_hid_im"],
        "B_x": _B_in["x"],
        "B_w_gate": _B_in["w_gate"],
        "B_w_up": _B_in["w_up"],
        "B_w_down": _B_in["w_down"],
    }

def reference(A_x, A_dft_seq_re, A_dft_seq_im, A_dft_hid_re, A_dft_hid_im, B_x, B_w_gate, B_w_up, B_w_down):
    def _A_ref(x, dft_seq_re, dft_seq_im, dft_hid_re, dft_hid_im):
        a = torch.einsum("bsd,ed->bse", x, dft_hid_re)
        b = torch.einsum("bsd,ed->bse", x, dft_hid_im)
        y = torch.einsum("ts,bse->bte", dft_seq_re, a) - torch.einsum("ts,bse->bte", dft_seq_im, b)
        return y

    def _B_ref(x, w_gate, w_up, w_down):
        g = _silu(x @ w_gate)
        u = x @ w_up
        return (g * u) @ w_down

    x = A_x
    x = x + _A_ref(_layernorm(x, axis=-1), A_dft_seq_re, A_dft_seq_im, A_dft_hid_re, A_dft_hid_im)
    x = x + _B_ref(_layernorm(x, axis=-1), B_w_gate, B_w_up, B_w_down)
    x = x + _A_ref(_layernorm(x, axis=-1), A_dft_seq_re, A_dft_seq_im, A_dft_hid_re, A_dft_hid_im)
    x = x + _B_ref(_layernorm(x, axis=-1), B_w_gate, B_w_up, B_w_down)
    return x
```

```asm
; @launch kernel=interleave_layers__spectral_fnet__swiglu_ffn__prompt_kernel grid=(256,1,1) block=(256,1,1) lds=163840
.amdgcn_target "amdgcn-amd-amdhsa--gfx950"
.text
.p2align 12
.globl interleave_layers__spectral_fnet__swiglu_ffn__prompt_kernel
.p2align 8
.type interleave_layers__spectral_fnet__swiglu_ffn__prompt_kernel,@function
interleave_layers__spectral_fnet__swiglu_ffn__prompt_kernel:
ffn_body:
    s_cmp_ge_u32 s2, 256
    s_cbranch_scc1 ffn_end
    s_load_dwordx2 s[52:53], s[0:1], 88
    s_load_dwordx2 s[54:55], s[0:1], 0
    s_load_dwordx8 s[56:63], s[0:1], 48
    s_load_dwordx2 s[22:23], s[0:1], 80
    s_getpc_b64 s[46:47]
.Lpc0:
    s_and_b32 s46, s46, 0xffffff00
    s_lshr_b32 s3, s2, 3
    s_and_b32 s3, s3, 31
    v_mad_u32_u24 v21, v0, 32, s3
    v_lshlrev_b32 v21, 7, v21
    v_min_u32 v21, ffn_end-ffn_body, v21
    v_cmp_gt_u32 vcc, 64, v0
    s_nop 1
    s_cbranch_vccz p0_nopf
    global_load_dword v21, v21, s[46:47]
p0_nopf:
    v_lshrrev_b32 v1, 6, v0
    v_and_b32 v0, 63, v0
    v_readfirstlane_b32 s16, v1
    s_and_b32 s17, s2, 15
    s_bfe_u32 s19, s2, 0x10004
    s_lshr_b32 s20, s2, 5
    s_add_u32 s18, s2, 243
    s_and_b32 s18, s18, 255
    v_lshlrev_b32 v14, 4, v0
    s_lshl_b32 s32, s19, 4
    s_add_u32 s32, s32, s17
    s_lshr_b32 s3, s16, 1
    s_lshl_b32 s3, s3, 5
    s_add_u32 s32, s32, s3
    s_and_b32 s3, s16, 1
    s_lshl_b32 s3, s3, 10
    s_add_u32 s32, s32, s3
    s_mul_i32 s32, s32, 1280
    v_lshrrev_b32 v16, 3, v0
    v_mul_u32_u24 v16, 81920, v16
    v_and_b32 v17, 7, v0
    v_lshl_add_u32 v16, v17, 4, v16
    v_add_u32 v17, 0xa0000, v16
    s_mul_i32 s35, s20, 160
    s_and_b32 s33, s35, 0xffffff80
    s_add_u32 s35, s35, s32
    s_add_u32 s33, s33, s32
    s_add_u32 s34, s32, 1280
    v_and_b32 v13, 1, v0
    s_lshl_b32 s3, s20, 1
    v_add_u32 v13, s3, v13
    v_mul_u32_u24 v13, 81920, v13
    v_bfe_u32 v15, v0, 1, 1
    v_mul_u32_u24 v15, 640, v15
    v_add_u32 v13, v13, v15
    s_waitcnt lgkmcnt(0)
    s_mov_b32 s8, s54
    s_and_b32 s9, s55, 0xffff
    s_mov_b32 s10, 0x280000
    s_mov_b32 s11, 0x20000
    s_cmp_lg_u32 s2, 0
    s_mov_b32 s4, s52
    s_pack_ll_b32_b16 s5, s53, 0
    s_mov_b32 s6, 0x10000000
    s_mov_b32 s7, 0x20000
    s_cbranch_scc1 p0_noown0
    s_lshl_b32 s3, s16, 12
    s_add_u32 s3, s3, 0x198c000
    v_mov_b32 v8, 0
    v_mov_b32 v9, 0
    v_mov_b32 v10, 0
    v_mov_b32 v11, 0
    buffer_store_dwordx4 v[8:11], v14, s[4:7], s3 offen offset:0 sc1
    buffer_store_dwordx4 v[8:11], v14, s[4:7], s3 offen offset:1024 sc1
    buffer_store_dwordx4 v[8:11], v14, s[4:7], s3 offen offset:2048 sc1
    buffer_store_dwordx4 v[8:11], v14, s[4:7], s3 offen offset:3072 sc1
p0_noown0:
    buffer_load_dwordx4 v[176:179], v16, s[8:11], s33 offen
    buffer_load_dwordx4 v[180:183], v17, s[8:11], s33 offen
    s_add_u32 s33, s33, 128
    s_cmp_eq_u32 s33, s34
    s_cselect_b32 s33, s32, s33
    buffer_load_dword v13, v13, s[8:11], s32 offen offset:512
    s_cmp_lg_u32 s2, 0
    s_cbranch_scc1 p0_noown
    v_mov_b32 v9, 16
    v_lshlrev_b32 v10, 2, v0
    s_waitcnt vmcnt(3)
    s_barrier
    s_cmp_lg_u32 s16, 0
    s_cbranch_scc1 p0_noown
    s_mov_b64 exec, 1
    global_atomic_add v10, v9, s[22:23] sc1
    s_mov_b64 exec, -1
p0_noown:
    s_cmp_lt_u32 s18, 108
    s_cbranch_scc1 p0_wd
    s_sub_u32 s24, s18, 108
    s_lshl_b32 s24, s24, 2
    s_add_u32 s24, s24, s16
    s_lshl_b32 s24, s24, 1
    s_cmp_ge_u32 s24, 1080
    s_cselect_b32 s30, 0x80000000, 0
    s_cmp_ge_u32 s24, 540
    s_cselect_b32 s56, s58, s56
    s_cselect_b32 s57, s59, s57
    s_cselect_b32 s31, 5120, 0
    s_cselect_b32 s3, 540, 0
    s_sub_u32 s24, s24, s3
    s_mov_b32 s12, s56
    s_and_b32 s13, s57, 0xffff
    s_mov_b32 s14, 0x21c000
    s_mov_b32 s15, 0x20000
    v_lshrrev_b32 v1, 3, v0
    v_mul_u32_u24 v4, 3456, v1
    v_and_b32 v2, 7, v0
    v_lshl_add_u32 v4, v2, 4, v4
    v_lshrrev_b32 v3, 2, v1
    v_mul_u32_u24 v3, 55296, v3
    v_add_u32 v4, s30, v4
    v_add_u32 v5, v4, v3
    s_lshl_b32 s29, s16, 13
    s_mul_i32 s25, s24, 2428
    s_lshr_b32 s25, s25, 16
    s_mul_i32 s3, s25, 27
    s_sub_u32 s28, s24, s3
    s_mul_i32 s26, s25, 110592
    s_lshl_b32 s3, s28, 7
    s_add_u32 s26, s26, s3
    s_mul_i32 s3, s25, 205
    s_lshr_b32 s3, s3, 10
    s_mul_i32 s3, s3, 5
    s_add_u32 s40, s3, s25
    s_add_u32 s3, s3, 5
    s_sub_u32 s27, s3, s25
    s_cmp_eq_u32 s27, 5
    s_cselect_b32 s27, 0, s27
    s_cmp_ge_u32 s27, 3
    s_cselect_b32 s3, -13824, 0
    s_add_u32 s3, s26, s3
    s_cmp_eq_u32 s27, 2
    s_cselect_b64 vcc, -1, 0
    s_add_u32 m0, s29, 0
    v_cndmask_b32 v6, v4, v5, vcc
    buffer_load_dwordx4 v6, s[12:15], s3 offen lds
    s_add_u32 s26, s26, 27648
    s_add_u32 s27, s27, 1
    s_cmp_eq_u32 s27, 5
    s_cselect_b32 s27, 0, s27
    s_cmp_ge_u32 s27, 3
    s_cselect_b32 s3, -13824, 0
    s_add_u32 s3, s26, s3
    s_cmp_eq_u32 s27, 2
    s_cselect_b64 vcc, -1, 0
    s_add_u32 m0, s29, 1024
    v_cndmask_b32 v6, v4, v5, vcc
    buffer_load_dwordx4 v6, s[12:15], s3 offen lds
    s_add_u32 s26, s26, 27648
    s_add_u32 s27, s27, 1
    s_cmp_eq_u32 s27, 5
    s_cselect_b32 s27, 0, s27
    s_cmp_ge_u32 s27, 3
    s_cselect_b32 s3, -13824, 0
    s_add_u32 s3, s26, s3
    s_cmp_eq_u32 s27, 2
    s_cselect_b64 vcc, -1, 0
    s_add_u32 m0, s29, 2048
    v_cndmask_b32 v6, v4, v5, vcc
    buffer_load_dwordx4 v6, s[12:15], s3 offen lds
    s_add_u32 s26, s26, 27648
    s_add_u32 s27, s27, 1
    s_cmp_eq_u32 s27, 5
    s_cselect_b32 s27, 0, s27
    s_cmp_ge_u32 s27, 3
    s_cselect_b32 s3, -13824, 0
    s_add_u32 s3, s26, s3
    s_cmp_eq_u32 s27, 2
    s_cselect_b64 vcc, -1, 0
    s_add_u32 m0, s29, 3072
    v_cndmask_b32 v6, v4, v5, vcc
    buffer_load_dwordx4 v6, s[12:15], s3 offen lds
    s_lshl_b32 s40, s40, 10
    s_mul_i32 s3, s28, 163840
    s_add_u32 s40, s40, s3
    s_add_u32 s40, s40, s31
    s_add_u32 s24, s24, 1
    s_mul_i32 s25, s24, 2428
    s_lshr_b32 s25, s25, 16
    s_mul_i32 s3, s25, 27
    s_sub_u32 s28, s24, s3
    s_mul_i32 s26, s25, 110592
    s_lshl_b32 s3, s28, 7
    s_add_u32 s26, s26, s3
    s_mul_i32 s3, s25, 205
    s_lshr_b32 s3, s3, 10
    s_mul_i32 s3, s3, 5
    s_add_u32 s41, s3, s25
    s_add_u32 s3, s3, 5
    s_sub_u32 s27, s3, s25
    s_cmp_eq_u32 s27, 5
    s_cselect_b32 s27, 0, s27
    s_cmp_ge_u32 s27, 3
    s_cselect_b32 s3, -13824, 0
    s_add_u32 s3, s26, s3
    s_cmp_eq_u32 s27, 2
    s_cselect_b64 vcc, -1, 0
    s_add_u32 m0, s29, 4096
    v_cndmask_b32 v6, v4, v5, vcc
    buffer_load_dwordx4 v6, s[12:15], s3 offen lds
    s_add_u32 s26, s26, 27648
    s_add_u32 s27, s27, 1
    s_cmp_eq_u32 s27, 5
    s_cselect_b32 s27, 0, s27
    s_cmp_ge_u32 s27, 3
    s_cselect_b32 s3, -13824, 0
    s_add_u32 s3, s26, s3
    s_cmp_eq_u32 s27, 2
    s_cselect_b64 vcc, -1, 0
    s_add_u32 m0, s29, 5120
    v_cndmask_b32 v6, v4, v5, vcc
    buffer_load_dwordx4 v6, s[12:15], s3 offen lds
    s_add_u32 s26, s26, 27648
    s_add_u32 s27, s27, 1
    s_cmp_eq_u32 s27, 5
    s_cselect_b32 s27, 0, s27
    s_cmp_ge_u32 s27, 3
    s_cselect_b32 s3, -13824, 0
    s_add_u32 s3, s26, s3
    s_cmp_eq_u32 s27, 2
    s_cselect_b64 vcc, -1, 0
    s_add_u32 m0, s29, 6144
    v_cndmask_b32 v6, v4, v5, vcc
    buffer_load_dwordx4 v6, s[12:15], s3 offen lds
    s_add_u32 s26, s26, 27648
    s_add_u32 s27, s27, 1
    s_cmp_eq_u32 s27, 5
    s_cselect_b32 s27, 0, s27
    s_cmp_ge_u32 s27, 3
    s_cselect_b32 s3, -13824, 0
    s_add_u32 s3, s26, s3
    s_cmp_eq_u32 s27, 2
    s_cselect_b64 vcc, -1, 0
    s_add_u32 m0, s29, 7168
    v_cndmask_b32 v6, v4, v5, vcc
    buffer_load_dwordx4 v6, s[12:15], s3 offen lds
    s_lshl_b32 s41, s41, 10
    s_mul_i32 s3, s28, 163840
    s_add_u32 s41, s41, s3
    s_add_u32 s41, s41, s31
    s_branch p0_rows
p0_wd:
    s_and_b32 s25, s18, 1
    s_lshr_b32 s24, s18, 1
    s_lshr_b32 s29, s16, 1
    s_mul_i32 s28, s24, 43
    s_lshr_b32 s28, s28, 9
    s_and_b32 s3, s24, 3
    s_mul_i32 s26, s3, 7
    s_lshr_b32 s3, s24, 2
    s_lshl_b32 s3, s3, 1
    s_add_u32 s26, s26, s3
    s_mul_i32 s3, s28, 21
    s_add_u32 s26, s26, s3
    s_add_u32 s26, s26, s29
    s_lshl_b32 s28, s24, 1
    s_add_u32 s28, s28, s29
    s_sub_u32 s28, s28, 96
    s_mul_i32 s3, s28, 86
    s_lshr_b32 s3, s3, 8
    s_mul_i32 s3, s3, 6
    s_mul_i32 s28, s28, 7
    s_add_u32 s28, s28, s3
    s_add_u32 s28, s28, 6
    s_cmp_ge_u32 s24, 48
    s_cselect_b32 s26, s28, s26
    s_lshl_b32 s26, s26, 1
    s_and_b32 s3, s16, 1
    s_add_u32 s26, s26, s3
    s_mul_i32 s26, s26, 10240
    s_mul_i32 s3, s25, 640
    s_add_u32 s26, s26, s3
    s_mul_i32 s27, s16, 5120
    s_mov_b32 s12, s60
    s_and_b32 s13, s61, 0xffff
    s_mov_b32 s14, 0x21c000
    s_mov_b32 s15, 0x20000
    v_add_u32 v2, 0, v0
    v_mul_u32_u24 v3, 1639, v2
    v_lshrrev_b32 v3, 16, v3
    v_mul_u32_u24 v3, 640, v3
    s_add_u32 m0, s27, 0
    v_lshl_add_u32 v3, v2, 4, v3
    buffer_load_dwordx4 v3, s[12:15], s26 offen lds
    v_add_u32 v2, 64, v0
    v_mul_u32_u24 v3, 1639, v2
    v_lshrrev_b32 v3, 16, v3
    v_mul_u32_u24 v3, 640, v3
    s_add_u32 m0, s27, 1024
    v_lshl_add_u32 v3, v2, 4, v3
    buffer_load_dwordx4 v3, s[12:15], s26 offen lds
    v_add_u32 v2, 128, v0
    v_mul_u32_u24 v3, 1639, v2
    v_lshrrev_b32 v3, 16, v3
    v_mul_u32_u24 v3, 640, v3
    s_add_u32 m0, s27, 2048
    v_lshl_add_u32 v3, v2, 4, v3
    buffer_load_dwordx4 v3, s[12:15], s26 offen lds
    v_add_u32 v2, 192, v0
    v_mul_u32_u24 v3, 1639, v2
    v_lshrrev_b32 v3, 16, v3
    v_mul_u32_u24 v3, 640, v3
    s_add_u32 m0, s27, 3072
    v_lshl_add_u32 v3, v2, 4, v3
    buffer_load_dwordx4 v3, s[12:15], s26 offen lds
    v_add_u32 v2, 256, v0
    v_mul_u32_u24 v3, 1639, v2
    v_lshrrev_b32 v3, 16, v3
    v_mul_u32_u24 v3, 640, v3
    s_add_u32 m0, s27, 4096
    v_lshl_add_u32 v3, v2, 4, v3
    buffer_load_dwordx4 v3, s[12:15], s26 offen lds
    v_mov_b32 v2, 0x80000000
    buffer_load_dword v20, v2, s[12:15], 0 offen
    buffer_load_dword v22, v2, s[12:15], 0 offen
    buffer_load_dword v23, v2, s[12:15], 0 offen
p0_rows:
    s_cmp_eq_u32 s16, 1
    s_cbranch_scc1 hop0_1
    s_cmp_eq_u32 s16, 2
    s_cbranch_scc1 hop0_2
    s_cmp_eq_u32 s16, 3
    s_cbranch_scc1 hop0_3
hop0_3:
hop0_ret:
    v_and_b32 v93, 15, v0
    v_lshrrev_b32 v94, 1, v93
    v_mul_u32_u24 v86, 336, v94
    s_lshl_b32 s3, s16, 3
    v_add_u32 v94, s3, v94
    v_and_b32 v95, 1, v0
    v_lshl_add_u32 v86, v95, 3, v86
    v_cvt_f32_u32 v96, v95
    v_mul_f32 v96, 0x3e800000, v96
    v_cmp_eq_u32 vcc, 0, v94
    v_lshlrev_b32 v95, 5, v95
    v_lshrrev_b32 v97, 5, v0
    v_cndmask_b32 v94, v94, v95, vcc
    v_cndmask_b32_e64 v96, v96, 0, vcc
    v_cvt_f32_u32 v94, v94
    v_mul_f32 v94, 0x3c800000, v94
    v_bfe_u32 v95, v0, 4, 1
    v_lshlrev_b32 v95, 5, v95
    v_lshl_add_u32 v95, v97, 1, v95
    v_cvt_f32_u32 v95, v95
    v_fma_f32 v96, v94, v95, v96
    v_fmamk_f32 v76, v94, 0x00000000, v96
    v_fmamk_f32 v95, v94, 0x41000000, v96
    v_cos_f32 v76, v76
    v_cos_f32 v95, v95
    v_fmamk_f32 v77, v94, 0x41800000, v96
    v_fmamk_f32 v97, v94, 0x41c00000, v96
    v_cvt_pk_bf16_f32 v76, v76, v95
    v_cos_f32 v77, v77
    v_cos_f32 v97, v97
    v_fmamk_f32 v78, v94, 0x40800000, v96
    v_fmamk_f32 v95, v94, 0x41400000, v96
    v_cvt_pk_bf16_f32 v77, v77, v97
    v_cos_f32 v78, v78
    v_cos_f32 v95, v95
    v_fmamk_f32 v79, v94, 0x41a00000, v96
    v_fmamk_f32 v97, v94, 0x41e00000, v96
    v_cvt_pk_bf16_f32 v78, v78, v95
    v_cos_f32 v79, v79
    v_cos_f32 v97, v97
    v_fmamk_f32 v80, v94, 0x3f800000, v96
    v_fmamk_f32 v95, v94, 0x41100000, v96
    v_cvt_pk_bf16_f32 v79, v79, v97
    v_cos_f32 v80, v80
    v_cos_f32 v95, v95
    v_fmamk_f32 v81, v94, 0x41880000, v96
    v_fmamk_f32 v97, v94, 0x41c80000, v96
    v_cvt_pk_bf16_f32 v80, v80, v95
    v_cos_f32 v81, v81
    v_cos_f32 v97, v97
    v_fmamk_f32 v82, v94, 0x40a00000, v96
    v_fmamk_f32 v95, v94, 0x41500000, v96
    v_cvt_pk_bf16_f32 v81, v81, v97
    v_cos_f32 v82, v82
    v_cos_f32 v95, v95
    v_fmamk_f32 v83, v94, 0x41a80000, v96
    v_fmamk_f32 v97, v94, 0x41e80000, v96
    v_cvt_pk_bf16_f32 v82, v82, v95
    v_cos_f32 v83, v83
    v_cos_f32 v97, v97
    s_lshl_b32 s3, s16, 4
    v_cvt_pk_bf16_f32 v83, v83, v97
    v_add_u32 v93, s3, v93
    v_mul_u32_u24 v84, 168, v93
    v_lshrrev_b32 v93, 4, v0
    v_mad_u32_u24 v84, v93, 40, v84
    v_and_b32 v94, 28, v0
    v_lshrrev_b32 v95, 5, v0
    v_add_u32 v94, v94, v95
    v_mul_u32_u24 v94, 168, v94
    v_and_b32 v95, 3, v0
    v_lshl_add_u32 v85, v95, 3, v94
    v_add_u32 v84, 0xf000, v84
    v_add_u32 v85, 0xf000, v85
    s_and_b32 s3, s17, 3
    v_xor_b32 v93, s3, v93
    v_lshl_add_u32 v86, v93, 4, v86
    s_mul_i32 s3, s16, 2688
    s_add_u32 s3, s3, 0x22000
    v_add_u32 v86, s3, v86
    s_mul_i32 s39, s20, 5
    v_add_u32 v93, 0, v0
    v_mul_u32_u24 v94, 205, v93
    v_lshrrev_b32 v94, 12, v94
    v_add_u32 v95, v93, v94
    v_lshl_add_u32 v87, v95, 4, s3
    v_mul_u32_u24 v95, 5, v94
    v_lshrrev_b32 v96, 2, v93
    v_sub_u32 v95, v96, v95
    v_add_u32 v95, s39, v95
    v_mul_u32_u24 v94, 81920, v94
    v_and_b32 v93, 3, v0
    v_lshl_add_u32 v94, v93, 4, v94
    v_bfe_u32 v96, v95, 2, 1
    v_xor_b32 v96, v95, v96
    v_lshl_add_u32 v90, v96, 6, v94
    v_add_u32 v93, 64, v0
    v_mul_u32_u24 v94, 205, v93
    v_lshrrev_b32 v94, 12, v94
    v_add_u32 v95, v93, v94
    v_lshl_add_u32 v88, v95, 4, s3
    v_mul_u32_u24 v95, 5, v94
    v_lshrrev_b32 v96, 2, v93
    v_sub_u32 v95, v96, v95
    v_add_u32 v95, s39, v95
    v_mul_u32_u24 v94, 81920, v94
    v_and_b32 v93, 3, v0
    v_lshl_add_u32 v94, v93, 4, v94
    v_bfe_u32 v96, v95, 2, 1
    v_xor_b32 v96, v95, v96
    v_lshl_add_u32 v91, v96, 6, v94
    v_add_u32 v93, 128, v0
    v_mul_u32_u24 v94, 205, v93
    v_lshrrev_b32 v94, 12, v94
    v_add_u32 v95, v93, v94
    v_lshl_add_u32 v89, v95, 4, s3
    v_mul_u32_u24 v95, 5, v94
    v_lshrrev_b32 v96, 2, v93
    v_sub_u32 v95, v96, v95
    v_add_u32 v95, s39, v95
    v_mul_u32_u24 v94, 81920, v94
    v_and_b32 v93, 3, v0
    v_lshl_add_u32 v94, v93, 4, v94
    v_lshrrev_b32 v93, 5, v0
    v_lshl_add_u32 v94, v93, 31, v94
    v_bfe_u32 v96, v95, 2, 1
    v_xor_b32 v96, v95, v96
    v_lshl_add_u32 v92, v96, 6, v94
    s_lshl_b32 s39, s19, 4
    s_add_u32 s39, s39, s17
    s_mul_i32 s39, s39, 2560
    s_mul_i32 s3, s16, 655360
    s_add_u32 s39, s39, s3
    s_add_u32 s39, s39, 0x800000
    v_mov_b32 v100, -1
    v_mov_b32 v101, -1
    v_mov_b32 v102, -1
    v_mov_b32 v103, -1
    s_mul_i32 s3, s16, 4352
    s_add_u32 s3, s3, 32768
    v_lshrrev_b32 v18, 3, v0
    v_mul_u32_u24 v18, 272, v18
    v_and_b32 v4, 7, v0
    v_lshl_add_u32 v18, v4, 4, v18
    v_add_u32 v18, s3, v18
    v_and_b32 v19, 15, v0
    v_mul_u32_u24 v19, 272, v19
    v_lshrrev_b32 v4, 4, v0
    v_mad_u32_u24 v19, v4, 40, v19
    v_add_u32 v19, s3, v19
    s_mul_i32 s3, s20, 160
    s_and_b32 s3, s3, 127
    v_add_u32 v19, s3, v19
    v_min_u32 v12, 1, v0
    v_lshlrev_b32 v12, 31, v12
    s_lshl_b32 s36, s17, 1
    s_add_u32 s36, s36, s19
    s_lshl_b32 s36, s36, 2
    s_add_u32 s36, s36, s16
    s_lshl_b32 s36, s36, 3
    s_add_u32 s36, s36, s20
    s_lshl_b32 s36, s36, 7
    s_add_u32 s36, s36, 0x2d00000
    v_lshrrev_b32 v4, 5, v0
    v_lshlrev_b32 v5, 2, v0
    v_lshl_add_u32 v4, v4, 31, v5
    v_mov_b32 v5, -1
    v_mov_b32 v6, 0
    s_lshr_b32 s37, s16, 1
    s_lshl_b32 s37, s37, 8
    s_add_u32 s37, s37, s2
    s_and_b32 s3, s16, 1
    s_lshl_b32 s38, s3, 9
    s_add_u32 s38, s38, 384
    s_cmp_ge_u32 s37, s38
    s_cselect_b32 s38, 0x80000000, 0
    v_or_b32 v7, s38, v4
    s_and_b32 s38, s2, 1
    s_mul_i32 s38, s38, 0x13fffc0
    s_lshl_b32 s43, s2, 6
    s_add_u32 s38, s38, s43
    s_add_u32 s38, s38, 0xf7ff80
    s_cmp_eq_u32 s16, 0
    s_cselect_b32 s38, s38, 0x80000000
    v_mov_b32 v4, s36
    v_mov_b32 v11, s38
    v_cmp_gt_u32 vcc, 32, v0
    s_mov_b32 s36, 0
    s_nop 0
    v_cndmask_b32 v4, v11, v4, vcc
    v_lshl_add_u32 v4, v0, 2, v4
    s_lshl_b32 s37, s37, 7
    s_mul_i32 s3, s3, 0x1400000
    s_add_u32 s37, s37, s3
    s_add_u32 s37, s37, 0x1980000
    v_mov_b32 v48, 0x3f803f80
    v_mov_b32 v44, 0
    v_mov_b32 v45, 0
    v_mov_b32 v46, 0
    v_mov_b32 v47, 0
    v_and_b32 v50, 15, v0
    v_bfe_u32 v51, v0, 2, 2
    v_sub_u32 v50, v50, v51
    v_cvt_f32_u32 v50, v50
    v_mul_f32 v50, 0x3acccccd, v50
    s_lshl_b32 s3, s16, 3
    v_cos_f32 v52, v50
    v_cvt_f32_u32 v51, s3
    v_lshrrev_b32 v53, 4, v0
    v_cvt_f32_u32 v53, v53
    v_fmamk_f32 v51, v53, 0x42000000, v51
    v_mul_f32 v51, v50, v51
    v_add_f32 v52, v52, v52
    v_fmamk_f32 v25, v50, 0x00000000, v51
    v_cos_f32 v24, v25
    v_sin_f32 v25, v25
    v_fmamk_f32 v27, v50, 0x43000000, v51
    v_cos_f32 v26, v27
    v_sin_f32 v27, v27
    v_fmamk_f32 v29, v50, 0x43800000, v51
    v_cos_f32 v28, v29
    v_sin_f32 v29, v29
    v_fmamk_f32 v31, v50, 0x43c00000, v51
    v_cos_f32 v30, v31
    v_sin_f32 v31, v31
    v_fmamk_f32 v33, v50, 0x44000000, v51
    v_cos_f32 v32, v33
    v_sin_f32 v33, v33
    v_cvt_pk_bf16_f32 v112, v24, v26
    v_cvt_pk_bf16_f32 v113, v28, v30
    v_cvt_pk_bf16_f32 v114, v32, 0
    v_cvt_pk_bf16_f32 v116, v25, v27
    v_cvt_pk_bf16_f32 v117, v29, v31
    v_cvt_pk_bf16_f32 v118, v33, 0
    v_fmamk_f32 v35, v50, 0x3f800000, v51
    v_cos_f32 v34, v35
    v_sin_f32 v35, v35
    v_fmamk_f32 v37, v50, 0x43010000, v51
    v_cos_f32 v36, v37
    v_sin_f32 v37, v37
    v_fmamk_f32 v39, v50, 0x43808000, v51
    v_cos_f32 v38, v39
    v_sin_f32 v39, v39
    v_fmamk_f32 v41, v50, 0x43c08000, v51
    v_cos_f32 v40, v41
    v_sin_f32 v41, v41
    v_fmamk_f32 v43, v50, 0x44004000, v51
    v_cos_f32 v42, v43
    v_sin_f32 v43, v43
    v_cvt_pk_bf16_f32 v120, v34, v36
    v_cvt_pk_bf16_f32 v121, v38, v40
    v_cvt_pk_bf16_f32 v122, v42, 0
    v_cvt_pk_bf16_f32 v124, v35, v37
    v_cvt_pk_bf16_f32 v125, v39, v41
    v_cvt_pk_bf16_f32 v126, v43, 0
    v_pk_fma_f32 v[24:25], v[52:53], v[34:35], v[24:25] op_sel_hi:[0,1,1] neg_lo:[0,0,1] neg_hi:[0,0,1]
    v_pk_fma_f32 v[26:27], v[52:53], v[36:37], v[26:27] op_sel_hi:[0,1,1] neg_lo:[0,0,1] neg_hi:[0,0,1]
    v_pk_fma_f32 v[28:29], v[52:53], v[38:39], v[28:29] op_sel_hi:[0,1,1] neg_lo:[0,0,1] neg_hi:[0,0,1]
    v_pk_fma_f32 v[30:31], v[52:53], v[40:41], v[30:31] op_sel_hi:[0,1,1] neg_lo:[0,0,1] neg_hi:[0,0,1]
    v_pk_fma_f32 v[32:33], v[52:53], v[42:43], v[32:33] op_sel_hi:[0,1,1] neg_lo:[0,0,1] neg_hi:[0,0,1]
    v_cvt_pk_bf16_f32 v128, v24, v26
    v_cvt_pk_bf16_f32 v129, v28, v30
    v_cvt_pk_bf16_f32 v130, v32, 0
    v_cvt_pk_bf16_f32 v132, v25, v27
    s_branch .Lps620
hop0_1:
.Lpd620:
    s_branch hop0_ret
.Lps620:
    v_cvt_pk_bf16_f32 v133, v29, v31
    v_cvt_pk_bf16_f32 v134, v33, 0
    v_pk_fma_f32 v[34:35], v[52:53], v[24:25], v[34:35] op_sel_hi:[0,1,1] neg_lo:[0,0,1] neg_hi:[0,0,1]
    v_pk_fma_f32 v[36:37], v[52:53], v[26:27], v[36:37] op_sel_hi:[0,1,1] neg_lo:[0,0,1] neg_hi:[0,0,1]
    v_pk_fma_f32 v[38:39], v[52:53], v[28:29], v[38:39] op_sel_hi:[0,1,1] neg_lo:[0,0,1] neg_hi:[0,0,1]
    v_pk_fma_f32 v[40:41], v[52:53], v[30:31], v[40:41] op_sel_hi:[0,1,1] neg_lo:[0,0,1] neg_hi:[0,0,1]
    v_pk_fma_f32 v[42:43], v[52:53], v[32:33], v[42:43] op_sel_hi:[0,1,1] neg_lo:[0,0,1] neg_hi:[0,0,1]
    v_cvt_pk_bf16_f32 v136, v34, v36
    v_cvt_pk_bf16_f32 v137, v38, v40
    v_cvt_pk_bf16_f32 v138, v42, 0
    v_cvt_pk_bf16_f32 v140, v35, v37
    v_cvt_pk_bf16_f32 v141, v39, v41
    v_cvt_pk_bf16_f32 v142, v43, 0
    v_pk_fma_f32 v[24:25], v[52:53], v[34:35], v[24:25] op_sel_hi:[0,1,1] neg_lo:[0,0,1] neg_hi:[0,0,1]
    v_pk_fma_f32 v[26:27], v[52:53], v[36:37], v[26:27] op_sel_hi:[0,1,1] neg_lo:[0,0,1] neg_hi:[0,0,1]
    v_pk_fma_f32 v[28:29], v[52:53], v[38:39], v[28:29] op_sel_hi:[0,1,1] neg_lo:[0,0,1] neg_hi:[0,0,1]
    v_pk_fma_f32 v[30:31], v[52:53], v[40:41], v[30:31] op_sel_hi:[0,1,1] neg_lo:[0,0,1] neg_hi:[0,0,1]
    v_pk_fma_f32 v[32:33], v[52:53], v[42:43], v[32:33] op_sel_hi:[0,1,1] neg_lo:[0,0,1] neg_hi:[0,0,1]
    v_cvt_pk_bf16_f32 v144, v24, v26
    v_cvt_pk_bf16_f32 v145, v28, v30
    v_cvt_pk_bf16_f32 v146, v32, 0
    v_cvt_pk_bf16_f32 v148, v25, v27
    v_cvt_pk_bf16_f32 v149, v29, v31
    v_cvt_pk_bf16_f32 v150, v33, 0
    v_pk_fma_f32 v[34:35], v[52:53], v[24:25], v[34:35] op_sel_hi:[0,1,1] neg_lo:[0,0,1] neg_hi:[0,0,1]
    v_pk_fma_f32 v[36:37], v[52:53], v[26:27], v[36:37] op_sel_hi:[0,1,1] neg_lo:[0,0,1] neg_hi:[0,0,1]
    v_pk_fma_f32 v[38:39], v[52:53], v[28:29], v[38:39] op_sel_hi:[0,1,1] neg_lo:[0,0,1] neg_hi:[0,0,1]
    v_pk_fma_f32 v[40:41], v[52:53], v[30:31], v[40:41] op_sel_hi:[0,1,1] neg_lo:[0,0,1] neg_hi:[0,0,1]
    v_pk_fma_f32 v[42:43], v[52:53], v[32:33], v[42:43] op_sel_hi:[0,1,1] neg_lo:[0,0,1] neg_hi:[0,0,1]
    v_cvt_pk_bf16_f32 v152, v34, v36
    v_cvt_pk_bf16_f32 v153, v38, v40
    v_cvt_pk_bf16_f32 v154, v42, 0
    v_cvt_pk_bf16_f32 v156, v35, v37
    v_cvt_pk_bf16_f32 v157, v39, v41
    v_cvt_pk_bf16_f32 v158, v43, 0
    v_pk_fma_f32 v[24:25], v[52:53], v[34:35], v[24:25] op_sel_hi:[0,1,1] neg_lo:[0,0,1] neg_hi:[0,0,1]
    v_pk_fma_f32 v[26:27], v[52:53], v[36:37], v[26:27] op_sel_hi:[0,1,1] neg_lo:[0,0,1] neg_hi:[0,0,1]
    v_pk_fma_f32 v[28:29], v[52:53], v[38:39], v[28:29] op_sel_hi:[0,1,1] neg_lo:[0,0,1] neg_hi:[0,0,1]
    v_pk_fma_f32 v[30:31], v[52:53], v[40:41], v[30:31] op_sel_hi:[0,1,1] neg_lo:[0,0,1] neg_hi:[0,0,1]
    v_pk_fma_f32 v[32:33], v[52:53], v[42:43], v[32:33] op_sel_hi:[0,1,1] neg_lo:[0,0,1] neg_hi:[0,0,1]
    v_cvt_pk_bf16_f32 v160, v24, v26
    v_cvt_pk_bf16_f32 v161, v28, v30
    v_cvt_pk_bf16_f32 v162, v32, 0
    v_cvt_pk_bf16_f32 v164, v25, v27
    v_cvt_pk_bf16_f32 v165, v29, v31
    v_cvt_pk_bf16_f32 v166, v33, 0
    v_pk_fma_f32 v[34:35], v[52:53], v[24:25], v[34:35] op_sel_hi:[0,1,1] neg_lo:[0,0,1] neg_hi:[0,0,1]
    v_pk_fma_f32 v[36:37], v[52:53], v[26:27], v[36:37] op_sel_hi:[0,1,1] neg_lo:[0,0,1] neg_hi:[0,0,1]
    v_pk_fma_f32 v[38:39], v[52:53], v[28:29], v[38:39] op_sel_hi:[0,1,1] neg_lo:[0,0,1] neg_hi:[0,0,1]
    v_pk_fma_f32 v[40:41], v[52:53], v[30:31], v[40:41] op_sel_hi:[0,1,1] neg_lo:[0,0,1] neg_hi:[0,0,1]
    v_pk_fma_f32 v[42:43], v[52:53], v[32:33], v[42:43] op_sel_hi:[0,1,1] neg_lo:[0,0,1] neg_hi:[0,0,1]
    v_cvt_pk_bf16_f32 v168, v34, v36
    v_cvt_pk_bf16_f32 v169, v38, v40
    v_cvt_pk_bf16_f32 v170, v42, 0
    v_cvt_pk_bf16_f32 v172, v35, v37
    v_cvt_pk_bf16_f32 v173, v39, v41
    v_cvt_pk_bf16_f32 v174, v43, 0
    v_mov_b32 v115, 0
    v_mov_b32 v119, 0
    v_mov_b32 v123, 0
    v_mov_b32 v127, 0
    v_mov_b32 v131, 0
    v_mov_b32 v135, 0
    v_mov_b32 v139, 0
    v_mov_b32 v143, 0
    v_mov_b32 v147, 0
    v_mov_b32 v151, 0
    v_mov_b32 v155, 0
    v_mov_b32 v159, 0
    v_mov_b32 v163, 0
    v_mov_b32 v167, 0
    v_mov_b32 v171, 0
    v_mov_b32 v175, 0
    buffer_load_dwordx4 v[184:187], v16, s[8:11], s33 offen
    buffer_load_dwordx4 v[188:191], v17, s[8:11], s33 offen
    s_add_u32 s33, s33, 128
    s_cmp_eq_u32 s33, s34
    s_cselect_b32 s33, s32, s33
    buffer_load_dwordx4 v[192:195], v16, s[8:11], s33 offen
    buffer_load_dwordx4 v[196:199], v17, s[8:11], s33 offen
    s_add_u32 s33, s33, 128
    s_cmp_eq_u32 s33, s34
    s_cselect_b32 s33, s32, s33
    buffer_load_dwordx4 v[200:203], v16, s[8:11], s33 offen
    buffer_load_dwordx4 v[204:207], v17, s[8:11], s33 offen
    s_add_u32 s33, s33, 128
    s_cmp_eq_u32 s33, s34
    s_cselect_b32 s33, s32, s33
    buffer_load_dwordx4 v[208:211], v16, s[8:11], s33 offen
    buffer_load_dwordx4 v[212:215], v17, s[8:11], s33 offen
    s_add_u32 s33, s33, 128
    s_cmp_eq_u32 s33, s34
    s_cselect_b32 s33, s32, s33
    buffer_load_dwordx4 v[216:219], v16, s[8:11], s33 offen
    s_waitcnt vmcnt(7)
    ds_write_b128 v18, v[176:179] offset:0
    ds_write_b128 v18, v[180:183] offset:2176
    ds_write_b128 v18, v[184:187] offset:128
    buffer_load_dwordx4 v[220:223], v17, s[8:11], s33 offen
    s_add_u32 s33, s33, 128
    s_cmp_eq_u32 s33, s34
    s_cselect_b32 s33, s32, s33
    ds_write_b128 v18, v[188:191] offset:2304
    buffer_load_dwordx4 v[224:227], v16, s[8:11], s33 offen
    ds_read_b64 v[64:65], v19 offset:0
    ds_read_b64 v[66:67], v19 offset:8
    buffer_load_dwordx4 v[228:231], v17, s[8:11], s33 offen
    s_add_u32 s33, s33, 128
    s_cmp_eq_u32 s33, s34
    s_cselect_b32 s33, s32, s33
    ds_read_b64 v[68:69], v19 offset:16
    buffer_load_dwordx4 v[232:235], v16, s[8:11], s33 offen
    ds_read_b64 v[70:71], v19 offset:24
    ds_read_b64 v[72:73], v19 offset:32
    v_dot2c_f32_bf16 v44, v176, v48
    v_dot2c_f32_bf16 v45, v176, v176
    buffer_load_dwordx4 v[236:239], v17, s[8:11], s33 offen
    s_add_u32 s33, s33, 128
    s_cmp_eq_u32 s33, s34
    s_cselect_b32 s33, s32, s33
    v_dot2c_f32_bf16 v46, v180, v48
    buffer_load_dwordx4 v[240:243], v16, s[8:11], s33 offen
    v_dot2c_f32_bf16 v47, v180, v180
    v_dot2c_f32_bf16 v44, v177, v48
    v_dot2c_f32_bf16 v45, v177, v177
    v_dot2c_f32_bf16 v46, v181, v48
    buffer_load_dwordx4 v[244:247], v17, s[8:11], s33 offen
    s_add_u32 s33, s33, 128
    s_cmp_eq_u32 s33, s34
    s_cselect_b32 s33, s32, s33
    v_dot2c_f32_bf16 v47, v181, v181
    buffer_load_dwordx4 v[248:251], v16, s[8:11], s33 offen
    v_dot2c_f32_bf16 v44, v178, v48
    v_dot2c_f32_bf16 v45, v178, v178
    v_dot2c_f32_bf16 v46, v182, v48
    v_dot2c_f32_bf16 v47, v182, v182
    buffer_load_dwordx4 v[252:255], v17, s[8:11], s33 offen
    v_dot2c_f32_bf16 v44, v179, v48
    v_dot2c_f32_bf16 v45, v179, v179
    v_dot2c_f32_bf16 v46, v183, v48
    v_dot2c_f32_bf16 v47, v183, v183
    v_dot2c_f32_bf16 v44, v184, v48
    v_dot2c_f32_bf16 v45, v184, v184
    v_dot2c_f32_bf16 v46, v188, v48
    v_dot2c_f32_bf16 v47, v188, v188
    v_dot2c_f32_bf16 v44, v185, v48
    v_dot2c_f32_bf16 v45, v185, v185
    v_dot2c_f32_bf16 v46, v189, v48
    v_dot2c_f32_bf16 v47, v189, v189
    v_dot2c_f32_bf16 v44, v186, v48
    v_dot2c_f32_bf16 v45, v186, v186
    v_dot2c_f32_bf16 v46, v190, v48
    v_dot2c_f32_bf16 v47, v190, v190
    v_dot2c_f32_bf16 v44, v187, v48
    v_dot2c_f32_bf16 v45, v187, v187
    v_dot2c_f32_bf16 v46, v191, v48
    v_dot2c_f32_bf16 v47, v191, v191
    s_waitcnt vmcnt(15)
    v_dot2c_f32_bf16 v44, v192, v48
    v_dot2c_f32_bf16 v45, v192, v192
    s_waitcnt vmcnt(14)
    v_dot2c_f32_bf16 v46, v196, v48
    v_dot2c_f32_bf16 v47, v196, v196
    v_dot2c_f32_bf16 v44, v193, v48
    v_dot2c_f32_bf16 v45, v193, v193
    v_dot2c_f32_bf16 v46, v197, v48
    v_dot2c_f32_bf16 v47, v197, v197
    v_dot2c_f32_bf16 v44, v194, v48
    v_dot2c_f32_bf16 v45, v194, v194
    v_dot2c_f32_bf16 v46, v198, v48
    v_dot2c_f32_bf16 v47, v198, v198
    v_dot2c_f32_bf16 v44, v195, v48
    v_dot2c_f32_bf16 v45, v195, v195
    v_dot2c_f32_bf16 v46, v199, v48
    v_dot2c_f32_bf16 v47, v199, v199
    s_waitcnt vmcnt(13)
    v_dot2c_f32_bf16 v44, v200, v48
    v_dot2c_f32_bf16 v45, v200, v200
    s_waitcnt vmcnt(12)
    v_dot2c_f32_bf16 v46, v204, v48
    v_dot2c_f32_bf16 v47, v204, v204
    v_dot2c_f32_bf16 v44, v201, v48
    v_dot2c_f32_bf16 v45, v201, v201
    v_dot2c_f32_bf16 v46, v205, v48
    v_dot2c_f32_bf16 v47, v205, v205
    v_dot2c_f32_bf16 v44, v202, v48
    v_dot2c_f32_bf16 v45, v202, v202
    v_dot2c_f32_bf16 v46, v206, v48
    v_dot2c_f32_bf16 v47, v206, v206
    v_dot2c_f32_bf16 v44, v203, v48
    v_dot2c_f32_bf16 v45, v203, v203
    v_dot2c_f32_bf16 v46, v207, v48
    v_dot2c_f32_bf16 v47, v207, v207
    s_waitcnt vmcnt(11)
    v_dot2c_f32_bf16 v44, v208, v48
    v_dot2c_f32_bf16 v45, v208, v208
    s_waitcnt vmcnt(10)
    v_dot2c_f32_bf16 v46, v212, v48
    v_dot2c_f32_bf16 v47, v212, v212
    v_dot2c_f32_bf16 v44, v209, v48
    v_dot2c_f32_bf16 v45, v209, v209
    v_dot2c_f32_bf16 v46, v213, v48
    v_dot2c_f32_bf16 v47, v213, v213
    v_dot2c_f32_bf16 v44, v210, v48
    v_dot2c_f32_bf16 v45, v210, v210
    v_dot2c_f32_bf16 v46, v214, v48
    v_dot2c_f32_bf16 v47, v214, v214
    v_dot2c_f32_bf16 v44, v211, v48
    v_dot2c_f32_bf16 v45, v211, v211
    v_dot2c_f32_bf16 v46, v215, v48
    v_dot2c_f32_bf16 v47, v215, v215
    s_waitcnt vmcnt(9)
    v_dot2c_f32_bf16 v44, v216, v48
    v_dot2c_f32_bf16 v45, v216, v216
    s_waitcnt vmcnt(8)
    v_dot2c_f32_bf16 v46, v220, v48
    v_dot2c_f32_bf16 v47, v220, v220
    v_dot2c_f32_bf16 v44, v217, v48
    v_dot2c_f32_bf16 v45, v217, v217
    v_dot2c_f32_bf16 v46, v221, v48
    v_dot2c_f32_bf16 v47, v221, v221
    v_dot2c_f32_bf16 v44, v218, v48
    v_dot2c_f32_bf16 v45, v218, v218
    v_dot2c_f32_bf16 v46, v222, v48
    v_dot2c_f32_bf16 v47, v222, v222
    v_dot2c_f32_bf16 v44, v219, v48
    v_dot2c_f32_bf16 v45, v219, v219
    v_dot2c_f32_bf16 v46, v223, v48
    v_dot2c_f32_bf16 v47, v223, v223
    s_waitcnt vmcnt(7)
    v_dot2c_f32_bf16 v44, v224, v48
    v_dot2c_f32_bf16 v45, v224, v224
    s_waitcnt vmcnt(6)
    v_dot2c_f32_bf16 v46, v228, v48
    v_dot2c_f32_bf16 v47, v228, v228
    v_dot2c_f32_bf16 v44, v225, v48
    v_dot2c_f32_bf16 v45, v225, v225
    v_dot2c_f32_bf16 v46, v229, v48
    v_dot2c_f32_bf16 v47, v229, v229
    v_dot2c_f32_bf16 v44, v226, v48
    v_dot2c_f32_bf16 v45, v226, v226
    v_dot2c_f32_bf16 v46, v230, v48
    v_dot2c_f32_bf16 v47, v230, v230
    v_dot2c_f32_bf16 v44, v227, v48
    v_dot2c_f32_bf16 v45, v227, v227
    v_dot2c_f32_bf16 v46, v231, v48
    v_dot2c_f32_bf16 v47, v231, v231
    buffer_store_dword v5, v4, s[4:7], s36 offen sc1
    buffer_store_dword v6, v7, s[4:7], s37 offen sc1
    buffer_store_dwordx4 v[100:103], v90, s[4:7], s39 offen sc1
    buffer_store_dwordx4 v[100:103], v91, s[4:7], s39 offen sc1
    buffer_store_dwordx4 v[100:103], v92, s[4:7], s39 offen sc1
    s_barrier
    s_cmp_lt_u32 s18, 108
    s_cbranch_scc0 p0_w1b
    v_lshrrev_b32 v1, 2, v0
    v_mul_u32_u24 v1, 640, v1
    v_and_b32 v2, 3, v0
    v_mul_u32_u24 v2, 40, v2
    s_mul_i32 s3, s16, 160
    v_add3_u32 v1, v1, v2, s3
    ds_read_b64_tr_b16 a[0:1], v1 offset:0
    ds_read_b64_tr_b16 a[2:3], v1 offset:10240
    ds_read_b64_tr_b16 a[4:5], v1 offset:8
    ds_read_b64_tr_b16 a[6:7], v1 offset:10248
    ds_read_b64_tr_b16 a[8:9], v1 offset:16
    ds_read_b64_tr_b16 a[10:11], v1 offset:10256
    ds_read_b64_tr_b16 a[12:13], v1 offset:24
    ds_read_b64_tr_b16 a[14:15], v1 offset:10264
    ds_read_b64_tr_b16 a[16:17], v1 offset:32
    ds_read_b64_tr_b16 a[18:19], v1 offset:10272
    s_lshl_b32 s25, s25, 2
    s_add_u32 s25, s25, s16
    s_mul_i32 s25, s25, 276480
    s_mul_i32 s3, s24, 5120
    s_add_u32 s25, s25, s3
    s_add_u32 s25, s25, 0x440000
    s_add_u32 s26, s25, 4096
    v_mov_b32 v2, 0x80000000
    s_waitcnt lgkmcnt(8)
    buffer_store_dwordx4 a[0:3], v14, s[4:7], s25 offen offset:0 sc1
    s_waitcnt lgkmcnt(6)
    buffer_store_dwordx4 a[4:7], v14, s[4:7], s25 offen offset:1024 sc1
    s_waitcnt lgkmcnt(4)
    buffer_store_dwordx4 a[8:11], v14, s[4:7], s25 offen offset:2048 sc1
    s_waitcnt lgkmcnt(2)
    buffer_store_dwordx4 a[12:15], v14, s[4:7], s25 offen offset:3072 sc1
    s_waitcnt lgkmcnt(0)
    buffer_store_dwordx4 a[16:19], v14, s[4:7], s26 offen offset:0 sc1
    buffer_store_dword v2, v2, s[4:7], 0 offen
    buffer_store_dword v2, v2, s[4:7], 0 offen
    buffer_store_dword v2, v2, s[4:7], 0 offen
    s_branch p0_stat
p0_w1b:
    v_lshrrev_b32 v1, 4, v0
    v_lshlrev_b32 v1, 10, v1
    v_bfe_u32 v2, v0, 2, 2
    v_lshl_add_u32 v1, v2, 7, v1
    v_and_b32 v2, 3, v0
    v_lshl_add_u32 v1, v2, 3, v1
    v_add_u32 v1, s29, v1
    ds_read_b64_tr_b16 a[0:1], v1 offset:0
    ds_read_b64_tr_b16 a[2:3], v1 offset:512
    ds_read_b64_tr_b16 a[4:5], v1 offset:32
    ds_read_b64_tr_b16 a[6:7], v1 offset:544
    ds_read_b64_tr_b16 a[8:9], v1 offset:64
    ds_read_b64_tr_b16 a[10:11], v1 offset:576
    ds_read_b64_tr_b16 a[12:13], v1 offset:96
    ds_read_b64_tr_b16 a[14:15], v1 offset:608
    ds_read_b64_tr_b16 a[16:17], v1 offset:4096
    ds_read_b64_tr_b16 a[18:19], v1 offset:4608
    ds_read_b64_tr_b16 a[20:21], v1 offset:4128
    ds_read_b64_tr_b16 a[22:23], v1 offset:4640
    ds_read_b64_tr_b16 a[24:25], v1 offset:4160
    ds_read_b64_tr_b16 a[26:27], v1 offset:4672
    ds_read_b64_tr_b16 a[28:29], v1 offset:4192
    ds_read_b64_tr_b16 a[30:31], v1 offset:4704
    v_add_u32 v2, s30, v14
    s_waitcnt lgkmcnt(14)
    buffer_store_dwordx4 a[0:3], v2, s[4:7], s40 offen sc1
    s_add_u32 s40, s40, 40960
    s_waitcnt lgkmcnt(12)
    buffer_store_dwordx4 a[4:7], v2, s[4:7], s40 offen sc1
    s_add_u32 s40, s40, 40960
    s_waitcnt lgkmcnt(10)
    buffer_store_dwordx4 a[8:11], v2, s[4:7], s40 offen sc1
    s_add_u32 s40, s40, 40960
    s_waitcnt lgkmcnt(8)
    buffer_store_dwordx4 a[12:15], v2, s[4:7], s40 offen sc1
    s_waitcnt lgkmcnt(6)
    buffer_store_dwordx4 a[16:19], v2, s[4:7], s41 offen sc1
    s_add_u32 s41, s41, 40960
    s_waitcnt lgkmcnt(4)
    buffer_store_dwordx4 a[20:23], v2, s[4:7], s41 offen sc1
    s_add_u32 s41, s41, 40960
    s_waitcnt lgkmcnt(2)
    buffer_store_dwordx4 a[24:27], v2, s[4:7], s41 offen sc1
    s_add_u32 s41, s41, 40960
    s_waitcnt lgkmcnt(0)
    buffer_store_dwordx4 a[28:31], v2, s[4:7], s41 offen sc1
p0_stat:
    v_mov_b32 v104, 0
    s_waitcnt vmcnt(18)
    v_dot2c_f32_bf16 v44, v232, v48
    v_dot2c_f32_bf16 v45, v232, v232
    s_waitcnt vmcnt(17)
    v_dot2c_f32_bf16 v46, v236, v48
    v_dot2c_f32_bf16 v47, v236, v236
    v_dot2c_f32_bf16 v44, v233, v48
    v_dot2c_f32_bf16 v45, v233, v233
    v_dot2c_f32_bf16 v46, v237, v48
    v_dot2c_f32_bf16 v47, v237, v237
    v_dot2c_f32_bf16 v44, v234, v48
    v_dot2c_f32_bf16 v45, v234, v234
    v_dot2c_f32_bf16 v46, v238, v48
    v_dot2c_f32_bf16 v47, v238, v238
    v_dot2c_f32_bf16 v44, v235, v48
    v_dot2c_f32_bf16 v45, v235, v235
    v_dot2c_f32_bf16 v46, v239, v48
    v_dot2c_f32_bf16 v47, v239, v239
    s_waitcnt vmcnt(16)
    v_dot2c_f32_bf16 v44, v240, v48
    v_dot2c_f32_bf16 v45, v240, v240
    s_waitcnt vmcnt(15)
    v_dot2c_f32_bf16 v46, v244, v48
    v_dot2c_f32_bf16 v47, v244, v244
    v_dot2c_f32_bf16 v44, v241, v48
    v_dot2c_f32_bf16 v45, v241, v241
    v_dot2c_f32_bf16 v46, v245, v48
    v_dot2c_f32_bf16 v47, v245, v245
    v_dot2c_f32_bf16 v44, v242, v48
    v_dot2c_f32_bf16 v45, v242, v242
    v_dot2c_f32_bf16 v46, v246, v48
    v_dot2c_f32_bf16 v47, v246, v246
    v_dot2c_f32_bf16 v44, v243, v48
    v_dot2c_f32_bf16 v45, v243, v243
    v_dot2c_f32_bf16 v46, v247, v48
    v_dot2c_f32_bf16 v47, v247, v247
    s_waitcnt vmcnt(14)
    v_dot2c_f32_bf16 v44, v248, v48
    v_dot2c_f32_bf16 v45, v248, v248
    s_waitcnt vmcnt(13)
    v_dot2c_f32_bf16 v46, v252, v48
    v_dot2c_f32_bf16 v47, v252, v252
    v_dot2c_f32_bf16 v44, v249, v48
    v_dot2c_f32_bf16 v45, v249, v249
    v_dot2c_f32_bf16 v46, v253, v48
    v_dot2c_f32_bf16 v47, v253, v253
    v_dot2c_f32_bf16 v44, v250, v48
    v_dot2c_f32_bf16 v45, v250, v250
    v_dot2c_f32_bf16 v46, v254, v48
    v_dot2c_f32_bf16 v47, v254, v254
    v_dot2c_f32_bf16 v44, v251, v48
    v_dot2c_f32_bf16 v45, v251, v251
    v_dot2c_f32_bf16 v46, v255, v48
    v_dot2c_f32_bf16 v47, v255, v255
    v_and_b32 v3, 1, v0
    v_cmp_eq_u32 vcc, 1, v3
    v_and_b32 v3, 7, v0
    v_add_f32_dpp v44, v44, v44 quad_perm:[1,0,3,2] row_mask:0xf bank_mask:0xf
    v_add_f32_dpp v45, v45, v45 quad_perm:[1,0,3,2] row_mask:0xf bank_mask:0xf
    v_add_f32_dpp v46, v46, v46 quad_perm:[1,0,3,2] row_mask:0xf bank_mask:0xf
    v_add_f32_dpp v47, v47, v47 quad_perm:[1,0,3,2] row_mask:0xf bank_mask:0xf
    v_add_f32_dpp v44, v44, v44 quad_perm:[2,3,0,1] row_mask:0xf bank_mask:0xf
    v_add_f32_dpp v45, v45, v45 quad_perm:[2,3,0,1] row_mask:0xf bank_mask:0xf
    v_add_f32_dpp v46, v46, v46 quad_perm:[2,3,0,1] row_mask:0xf bank_mask:0xf
    v_add_f32_dpp v47, v47, v47 quad_perm:[2,3,0,1] row_mask:0xf bank_mask:0xf
    v_add_f32_dpp v44, v44, v44 row_half_mirror row_mask:0xf bank_mask:0xf
    v_add_f32_dpp v45, v45, v45 row_half_mirror row_mask:0xf bank_mask:0xf
    v_add_f32_dpp v46, v46, v46 row_half_mirror row_mask:0xf bank_mask:0xf
    v_add_f32_dpp v47, v47, v47 row_half_mirror row_mask:0xf bank_mask:0xf
    v_bfe_u32 v48, v0, 3, 1
    v_lshl_add_u32 v3, v3, 3, v48
    v_lshlrev_b32 v3, 2, v3
    v_cndmask_b32 v44, v44, v46, vcc
    v_cndmask_b32 v45, v45, v47, vcc
    ds_bpermute_b32 v46, v3, v44
    ds_bpermute_b32 v47, v3, v45
    v_lshlrev_b32 v24, 16, v64
    v_and_b32 v25, 0xffff0000, v64
    v_lshlrev_b32 v26, 16, v65
    v_and_b32 v27, 0xffff0000, v65
    v_lshlrev_b32 v28, 16, v66
    v_and_b32 v29, 0xffff0000, v66
    v_lshlrev_b32 v30, 16, v67
    v_and_b32 v31, 0xffff0000, v67
    v_lshlrev_b32 v32, 16, v68
    v_and_b32 v33, 0xffff0000, v68
    v_lshlrev_b32 v34, 16, v69
    v_and_b32 v35, 0xffff0000, v69
    v_lshlrev_b32 v36, 16, v70
    v_and_b32 v37, 0xffff0000, v70
    v_lshlrev_b32 v38, 16, v71
    v_and_b32 v39, 0xffff0000, v71
    v_lshlrev_b32 v40, 16, v72
    v_and_b32 v41, 0xffff0000, v72
    v_lshlrev_b32 v42, 16, v73
    v_and_b32 v43, 0xffff0000, v73
    s_lshl_b32 s38, s17, 7
    s_add_u32 s38, s38, 0x198c000
    s_min_u32 s3, s16, 1
    s_lshl_b32 s3, s3, 31
    v_or_b32 v245, s3, v12
    v_mov_b32 v242, 1
    s_and_b32 s37, s2, 63
    s_lshl_b32 s37, s37, 7
    s_add_u32 s37, s37, 0x198e000
    s_mov_b32 s36, 0x198e000
    v_lshlrev_b32 v241, 7, v0
    v_mov_b32 v240, 1
    s_waitcnt lgkmcnt(1)
    v_mul_f32 v96, 0xbacccccd, v46
    s_waitcnt lgkmcnt(0)
    v_mul_f32 v94, 0x3acccccd, v47
    v_fma_f32 v94, -v96, v96, v94
    v_max_f32 v94, 0, v94
    v_add_f32 v94, 0x3727c5ac, v94
    v_rsq_f32 v94, v94
    s_nop 0
    v_mul_f32 v96, v96, v94
    v_pk_fma_f32 v[24:25], v[24:25], v[94:95], v[96:97] op_sel_hi:[1,0,0]
    v_pk_fma_f32 v[26:27], v[26:27], v[94:95], v[96:97] op_sel_hi:[1,0,0]
    v_pk_fma_f32 v[28:29], v[28:29], v[94:95], v[96:97] op_sel_hi:[1,0,0]
    v_pk_fma_f32 v[30:31], v[30:31], v[94:95], v[96:97] op_sel_hi:[1,0,0]
    v_pk_fma_f32 v[32:33], v[32:33], v[94:95], v[96:97] op_sel_hi:[1,0,0]
    v_pk_fma_f32 v[34:35], v[34:35], v[94:95], v[96:97] op_sel_hi:[1,0,0]
    v_pk_fma_f32 v[36:37], v[36:37], v[94:95], v[96:97] op_sel_hi:[1,0,0]
    v_pk_fma_f32 v[38:39], v[38:39], v[94:95], v[96:97] op_sel_hi:[1,0,0]
    v_pk_fma_f32 v[40:41], v[40:41], v[94:95], v[96:97] op_sel_hi:[1,0,0]
    v_pk_fma_f32 v[42:43], v[42:43], v[94:95], v[96:97] op_sel_hi:[1,0,0]
    v_cvt_pk_bf16_f32 v176, v24, v25
    v_cvt_pk_bf16_f32 v177, v26, v27
    v_cvt_pk_bf16_f32 v178, v28, v29
    v_cvt_pk_bf16_f32 v179, v30, v31
    v_cvt_pk_bf16_f32 v180, v32, v33
    v_cvt_pk_bf16_f32 v181, v34, v35
    v_cvt_pk_bf16_f32 v182, v36, v37
    v_cvt_pk_bf16_f32 v183, v38, v39
    v_cvt_pk_bf16_f32 v184, v40, v41
    v_cvt_pk_bf16_f32 v185, v42, v43
    ds_write_b64 v84, v[176:177] offset:0
    ds_write_b64 v84, v[178:179] offset:8
    ds_write_b64 v84, v[180:181] offset:16
    ds_write_b64 v84, v[182:183] offset:24
    ds_write_b64 v84, v[184:185] offset:32
    s_waitcnt lgkmcnt(0)
    s_barrier
    global_load_dword v105, v104, s[22:23] sc1
    ds_read_b64_tr_b16 v[176:177], v85 offset:0
    ds_read_b64_tr_b16 v[178:179], v85 offset:336
    ds_read_b64_tr_b16 v[180:181], v85 offset:5376
    ds_read_b64_tr_b16 v[182:183], v85 offset:5712
    ds_read_b64_tr_b16 v[184:185], v85 offset:32
    ds_read_b64_tr_b16 v[186:187], v85 offset:368
    ds_read_b64_tr_b16 v[188:189], v85 offset:5408
    ds_read_b64_tr_b16 v[190:191], v85 offset:5744
    ds_read_b64_tr_b16 v[192:193], v85 offset:64
    ds_read_b64_tr_b16 v[194:195], v85 offset:400
    ds_read_b64_tr_b16 v[196:197], v85 offset:5440
    ds_read_b64_tr_b16 v[198:199], v85 offset:5776
    s_waitcnt lgkmcnt(10)
    v_mfma_f32_16x16x32_bf16 v[216:219], v[176:179], v[76:79], 0
    ds_read_b64_tr_b16 v[200:201], v85 offset:96
    ds_read_b64_tr_b16 v[202:203], v85 offset:432
    s_waitcnt lgkmcnt(10)
    v_mfma_f32_16x16x32_bf16 v[216:219], v[180:183], v[80:83], v[216:219]
    ds_read_b64_tr_b16 v[204:205], v85 offset:5472
    ds_read_b64_tr_b16 v[206:207], v85 offset:5808
    s_waitcnt lgkmcnt(10)
    v_mfma_f32_16x16x32_bf16 v[220:223], v[184:187], v[76:79], 0
    ds_read_b64_tr_b16 v[208:209], v85 offset:128
    ds_read_b64_tr_b16 v[210:211], v85 offset:464
    s_waitcnt lgkmcnt(10)
    v_mfma_f32_16x16x32_bf16 v[220:223], v[188:191], v[80:83], v[220:223]
    ds_read_b64_tr_b16 v[212:213], v85 offset:5504
    ds_read_b64_tr_b16 v[214:215], v85 offset:5840
    s_waitcnt lgkmcnt(10)
    v_mfma_f32_16x16x32_bf16 v[224:227], v[192:195], v[76:79], 0
    s_waitcnt lgkmcnt(8)
    v_mfma_f32_16x16x32_bf16 v[224:227], v[196:199], v[80:83], v[224:227]
    s_waitcnt lgkmcnt(6)
    v_mfma_f32_16x16x32_bf16 v[228:231], v[200:203], v[76:79], 0
    s_waitcnt lgkmcnt(4)
    v_mfma_f32_16x16x32_bf16 v[228:231], v[204:207], v[80:83], v[228:231]
    s_waitcnt lgkmcnt(2)
    v_mfma_f32_16x16x32_bf16 v[232:235], v[208:211], v[76:79], 0
    v_cvt_pk_bf16_f32 v24, v216, v217
    v_cvt_pk_bf16_f32 v25, v218, v219
    s_waitcnt lgkmcnt(0)
    v_mfma_f32_16x16x32_bf16 v[232:235], v[212:215], v[80:83], v[232:235]
    v_cvt_pk_bf16_f32 v26, v220, v221
    v_cvt_pk_bf16_f32 v27, v222, v223
    s_waitcnt vmcnt(0)
    v_readfirstlane_b32 s43, v105
    s_waitcnt lgkmcnt(0)
    s_nop 0
    s_cmp_lt_u32 s43, 16
    s_cbranch_scc1 rdy_slow
rdy_ok:
    s_barrier
    buffer_atomic_add v242, v245, s[4:7], s38 offen sc0 sc1
    v_cvt_pk_bf16_f32 v28, v224, v225
    v_cvt_pk_bf16_f32 v29, v226, v227
    v_cvt_pk_bf16_f32 v30, v228, v229
    v_cvt_pk_bf16_f32 v31, v230, v231
    v_cvt_pk_bf16_f32 v32, v232, v233
    v_cvt_pk_bf16_f32 v33, v234, v235
    ds_write_b64 v86, v[24:25] offset:0
    ds_write_b64 v86, v[26:27] offset:64
    ds_write_b64 v86, v[28:29] offset:128
    ds_write_b64 v86, v[30:31] offset:192
    ds_write_b64 v86, v[32:33] offset:256
    ds_read_b128 v[176:179], v87 offset:0
    ds_read_b128 v[180:183], v88 offset:0
    ds_read_b128 v[184:187], v89 offset:0
    s_waitcnt lgkmcnt(2)
    buffer_store_dwordx4 v[176:179], v90, s[4:7], s39 offen sc1
    s_waitcnt lgkmcnt(1)
    buffer_store_dwordx4 v[180:183], v91, s[4:7], s39 offen sc1
    s_waitcnt lgkmcnt(0)
    buffer_store_dwordx4 v[184:187], v92, s[4:7], s39 offen sc1
    s_bfe_u32 s17, s2, 0x20001
    s_lshl_b32 s17, s17, 1
    s_bfe_u32 s3, s2, 0x10004
    s_add_u32 s17, s17, s3
    s_add_u32 s17, s17, 1
    s_sub_u32 s3, 16, s17
    s_cmp_eq_u32 s3, 8
    s_cselect_b32 s3, 0, s3
    s_bitcmp1_b32 s2, 3
    s_cselect_b32 s17, s3, s17
    s_and_b32 s19, s2, 1
    s_lshr_b32 s20, s2, 5
    s_lshl_b32 s18, s19, 3
    s_or_b32 s18, s18, s20
    s_lshr_b32 s24, s18, 2
    s_sub_u32 s3, 3, s24
    s_cmp_gt_u32 s17, 8
    s_cselect_b32 s24, s3, s24
    s_and_b32 s3, s24, 1
    s_lshl_b32 s25, s17, 1
    s_add_u32 s25, s25, s3
    s_lshl_b32 s25, s25, 1
    s_lshr_b32 s3, s24, 1
    s_add_u32 s25, s25, s3
    s_lshl_b32 s24, s24, 4
    s_add_u32 s24, s24, s17
    s_sub_u32 s3, 64, s24
    s_min_u32 s3, s3, s24
    s_and_b32 s3, s3, 31
    s_mul_i32 s3, s3, 81920
    s_add_u32 s3, s3, 0x800000
    v_add_u32 v252, s3, v14
    s_mul_i32 s27, s16, 10240
    s_and_b32 s26, s18, 3
    s_lshl_b32 s28, s25, 2
    s_add_u32 s28, s28, s26
    s_mul_i32 s3, s28, 10240
    s_add_u32 s3, s3, 0xa5b000
    v_add_u32 v253, s3, v14
    s_mul_i32 s29, s16, 2560
    s_cmp_lt_u32 s24, 32
    s_cselect_b32 s30, 0xbe800000, 0
    s_cmp_gt_u32 s24, 32
    s_cselect_b32 s30, 0x3e800000, s30
    s_cmp_eq_u32 s24, 0
    s_cselect_b32 s31, 0xffff, -1
    s_cmp_eq_u32 s24, 32
    s_cselect_b32 s31, 0xffff0000, s31
    v_and_b32 v196, 31, v0
    s_lshr_b32 s3, s16, 1
    v_add_u32 v196, s3, v196
    v_cvt_f32_u32 v196, v196
    v_mul_f32 v196, 0x3d000000, v196
    s_and_b32 s3, s16, 1
    s_lshl_b32 s3, s3, 4
    v_cos_f32 v198, v196
    v_lshrrev_b32 v197, 5, v0
    v_lshl_add_u32 v197, v197, 3, s3
    v_cvt_f32_u32 v197, v197
    s_waitcnt vmcnt(3)
    v_readfirstlane_b32 s48, v242
    s_nop 1
    s_cmp_lg_u32 s48, 15
    s_cbranch_scc1 a2a_notlast0
    buffer_atomic_add v240, v241, s[4:7], s36 offen sc1
a2a_notlast0:
    v_mul_f32 v177, v196, v197
    v_add_f32 v179, v177, v196
    v_add_f32 v198, v198, v198
    v_cos_f32 v176, v177
    v_sin_f32 v177, v177
    v_cos_f32 v178, v179
    v_sin_f32 v179, v179
    s_lshl_b32 s3, s16, 11
    v_add_u32 v251, 0x1f000, v14
    v_add_u32 v197, s3, v251
    v_pk_fma_f32 v[180:181], v[198:199], v[178:179], v[176:177] op_sel_hi:[0,1,1] neg_lo:[0,0,1] neg_hi:[0,0,1]
    v_pk_fma_f32 v[182:183], v[198:199], v[180:181], v[178:179] op_sel_hi:[0,1,1] neg_lo:[0,0,1] neg_hi:[0,0,1]
    v_pk_fma_f32 v[184:185], v[198:199], v[182:183], v[180:181] op_sel_hi:[0,1,1] neg_lo:[0,0,1] neg_hi:[0,0,1]
    v_pk_fma_f32 v[186:187], v[198:199], v[184:185], v[182:183] op_sel_hi:[0,1,1] neg_lo:[0,0,1] neg_hi:[0,0,1]
    v_pk_fma_f32 v[188:189], v[198:199], v[186:187], v[184:185] op_sel_hi:[0,1,1] neg_lo:[0,0,1] neg_hi:[0,0,1]
    v_pk_fma_f32 v[190:191], v[198:199], v[188:189], v[186:187] op_sel_hi:[0,1,1] neg_lo:[0,0,1] neg_hi:[0,0,1]
    v_cvt_pk_bf16_f32 v24, v176, v178
    v_cvt_pk_bf16_f32 v25, v180, v182
    v_cvt_pk_bf16_f32 v26, v184, v186
    v_cvt_pk_bf16_f32 v27, v188, v190
    ds_write_b128 v197, v[24:27] offset:0
    v_cvt_pk_bf16_f32 v28, v177, v179
    v_cvt_pk_bf16_f32 v29, v181, v183
    v_cvt_pk_bf16_f32 v30, v185, v187
    v_cvt_pk_bf16_f32 v31, v189, v191
    ds_write_b128 v197, v[28:31] offset:1024
    s_lshr_b32 s3, s18, 2
    s_sub_u32 s3, s18, s3
    s_mul_i32 s48, s18, 6
    s_add_u32 s3, s3, s48
    s_mul_i32 s3, s3, 40960
    v_add_u32 v11, s3, v14
    s_mul_i32 s3, s20, 276480
    s_mul_i32 s48, s16, 61440
    s_add_u32 s3, s3, s48
    s_add_u32 s3, s3, 0x440000
    v_add_u32 v15, s3, v14
    s_mul_i32 s44, s16, 11264
    s_lshl_b32 s3, s26, 2
    s_add_u32 s3, s3, s16
    s_lshl_b32 s3, s3, 7
    s_add_u32 s3, s3, s24
    s_mul_i32 s3, s3, 1280
    v_lshrrev_b32 v253, 5, v0
    v_mul_u32_u24 v253, 81920, v253
    v_and_b32 v254, 31, v0
    v_mad_u32_u24 v253, v254, 40, v253
    buffer_load_dwordx4 v[216:219], v253, s[8:11], s3 offen
    buffer_load_dwordx4 v[220:223], v253, s[8:11], s3 offen offset:16
    buffer_load_dwordx2 v[224:225], v253, s[8:11], s3 offen offset:32
    s_lshl_b32 s3, s26, 9
    s_add_u32 s3, s3, s24
    v_bfe_u32 v196, v0, 1, 3
    v_lshl_add_u32 v196, v196, 6, s3
    v_cvt_f32_u32 v196, v196
    v_mul_f32 v196, 0x3a000000, v196
    v_lshrrev_b32 v197, 4, v0
    v_cvt_f32_u32 v201, v197
    v_add_f32 v197, v201, v201
    v_and_b32 v198, 1, v0
    v_cvt_f32_u32 v198, v198
    v_mov_b32 v242, 0
    buffer_atomic_add v242, v245, s[4:7], s37 offen sc0 sc1
    v_mul_f32 v198, 0x3e800000, v198
    v_fma_f32 v197, v196, v197, v198
    v_fmamk_f32 v16, v196, 0x00000000, v197
    v_add_f32 v176, s30, v16
    v_cos_f32 v16, v16
    v_cos_f32 v176, v176
    v_fmamk_f32 v17, v196, 0x3f800000, v197
    v_add_f32 v177, s30, v17
    v_cos_f32 v17, v17
    v_cos_f32 v177, v177
    v_fmamk_f32 v18, v196, 0x41000000, v197
    v_add_f32 v178, s30, v18
    v_cos_f32 v18, v18
    v_cos_f32 v178, v178
    v_fmamk_f32 v19, v196, 0x41100000, v197
    s_branch .Lps1325
hop0_2:
.Lpd1325:
    s_branch hop0_ret
.Lps1325:
    v_add_f32 v179, s30, v19
    v_cos_f32 v19, v19
    v_cos_f32 v179, v179
    v_fmamk_f32 v20, v196, 0x41800000, v197
    v_add_f32 v180, s30, v20
    v_cos_f32 v20, v20
    v_cos_f32 v180, v180
    v_fmamk_f32 v21, v196, 0x41880000, v197
    v_add_f32 v181, s30, v21
    v_cos_f32 v21, v21
    v_cos_f32 v181, v181
    v_fmamk_f32 v22, v196, 0x41c00000, v197
    v_add_f32 v182, s30, v22
    v_cos_f32 v22, v22
    v_cos_f32 v182, v182
    v_fmamk_f32 v23, v196, 0x41c80000, v197
    v_add_f32 v183, s30, v23
    v_cos_f32 v23, v23
    v_cos_f32 v183, v183
    v_cvt_pk_bf16_f32 v16, v16, v176
    v_and_b32 v16, s31, v16
    v_cvt_pk_bf16_f32 v17, v17, v177
    v_and_b32 v17, s31, v17
    v_cvt_pk_bf16_f32 v18, v18, v178
    v_and_b32 v18, s31, v18
    v_cvt_pk_bf16_f32 v19, v19, v179
    v_and_b32 v19, s31, v19
    v_cvt_pk_bf16_f32 v20, v20, v180
    v_and_b32 v20, s31, v20
    v_cvt_pk_bf16_f32 v21, v21, v181
    v_and_b32 v21, s31, v21
    v_cvt_pk_bf16_f32 v22, v22, v182
    v_and_b32 v22, s31, v22
    v_cvt_pk_bf16_f32 v23, v23, v183
    v_and_b32 v23, s31, v23
    v_lshrrev_b32 v196, 3, v0
    v_mul_u32_u24 v197, 2560, v196
    v_bfe_u32 v198, v0, 2, 1
    v_lshl_add_u32 v197, v198, 3, v197
    v_and_b32 v198, 3, v0
    v_lshl_add_u32 v197, v198, 7, v197
    v_and_b32 v196, 3, v196
    v_and_b32 v198, 2, v0
    v_lshl_or_b32 v196, v198, 1, v196
    s_lshl_b32 s3, s16, 1
    v_xor_b32 v196, s3, v196
    v_mov_b32 v243, 0
    buffer_atomic_add v243, v245, s[4:7], s37 offen sc0 sc1
    v_lshl_add_u32 v1, v196, 4, v197
    v_xor_b32 v2, 16, v1
    s_lshl_b32 s3, s16, 1
    v_and_b32 v198, 31, v0
    v_lshrrev_b32 v200, 5, v0
    v_add_u32 v199, s3, v200
    v_lshrrev_b32 v196, 1, v198
    v_mul_u32_u24 v196, 640, v196
    v_and_b32 v197, 1, v198
    v_and_b32 v9, 7, v198
    v_xor_b32 v9, v9, v199
    v_lshl_add_u32 v9, v9, 4, v196
    v_and_b32 v10, 6, v198
    v_xor_b32 v10, v10, v199
    v_lshl_add_u32 v10, v10, 4, v196
    v_lshl_add_u32 v10, v197, 3, v10
    v_add_u32 v10, 256, v10
    v_mul_u32_u24 v197, 384, v197
    v_add_u32 v9, v9, v197
    v_add_u32 v9, 0x25000, v9
    v_add_u32 v10, 0x25000, v10
    v_bfe_u32 v197, v0, 3, 2
    v_cmp_eq_u32 vcc, 3, v197
    v_bfe_u32 v196, v0, 2, 1
    v_add_u32 v196, s3, v196
    v_and_b32 v198, 3, v0
    v_cndmask_b32_e64 v197, v197, 0, vcc
    v_lshl_add_u32 v197, v197, 2, v198
    v_mad_u32_u24 v198, v196, 12, v197
    v_lshlrev_b32 v198, 7, v198
    v_lshrrev_b32 v197, 1, v197
    v_and_b32 v196, 3, v196
    v_xor_b32 v196, v196, v197
    v_xor_b32 v196, v196, v200
    v_lshl_add_u32 v196, v196, 4, v198
    v_add_u32 v5, 0x1f000, v196
    v_xor_b32 v6, 32, v5
    v_xor_b32 v7, 64, v5
    v_xor_b32 v8, 96, v5
    v_bfe_u32 v196, v0, 1, 3
    v_lshrrev_b32 v197, 4, v0
    v_mul_u32_u24 v197, 3, v197
    v_mad_u32_u24 v198, v196, 12, v197
    v_lshlrev_b32 v198, 7, v198
    v_add_u32 v198, 0x1f000, v198
    v_and_b32 v196, 3, v196
    v_and_b32 v199, 1, v0
    v_lshl_or_b32 v199, v199, 2, s16
    v_xor_b32 v196, v196, v199
    v_lshrrev_b32 v199, 1, v197
    v_xor_b32 v199, v199, v196
    v_lshl_add_u32 v3, v199, 4, v198
    v_add_u32 v197, 1, v197
    v_lshrrev_b32 v199, 1, v197
    v_xor_b32 v199, v199, v196
    v_lshl_add_u32 v4, v199, 4, v198
    v_add_u32 v197, 1, v197
    v_lshrrev_b32 v199, 1, v197
    v_xor_b32 v199, v199, v196
    v_lshl_add_u32 v255, v199, 4, v198
    s_mul_i32 s35, s16, 5120
    v_mov_b32 v244, 0
    buffer_atomic_add v244, v245, s[4:7], s37 offen sc0 sc1
    s_waitcnt lgkmcnt(0)
    s_cmp_eq_u32 s16, 1
    s_cbranch_scc1 hop1_1
    s_cmp_eq_u32 s16, 2
    s_cbranch_scc1 hop1_2
    s_cmp_eq_u32 s16, 3
    s_cbranch_scc1 hop1_3
    s_waitcnt vmcnt(2)
    v_readfirstlane_b32 s48, v242
    s_nop 1
    s_bitcmp1_b32 s48, 4
    s_cbranch_scc0 a2a0_slow
a2a0_ok:
hop1_ret:
    s_barrier
    s_add_u32 m0, s27, 0
    v_add_u32 v13, m0, v252
    buffer_load_dwordx4 v13, s[4:7], 0 offen offset:0 sc1 lds
    buffer_load_dwordx4 v13, s[4:7], 0 offen offset:1024 sc1 lds
    buffer_load_dwordx4 v13, s[4:7], 0 offen offset:2048 sc1 lds
    buffer_load_dwordx4 v13, s[4:7], 0 offen offset:3072 sc1 lds
    s_add_u32 m0, s27, 4096
    v_add_u32 v13, m0, v252
    buffer_load_dwordx4 v13, s[4:7], 0 offen offset:0 sc1 lds
    buffer_load_dwordx4 v13, s[4:7], 0 offen offset:1024 sc1 lds
    buffer_load_dwordx4 v13, s[4:7], 0 offen offset:2048 sc1 lds
    buffer_load_dwordx4 v13, s[4:7], 0 offen offset:3072 sc1 lds
    s_add_u32 m0, s27, 8192
    v_add_u32 v13, m0, v252
    buffer_load_dwordx4 v13, s[4:7], 0 offen offset:0 sc1 lds
    buffer_load_dwordx4 v13, s[4:7], 0 offen offset:1024 sc1 lds
    s_add_u32 m0, s27, 40960
    v_add_u32 v13, m0, v252
    buffer_load_dwordx4 v13, s[4:7], 0 offen offset:0 sc1 lds
    ds_read_b128 v[24:27], v251 offset:0
    ds_read_b128 v[32:35], v251 offset:1024
    ds_read_b128 v[28:31], v251 offset:2048
    ds_read_b128 v[36:39], v251 offset:3072
    ds_read_b128 v[48:51], v251 offset:4096
    ds_read_b128 v[56:59], v251 offset:5120
    ds_read_b128 v[52:55], v251 offset:6144
    ds_read_b128 v[60:63], v251 offset:7168
    s_mul_i32 s3, s16, 20
    v_lshrrev_b32 v196, 3, v0
    v_add_u32 v196, s3, v196
    v_mul_u32_u24 v197, 205, v196
    v_lshrrev_b32 v197, 9, v197
    v_xor_b32 v197, v197, v0
    v_and_b32 v197, 7, v197
    v_lshlrev_b32 v198, 9, v196
    buffer_load_dwordx4 v13, s[4:7], 0 offen offset:1024 sc1 lds
    v_lshl_add_u32 v248, v197, 4, v198
    v_add_u32 v196, 8, v196
    v_mul_u32_u24 v197, 205, v196
    v_lshrrev_b32 v197, 9, v197
    v_xor_b32 v197, v197, v0
    v_and_b32 v197, 7, v197
    v_lshlrev_b32 v198, 9, v196
    v_lshl_add_u32 v249, v197, 4, v198
    v_add_u32 v196, 8, v196
    v_mul_u32_u24 v197, 205, v196
    v_lshrrev_b32 v197, 9, v197
    v_xor_b32 v197, v197, v0
    v_and_b32 v197, 7, v197
    v_lshlrev_b32 v198, 9, v196
    v_lshl_add_u32 v250, v197, 4, v198
    buffer_load_dwordx4 v13, s[4:7], 0 offen offset:2048 sc1 lds
    v_lshrrev_b32 v196, 5, v0
    v_lshl_add_u32 v250, v196, 31, v250
    s_mul_i32 s32, s25, 40960
    s_lshl_b32 s3, s26, 7
    s_add_u32 s32, s32, s3
    s_add_u32 s32, s32, 0xd00000
    s_add_u32 s3, s29, 0x25000
    v_add_u32 v251, s3, v14
    v_and_b32 v197, 31, v0
    v_min_u32 v197, 1, v197
    v_lshlrev_b32 v197, 31, v197
    v_lshl_add_u32 v254, v196, 3, v197
    s_lshl_b32 s33, s28, 2
    s_add_u32 s33, s33, s16
    s_lshl_b32 s33, s33, 4
    buffer_load_dwordx4 v13, s[4:7], 0 offen offset:3072 sc1 lds
    s_add_u32 s33, s33, 0xf80000
    s_lshl_b32 s45, s25, 9
    s_add_u32 s45, s45, 0x1980000
    s_waitcnt lgkmcnt(6)
    v_xor_b32 v40, 0x80008000, v32
    v_xor_b32 v41, 0x80008000, v33
    v_xor_b32 v42, 0x80008000, v34
    v_xor_b32 v43, 0x80008000, v35
    s_waitcnt lgkmcnt(4)
    v_xor_b32 v44, 0x80008000, v36
    v_xor_b32 v45, 0x80008000, v37
    v_xor_b32 v46, 0x80008000, v38
    v_xor_b32 v47, 0x80008000, v39
    s_waitcnt lgkmcnt(3)
    v_xor_b32 v64, 0x80008000, v48
    v_xor_b32 v65, 0x80008000, v49
    v_xor_b32 v66, 0x80008000, v50
    v_xor_b32 v67, 0x80008000, v51
    s_add_u32 m0, s27, 45056
    v_add_u32 v13, m0, v252
    buffer_load_dwordx4 v13, s[4:7], 0 offen offset:0 sc1 lds
    s_waitcnt lgkmcnt(1)
    v_xor_b32 v68, 0x80008000, v52
    v_xor_b32 v69, 0x80008000, v53
    v_xor_b32 v70, 0x80008000, v54
    v_xor_b32 v71, 0x80008000, v55
    s_waitcnt vmcnt(20)
    v_lshlrev_b32 v176, 16, v216
    v_and_b32 v177, 0xffff0000, v216
    v_lshlrev_b32 v178, 16, v217
    v_and_b32 v179, 0xffff0000, v217
    v_lshlrev_b32 v180, 16, v218
    v_and_b32 v181, 0xffff0000, v218
    v_lshlrev_b32 v182, 16, v219
    v_and_b32 v183, 0xffff0000, v219
    s_waitcnt vmcnt(19)
    v_lshlrev_b32 v184, 16, v220
    buffer_load_dwordx4 v13, s[4:7], 0 offen offset:1024 sc1 lds
    v_and_b32 v185, 0xffff0000, v220
    v_lshlrev_b32 v202, 16, v221
    v_and_b32 v201, 0xffff0000, v221
    v_lshlrev_b32 v200, 16, v222
    v_and_b32 v199, 0xffff0000, v222
    v_lshlrev_b32 v198, 16, v223
    v_and_b32 v197, 0xffff0000, v223
    s_waitcnt vmcnt(19)
    v_lshlrev_b32 v196, 16, v224
    v_and_b32 v195, 0xffff0000, v224
    v_lshlrev_b32 v194, 16, v225
    v_and_b32 v193, 0xffff0000, v225
    buffer_load_dwordx4 v13, s[4:7], 0 offen offset:2048 sc1 lds
    buffer_load_dwordx4 v13, s[4:7], 0 offen offset:3072 sc1 lds
    s_add_u32 m0, s27, 49152
    v_add_u32 v13, m0, v252
    buffer_load_dwordx4 v13, s[4:7], 0 offen offset:0 sc1 lds
    buffer_load_dwordx4 v13, s[4:7], 0 offen offset:1024 sc1 lds
    s_waitcnt vmcnt(10) lgkmcnt(0)
    s_barrier
    s_add_u32 m0, s44, 81920
    v_add_u32 v13, m0, v11
    buffer_load_dwordx4 v13, s[4:7], 0 offen offset:0 sc1 lds
    ds_read_b64_tr_b16 v[72:73], v1 offset:0
    buffer_load_dwordx4 v13, s[4:7], 0 offen offset:1024 sc1 lds
    ds_read_b64_tr_b16 v[74:75], v1 offset:20480
    ds_read_b64_tr_b16 v[76:77], v1 offset:512
    ds_read_b64_tr_b16 v[78:79], v1 offset:20992
    ds_read_b64_tr_b16 v[80:81], v1 offset:1024
    ds_read_b64_tr_b16 v[82:83], v1 offset:21504
    ds_read_b64_tr_b16 v[84:85], v1 offset:1536
    ds_read_b64_tr_b16 v[86:87], v1 offset:22016
    ds_read_b64_tr_b16 v[88:89], v1 offset:2048
    buffer_load_dwordx4 v13, s[4:7], 0 offen offset:2048 sc1 lds
    ds_read_b64_tr_b16 v[90:91], v1 offset:22528
    ds_read_b64_tr_b16 v[92:93], v2 offset:0
    ds_read_b64_tr_b16 v[94:95], v2 offset:20480
    s_waitcnt lgkmcnt(10)
    v_mfma_f32_16x16x32_bf16 v[208:211], v[72:75], v[16:19], 0
    ds_read_b64_tr_b16 v[96:97], v2 offset:512
    ds_read_b64_tr_b16 v[98:99], v2 offset:20992
    buffer_load_dwordx4 v13, s[4:7], 0 offen offset:3072 sc1 lds
    s_waitcnt lgkmcnt(10)
    v_mfma_f32_16x16x32_bf16 v[212:215], v[76:79], v[16:19], 0
    ds_read_b64_tr_b16 v[100:101], v2 offset:1024
    ds_read_b64_tr_b16 v[102:103], v2 offset:21504
    s_waitcnt lgkmcnt(10)
    v_mfma_f32_16x16x32_bf16 v[216:219], v[80:83], v[16:19], 0
    s_add_u32 m0, s44, 86016
    v_add_u32 v13, m0, v11
    buffer_load_dwordx4 v13, s[4:7], 0 offen offset:0 sc1 lds
    ds_read_b64_tr_b16 v[104:105], v2 offset:1536
    ds_read_b64_tr_b16 v[106:107], v2 offset:22016
    s_waitcnt lgkmcnt(10)
    v_mfma_f32_16x16x32_bf16 v[220:223], v[84:87], v[16:19], 0
    buffer_load_dwordx4 v13, s[4:7], 0 offen offset:1024 sc1 lds
    ds_read_b64_tr_b16 v[108:109], v2 offset:2048
    ds_read_b64_tr_b16 v[110:111], v2 offset:22528
    s_waitcnt lgkmcnt(10)
    v_mfma_f32_16x16x32_bf16 v[224:227], v[88:91], v[16:19], 0
    s_waitcnt lgkmcnt(8)
    v_mfma_f32_16x16x32_bf16 v[228:231], v[92:95], v[16:19], 0
    buffer_load_dwordx4 v13, s[4:7], 0 offen offset:2048 sc1 lds
    s_waitcnt lgkmcnt(6)
    v_mfma_f32_16x16x32_bf16 v[232:235], v[96:99], v[16:19], 0
    s_waitcnt lgkmcnt(4)
    v_mfma_f32_16x16x32_bf16 v[236:239], v[100:103], v[16:19], 0
    buffer_load_dwordx4 v13, s[4:7], 0 offen offset:3072 sc1 lds
    s_waitcnt lgkmcnt(2)
    v_mfma_f32_16x16x32_bf16 v[240:243], v[104:107], v[16:19], 0
    s_waitcnt lgkmcnt(0)
    v_mfma_f32_16x16x32_bf16 v[244:247], v[108:111], v[16:19], 0
    s_waitcnt vmcnt(8) lgkmcnt(0)
    s_barrier
    ds_read_b64_tr_b16 v[72:73], v1 offset:40960
    ds_read_b64_tr_b16 v[74:75], v1 offset:61440
    ds_read_b64_tr_b16 v[76:77], v1 offset:41472
    ds_read_b64_tr_b16 v[78:79], v1 offset:61952
    ds_read_b64_tr_b16 v[80:81], v1 offset:41984
    ds_read_b64_tr_b16 v[82:83], v1 offset:62464
    ds_read_b64_tr_b16 v[84:85], v1 offset:42496
    ds_read_b64_tr_b16 v[86:87], v1 offset:62976
    ds_read_b64_tr_b16 v[88:89], v1 offset:43008
    ds_read_b64_tr_b16 v[90:91], v1 offset:63488
    ds_read_b64_tr_b16 v[92:93], v2 offset:40960
    ds_read_b64_tr_b16 v[94:95], v2 offset:61440
    s_waitcnt lgkmcnt(10)
    v_mfma_f32_16x16x32_bf16 v[208:211], v[72:75], v[20:23], v[208:211]
    s_add_u32 m0, s44, 90112
    v_add_u32 v13, m0, v11
    buffer_load_dwordx4 v13, s[4:7], 0 offen offset:0 sc1 lds
    ds_read_b64_tr_b16 v[96:97], v2 offset:41472
    ds_read_b64_tr_b16 v[98:99], v2 offset:61952
    s_waitcnt lgkmcnt(10)
    v_mfma_f32_16x16x32_bf16 v[212:215], v[76:79], v[20:23], v[212:215]
    ds_read_b64_tr_b16 v[100:101], v2 offset:41984
    buffer_load_dwordx4 v13, s[4:7], 0 offen offset:1024 sc1 lds
    ds_read_b64_tr_b16 v[102:103], v2 offset:62464
    s_waitcnt lgkmcnt(10)
    v_mfma_f32_16x16x32_bf16 v[216:219], v[80:83], v[20:23], v[216:219]
    ds_read_b64_tr_b16 v[104:105], v2 offset:42496
    ds_read_b64_tr_b16 v[106:107], v2 offset:62976
    s_waitcnt lgkmcnt(10)
    v_mfma_f32_16x16x32_bf16 v[220:223], v[84:87], v[20:23], v[220:223]
    ds_read_b64_tr_b16 v[108:109], v2 offset:43008
    buffer_load_dwordx4 v13, s[4:7], 0 offen offset:2048 sc1 lds
    ds_read_b64_tr_b16 v[110:111], v2 offset:63488
    s_waitcnt lgkmcnt(10)
    v_mfma_f32_16x16x32_bf16 v[224:227], v[88:91], v[20:23], v[224:227]
    s_waitcnt lgkmcnt(8)
    v_mfma_f32_16x16x32_bf16 v[228:231], v[92:95], v[20:23], v[228:231]
    s_waitcnt lgkmcnt(6)
    v_mfma_f32_16x16x32_bf16 v[232:235], v[96:99], v[20:23], v[232:235]
    buffer_load_dwordx4 a[0:3], v15, s[4:7], 0 offen offset:0 sc1
    s_waitcnt lgkmcnt(4)
    v_mfma_f32_16x16x32_bf16 v[236:239], v[100:103], v[20:23], v[236:239]
    s_waitcnt lgkmcnt(2)
    v_mfma_f32_16x16x32_bf16 v[240:243], v[104:107], v[20:23], v[240:243]
    s_waitcnt lgkmcnt(0)
    v_mfma_f32_16x16x32_bf16 v[244:247], v[108:111], v[20:23], v[244:247]
    buffer_load_dwordx4 a[4:7], v15, s[4:7], 0 offen offset:1024 sc1
    v_add_f32 v190, v208, v212
    v_add_f32 v190, v190, v216
    v_add_f32 v190, v190, v220
    v_add_f32 v190, v190, v224
    v_cvt_pk_bf16_f32 v72, v208, v212
    v_cvt_pk_bf16_f32 v73, v216, v220
    v_cvt_pk_bf16_f32 v74, v224, 0
    v_cvt_pk_bf16_f32 v76, v209, v213
    v_cvt_pk_bf16_f32 v77, v217, v221
    v_cvt_pk_bf16_f32 v78, v225, 0
    v_cvt_pk_bf16_f32 v80, v210, v214
    v_cvt_pk_bf16_f32 v81, v218, v222
    v_cvt_pk_bf16_f32 v82, v226, 0
    v_cvt_pk_bf16_f32 v84, v211, v215
    v_add_f32 v190, v190, v228
    v_add_f32 v190, v190, v232
    v_add_f32 v190, v190, v236
    v_add_f32 v190, v190, v240
    v_cmp_u_f32 vcc, v190, v244
    v_cvt_pk_bf16_f32 v85, v219, v223
    v_cvt_pk_bf16_f32 v86, v227, 0
    s_cbranch_vccnz g_slow0
g_ok0:
    buffer_load_dwordx4 a[8:11], v15, s[4:7], 0 offen offset:2048 sc1
    v_mfma_f32_16x16x32_bf16 v[208:211], v[112:115], v[72:75], 0
    buffer_load_dwordx4 a[12:15], v15, s[4:7], 0 offen offset:3072 sc1
    v_cvt_pk_bf16_f32 v88, v228, v232
    v_cvt_pk_bf16_f32 v89, v236, v240
    v_mfma_f32_16x16x32_bf16 v[212:215], v[120:123], v[76:79], 0
    v_cvt_pk_bf16_f32 v90, v244, 0
    v_cvt_pk_bf16_f32 v92, v229, v233
    v_add_u32 v15, 4096, v15
    buffer_load_dwordx4 a[16:19], v15, s[4:7], 0 offen offset:0 sc1
    v_mfma_f32_16x16x32_bf16 v[216:219], v[128:131], v[80:83], 0
    v_cvt_pk_bf16_f32 v93, v237, v241
    v_cvt_pk_bf16_f32 v94, v245, 0
    v_mfma_f32_16x16x32_bf16 v[220:223], v[136:139], v[84:87], 0
    v_cvt_pk_bf16_f32 v96, v230, v234
    buffer_load_dwordx4 a[20:23], v15, s[4:7], 0 offen offset:1024 sc1
    v_cvt_pk_bf16_f32 v97, v238, v242
    v_mfma_f32_16x16x32_bf16 v[112:115], v[116:119], v[72:75], 0
    v_cvt_pk_bf16_f32 v98, v246, 0
    v_cvt_pk_bf16_f32 v100, v231, v235
    v_mfma_f32_16x16x32_bf16 v[120:123], v[124:127], v[76:79], 0
    v_cvt_pk_bf16_f32 v101, v239, v243
    buffer_load_dwordx4 a[24:27], v15, s[4:7], 0 offen offset:2048 sc1
    v_cvt_pk_bf16_f32 v102, v247, 0
    v_mfma_f32_16x16x32_bf16 v[224:227], v[144:147], v[88:91], 0
    v_mfma_f32_16x16x32_bf16 v[228:231], v[152:155], v[92:95], 0
    v_cvt_pk_bf16_f32 v104, v208, v212
    v_cvt_pk_bf16_f32 v108, v209, v213
    v_mfma_f32_16x16x32_bf16 v[232:235], v[160:163], v[96:99], 0
    buffer_load_dwordx4 a[28:31], v15, s[4:7], 0 offen offset:3072 sc1
    v_cvt_pk_bf16_f32 v240, v210, v214
    v_cvt_pk_bf16_f32 v105, v216, v220
    v_mfma_f32_16x16x32_bf16 v[236:239], v[168:171], v[100:103], 0
    v_cvt_pk_bf16_f32 v109, v217, v221
    v_cvt_pk_bf16_f32 v241, v218, v222
    v_mfma_f32_16x16x32_bf16 v[128:131], v[132:135], v[80:83], 0
    v_add_u32 v15, 4096, v15
    buffer_load_dwordx4 a[32:35], v15, s[4:7], 0 offen offset:0 sc1
    v_mfma_f32_16x16x32_bf16 v[136:139], v[140:143], v[84:87], 0
    v_cvt_pk_bf16_f32 v106, v224, v228
    v_cvt_pk_bf16_f32 v110, v225, v229
    v_mfma_f32_16x16x32_bf16 v[144:147], v[148:151], v[88:91], 0
    buffer_load_dwordx4 a[36:39], v15, s[4:7], 0 offen offset:1024 sc1
    v_cvt_pk_bf16_f32 v242, v226, v230
    v_mfma_f32_16x16x32_bf16 v[152:155], v[156:159], v[92:95], 0
    v_cvt_pk_bf16_f32 v107, v232, v236
    v_cvt_pk_bf16_f32 v111, v233, v237
    v_mfma_f32_16x16x32_bf16 v[160:163], v[164:167], v[96:99], 0
    buffer_load_dwordx4 a[40:43], v15, s[4:7], 0 offen offset:2048 sc1
    ds_write_b128 v3, v[104:107] offset:0
    v_cvt_pk_bf16_f32 v243, v234, v238
    v_mfma_f32_16x16x32_bf16 v[168:171], v[172:175], v[100:103], 0
    ds_write_b128 v4, v[108:111] offset:128
    ds_write_b128 v255, v[240:243] offset:256
    buffer_load_dwordx4 a[44:47], v15, s[4:7], 0 offen offset:3072 sc1
    s_waitcnt lgkmcnt(0)
    s_barrier
    ds_read_b128 v[72:75], v5 offset:0
    ds_read_b128 v[76:79], v6 offset:0
    ds_read_b128 v[80:83], v7 offset:0
    ds_read_b128 v[84:87], v8 offset:0
    s_add_u32 m0, s35, 0
    v_add_u32 v13, m0, v11
    buffer_load_dwordx4 v13, s[4:7], 0 offen offset:0 sc1 lds
    v_cvt_pk_bf16_f32 v104, v112, v120
    v_cvt_pk_bf16_f32 v105, v128, v136
    v_cvt_pk_bf16_f32 v106, v144, v152
    v_cvt_pk_bf16_f32 v107, v160, v168
    v_cvt_pk_bf16_f32 v108, v113, v121
    v_cvt_pk_bf16_f32 v109, v129, v137
    v_cvt_pk_bf16_f32 v110, v145, v153
    v_cvt_pk_bf16_f32 v111, v161, v169
    v_cvt_pk_bf16_f32 v240, v114, v122
    v_cvt_pk_bf16_f32 v241, v130, v138
    v_cvt_pk_bf16_f32 v242, v146, v154
    v_cvt_pk_bf16_f32 v243, v162, v170
    ds_write_b128 v3, v[104:107] offset:12288
    s_waitcnt lgkmcnt(4)
    v_mfma_f32_32x32x16_bf16 v[176:191], v[72:75], v[24:27], v[176:191]
    ds_write_b128 v4, v[108:111] offset:12416
    s_waitcnt lgkmcnt(4)
    v_mfma_f32_32x32x16_bf16 v[176:191], v[76:79], v[28:31], v[176:191]
    ds_write_b128 v255, v[240:243] offset:12544
    s_waitcnt lgkmcnt(4)
    v_mfma_f32_32x32x16_bf16 v[176:191], v[80:83], v[32:35], v[176:191]
    buffer_load_dwordx4 v13, s[4:7], 0 offen offset:1024 sc1 lds
    s_waitcnt lgkmcnt(3)
    v_mfma_f32_32x32x16_bf16 v[176:191], v[84:87], v[36:39], v[176:191]
    v_mfma_f32_32x32x16_bf16 v[192:207], v[72:75], v[48:51], v[192:207]
    s_waitcnt lgkmcnt(0)
    s_barrier
    ds_read_b128 v[88:91], v5 offset:12288
    ds_read_b128 v[92:95], v6 offset:12288
    ds_read_b128 v[96:99], v7 offset:12288
    ds_read_b128 v[100:103], v8 offset:12288
    v_mfma_f32_32x32x16_bf16 v[192:207], v[76:79], v[52:55], v[192:207]
    v_mfma_f32_32x32x16_bf16 v[192:207], v[80:83], v[56:59], v[192:207]
    v_mfma_f32_32x32x16_bf16 v[192:207], v[84:87], v[60:63], v[192:207]
    s_waitcnt lgkmcnt(3)
    v_mfma_f32_32x32x16_bf16 v[176:191], v[88:91], v[40:43], v[176:191]
    buffer_load_dwordx4 v13, s[4:7], 0 offen offset:2048 sc1 lds
    s_lshl_b32 s3, s16, 6
    v_add_u32 v1, s3, v0
    v_lshrrev_b32 v1, 2, v1
    v_min_u32 v1, 1, v1
    v_lshlrev_b32 v1, 31, v1
    s_waitcnt lgkmcnt(2)
    v_mfma_f32_32x32x16_bf16 v[176:191], v[92:95], v[44:47], v[176:191]
    buffer_load_dwordx4 v13, s[4:7], 0 offen offset:3072 sc1 lds
    v_lshl_add_u32 v1, v0, 7, v1
    v_mov_b32 v2, 1
    s_waitcnt lgkmcnt(1)
    v_mfma_f32_32x32x16_bf16 v[176:191], v[96:99], v[24:27], v[176:191]
    s_add_u32 m0, s35, 4096
    v_add_u32 v13, m0, v11
    buffer_load_dwordx4 v13, s[4:7], 0 offen offset:0 sc1 lds
    s_waitcnt lgkmcnt(0)
    v_mfma_f32_32x32x16_bf16 v[176:191], v[100:103], v[28:31], v[176:191]
    s_add_u32 m0, s35, 40960
    v_add_u32 v13, m0, v11
    buffer_load_dwordx4 v13, s[4:7], 0 offen offset:0 sc1 lds
    v_mfma_f32_32x32x16_bf16 v[192:207], v[88:91], v[56:59], v[192:207]
    buffer_load_dwordx4 v13, s[4:7], 0 offen offset:1024 sc1 lds
    v_mfma_f32_32x32x16_bf16 v[192:207], v[92:95], v[60:63], v[192:207]
    buffer_load_dwordx4 v13, s[4:7], 0 offen offset:2048 sc1 lds
    v_mfma_f32_32x32x16_bf16 v[192:207], v[96:99], v[64:67], v[192:207]
    buffer_load_dwordx4 v13, s[4:7], 0 offen offset:3072 sc1 lds
    s_nop 2
    v_add_f32 v208, v176, v177
    v_mul_f32 v209, v176, v176
    v_fmac_f32 v209, v177, v177
    v_add_f32 v208, v208, v178
    v_fmac_f32 v209, v178, v178
    v_mfma_f32_32x32x16_bf16 v[192:207], v[100:103], v[68:71], v[192:207]
    v_add_f32 v208, v208, v179
    v_fmac_f32 v209, v179, v179
    v_add_f32 v208, v208, v180
    v_fmac_f32 v209, v180, v180
    v_add_f32 v208, v208, v181
    v_fmac_f32 v209, v181, v181
    v_add_f32 v208, v208, v182
    v_fmac_f32 v209, v182, v182
    v_add_f32 v208, v208, v183
    v_fmac_f32 v209, v183, v183
    v_add_f32 v208, v208, v184
    v_fmac_f32 v209, v184, v184
    v_add_f32 v208, v208, v185
    s_add_u32 m0, s35, 45056
    v_add_u32 v13, m0, v11
    buffer_load_dwordx4 v13, s[4:7], 0 offen offset:0 sc1 lds
    v_fmac_f32 v209, v185, v185
    v_add_f32 v208, v208, v202
    v_fmac_f32 v209, v202, v202
    v_add_f32 v208, v208, v201
    v_fmac_f32 v209, v201, v201
    v_add_f32 v208, v208, v200
    v_fmac_f32 v209, v200, v200
    v_add_f32 v208, v208, v199
    v_fmac_f32 v209, v199, v199
    v_add_f32 v208, v208, v198
    s_add_u32 m0, s35, 20480
    v_add_u32 v13, m0, v11
    buffer_load_dwordx4 v13, s[4:7], 0 offen offset:0 sc1 lds
    v_fmac_f32 v209, v198, v198
    v_add_f32 v208, v208, v197
    v_fmac_f32 v209, v197, v197
    v_add_f32 v208, v208, v196
    v_fmac_f32 v209, v196, v196
    v_add_f32 v208, v208, v195
    v_fmac_f32 v209, v195, v195
    v_add_f32 v208, v208, v194
    v_fmac_f32 v209, v194, v194
    v_add_f32 v208, v208, v193
    buffer_load_dwordx4 v13, s[4:7], 0 offen offset:1024 sc1 lds
    v_fmac_f32 v209, v193, v193
    v_add_f32_dpp v208, v208, v208 quad_perm:[1,0,3,2] row_mask:0xf bank_mask:0xf
    s_nop 0
    v_add_f32_dpp v209, v209, v209 quad_perm:[1,0,3,2] row_mask:0xf bank_mask:0xf
    v_add_f32_dpp v208, v208, v208 quad_perm:[2,3,0,1] row_mask:0xf bank_mask:0xf
    s_nop 0
    v_add_f32_dpp v209, v209, v209 quad_perm:[2,3,0,1] row_mask:0xf bank_mask:0xf
    v_add_f32_dpp v208, v208, v208 row_half_mirror row_mask:0xf bank_mask:0xf
    s_nop 0
    v_add_f32_dpp v209, v209, v209 row_half_mirror row_mask:0xf bank_mask:0xf
    v_add_f32_dpp v208, v208, v208 row_mirror row_mask:0xf bank_mask:0xf
    s_nop 0
    v_add_f32_dpp v209, v209, v209 row_mirror row_mask:0xf bank_mask:0xf
    v_mov_b32 v210, v208
    v_mov_b32 v211, v209
    s_nop 0
    v_permlane16_swap_b32 v208, v210
    v_permlane16_swap_b32 v209, v211
    v_add_f32 v208, v208, v210
    v_add_f32 v209, v209, v211
    v_mul_f32 v212, 0xbacccccd, v208
    v_mul_f32 v210, 0x3acccccd, v209
    v_fma_f32 v210, -v212, v212, v210
    v_max_f32 v210, 0, v210
    v_add_f32 v210, 0x3727c5ac, v210
    v_rsq_f32 v210, v210
    s_nop 0
    v_mul_f32 v210, 0x3fb8aa3b, v210
    v_mul_f32 v212, v212, v210
    v_pk_fma_f32 v[176:177], v[176:177], v[210:211], v[212:213] op_sel_hi:[1,0,0]
    v_pk_fma_f32 v[178:179], v[178:179], v[210:211], v[212:213] op_sel_hi:[1,0,0]
    v_pk_fma_f32 v[180:181], v[180:181], v[210:211], v[212:213] op_sel_hi:[1,0,0]
    v_pk_fma_f32 v[182:183], v[182:183], v[210:211], v[212:213] op_sel_hi:[1,0,0]
    v_pk_fma_f32 v[184:185], v[184:185], v[210:211], v[212:213] op_sel_hi:[1,0,0]
    v_pk_fma_f32 v[202:203], v[202:203], v[210:211], v[212:213] op_sel_hi:[1,0,0]
    v_pk_fma_f32 v[200:201], v[200:201], v[210:211], v[212:213] op_sel_hi:[1,0,0]
    v_pk_fma_f32 v[198:199], v[198:199], v[210:211], v[212:213] op_sel_hi:[1,0,0]
    v_pk_fma_f32 v[196:197], v[196:197], v[210:211], v[212:213] op_sel_hi:[1,0,0]
    v_cvt_pk_bf16_f32 v72, v176, v177
    v_cvt_pk_bf16_f32 v73, v178, v179
    v_cvt_pk_bf16_f32 v74, v180, v181
    v_cvt_pk_bf16_f32 v75, v182, v183
    v_cvt_pk_bf16_f32 v76, v184, v185
    v_cvt_pk_bf16_f32 v77, v202, v201
    v_cvt_pk_bf16_f32 v78, v200, v199
    v_cvt_pk_bf16_f32 v79, v198, v197
    ds_write_b128 v9, v[72:75]
    ds_write_b128 v9, v[76:79] offset:128
    v_pk_fma_f32 v[194:195], v[194:195], v[210:211], v[212:213] op_sel_hi:[1,0,0]
    v_pk_fma_f32 v[192:193], v[192:193], v[210:211], v[212:213] op_sel_hi:[1,0,0]
    v_cvt_pk_bf16_f32 v80, v196, v195
    v_cvt_pk_bf16_f32 v81, v194, v193
    ds_write_b64 v10, v[80:81]
    v_rcp_f32 v209, v210
    v_mul_f32 v208, 0x3acccccd, v208
    s_waitcnt lgkmcnt(0)
    s_barrier
    ds_read_b128 v[216:219], v251 offset:0
    ds_read_b128 v[220:223], v251 offset:1024
    ds_read_b128 v[224:227], v251 offset:2048
    buffer_store_dwordx2 v[208:209], v254, s[4:7], s33 offen sc1
    s_waitcnt lgkmcnt(2)
    buffer_store_dwordx4 v[216:219], v248, s[4:7], s32 offen sc1
    s_waitcnt lgkmcnt(1)
    buffer_store_dwordx4 v[220:223], v249, s[4:7], s32 offen sc1
    s_waitcnt lgkmcnt(0)
    buffer_store_dwordx4 v[224:227], v250, s[4:7], s32 offen sc1
    s_barrier
    s_mul_i32 s34, s16, 9216
    buffer_load_dwordx4 v13, s[4:7], 0 offen offset:2048 sc1 lds
    buffer_load_dwordx4 v13, s[4:7], 0 offen offset:3072 sc1 lds
    s_add_u32 m0, s35, 24576
    v_add_u32 v13, m0, v11
    buffer_load_dwordx4 v13, s[4:7], 0 offen offset:0 sc1 lds
    s_add_u32 m0, s35, 61440
    v_add_u32 v13, m0, v11
    buffer_load_dwordx4 v13, s[4:7], 0 offen offset:0 sc1 lds
    v_mov_b32 v6, 1
    s_lshl_b32 s24, s17, 2
    s_add_u32 s24, s24, s16
    s_lshl_b32 s25, s24, 9
    s_add_u32 s25, s25, 0x1980000
    s_lshr_b32 s36, s18, 2
    buffer_load_dwordx4 v13, s[4:7], 0 offen offset:1024 sc1 lds
    s_lshl_b32 s36, s36, 7
    s_add_u32 s36, s36, s25
    s_lshl_b32 s3, s16, 6
    v_add_u32 v7, s3, v0
    v_lshrrev_b32 v7, 2, v7
    buffer_load_dwordx4 v13, s[4:7], 0 offen offset:2048 sc1 lds
    v_min_u32 v7, 1, v7
    v_lshlrev_b32 v7, 31, v7
    v_lshl_add_u32 v7, v0, 7, v7
    s_mul_i32 s27, s24, 110592
    s_mul_i32 s24, s24, 40960
    buffer_load_dwordx4 v13, s[4:7], 0 offen offset:3072 sc1 lds
    s_add_u32 s24, s24, 0xd00000
    v_lshrrev_b32 v3, 4, v0
    v_and_b32 v4, 15, v0
    v_lshlrev_b32 v4, 4, v4
    s_branch .Lps1975
hop1_1:
.Lpd1975:
    s_branch .Lpd3712
.Lps1975:
    v_lshl_add_u32 v3, v3, 9, v4
    v_add_u32 v3, s24, v3
    v_lshlrev_b32 v4, 3, v0
    v_add_u32 v1, 0x10000, v14
    v_add_u32 v2, 0x20000, v14
    s_add_u32 s27, s27, 0x1200000
    s_lshr_b32 s3, s18, 2
    s_sub_u32 s28, s18, s3
    s_lshl_b32 s28, s28, 10
    s_add_u32 s28, s28, s27
    s_add_u32 s28, s28, 98304
    s_mul_i32 s3, s3, 24576
    s_add_u32 s27, s27, s3
    s_lshl_b32 s3, s26, 11
    s_add_u32 s27, s27, s3
    s_mul_i32 s29, s16, 5120
    s_add_u32 s30, s26, 1
    s_lshr_b32 s30, s30, 2
    s_lshl_b32 s30, s30, 31
    s_mov_b32 s31, 0x40053526
    s_waitcnt vmcnt(7)
    s_barrier
    buffer_atomic_add v6, v7, s[4:7], s45 offen sc1
    s_add_u32 m0, s35, 65536
    v_add_u32 v13, m0, v11
    buffer_load_dwordx4 v13, s[4:7], 0 offen offset:0 sc1 lds
    s_add_u32 m0, s34, 126976
    v_add_u32 v13, m0, v11
    buffer_load_dwordx4 v13, s[4:7], 0 offen offset:0 sc1 lds
    buffer_load_dwordx4 v13, s[4:7], 0 offen offset:1024 sc1 lds
    buffer_load_dwordx4 v13, s[4:7], 0 offen offset:2048 sc1 lds
    buffer_load_dwordx4 v13, s[4:7], 0 offen offset:3072 sc1 lds
    s_add_u32 m0, s34, 131072
    v_add_u32 v13, m0, v11
    buffer_load_dwordx4 v13, s[4:7], 0 offen offset:0 sc1 lds
    buffer_load_dwordx4 v13, s[4:7], 0 offen offset:1024 sc1 lds
    buffer_load_dwordx4 v13, s[4:7], 0 offen offset:2048 sc1 lds
    s_lshl_b32 s46, s17, 2
    s_lshr_b32 s3, s18, 2
    s_add_u32 s46, s46, s3
    s_lshl_b32 s46, s46, 1
    s_lshr_b32 s3, s16, 1
    s_add_u32 s46, s46, s3
    s_lshl_b32 s46, s46, 7
    s_add_u32 s46, s46, 0x1988000
    s_lshl_b32 s47, s17, 2
    s_add_u32 s47, s47, s16
    s_lshl_b32 s47, s47, 1
    s_add_u32 s47, s47, s19
    s_lshl_b32 s47, s47, 7
    s_add_u32 s47, s47, 0x1988000
    s_lshl_b32 s41, s17, 1
    s_add_u32 s41, s41, s19
    v_mov_b32 v5, 0
    buffer_atomic_add v5, v12, s[4:7], s36 offen sc0 sc1
    buffer_load_dwordx4 v13, s[4:7], 0 offen offset:3072 sc1 lds
    s_add_u32 m0, s34, 135168
    v_add_u32 v13, m0, v11
    buffer_load_dwordx4 v13, s[4:7], 0 offen offset:0 sc1 lds
    v_add_u32 v15, 4096, v15
    buffer_load_dwordx4 a[48:51], v15, s[4:7], 0 offen offset:0 sc1
    s_mul_i32 s41, s41, 221184
    s_mul_i32 s3, s16, 24576
    s_add_u32 s41, s41, s3
    s_add_u32 s41, s41, 0x1200000
    s_xor_b32 s42, s16, 3
    s_lshr_b32 s3, s42, 1
    s_mul_i32 s3, s3, 110592
    s_add_u32 s37, s41, s3
    s_and_b32 s3, s42, 1
    s_lshl_b32 s3, s3, 10
    s_add_u32 s37, s37, s3
    s_xor_b32 s42, s16, 2
    s_lshr_b32 s3, s42, 1
    s_mul_i32 s3, s3, 110592
    s_add_u32 s38, s41, s3
    s_and_b32 s3, s42, 1
    v_mov_b32 v8, 0
    buffer_atomic_add v8, v12, s[4:7], s36 offen sc0 sc1
    buffer_load_dwordx4 a[52:55], v15, s[4:7], 0 offen offset:1024 sc1
    buffer_load_dwordx4 a[56:59], v15, s[4:7], 0 offen offset:2048 sc1
    buffer_load_dwordx4 a[60:63], v15, s[4:7], 0 offen offset:3072 sc1
    s_lshl_b32 s3, s3, 10
    s_add_u32 s38, s38, s3
    s_xor_b32 s42, s16, 1
    s_lshr_b32 s3, s42, 1
    s_mul_i32 s3, s3, 110592
    s_add_u32 s39, s41, s3
    s_and_b32 s3, s42, 1
    s_lshl_b32 s3, s3, 10
    s_add_u32 s39, s39, s3
    s_xor_b32 s42, s16, 0
    s_lshr_b32 s3, s42, 1
    s_mul_i32 s3, s3, 110592
    s_add_u32 s40, s41, s3
    s_and_b32 s3, s42, 1
    s_lshl_b32 s3, s3, 10
    s_add_u32 s40, s40, s3
    v_mov_b32 v9, 0
    buffer_atomic_add v9, v12, s[4:7], s36 offen sc0 sc1
    v_add_u32 v15, 4096, v15
    buffer_load_dwordx4 a[64:67], v15, s[4:7], 0 offen offset:0 sc1
    buffer_load_dwordx4 a[68:71], v15, s[4:7], 0 offen offset:1024 sc1
    buffer_load_dwordx4 a[72:75], v15, s[4:7], 0 offen offset:2048 sc1
    s_barrier
    ds_read_b128 a[160:163], v14 offset:0
    ds_read_b128 a[164:167], v14 offset:5120
    ds_read_b128 a[168:171], v14 offset:40960
    ds_read_b128 a[172:175], v14 offset:46080
    ds_read_b128 a[176:179], v1 offset:16384
    ds_read_b128 v[72:75], v1 offset:21504
    s_waitcnt vmcnt(11)
    v_readfirstlane_b32 s48, v5
    s_nop 1
    s_bitcmp1_b32 s48, 2
    s_cbranch_scc0 zf0_slow
zf0_ok:
    buffer_load_dwordx4 v[96:99], v3, s[4:7], 0 offen offset:0 sc1
    buffer_load_dwordx4 v[100:103], v3, s[4:7], 0 offen offset:256 sc1
    buffer_load_dwordx4 v[104:107], v3, s[4:7], 0 offen offset:2048 sc1
    buffer_load_dwordx4 v[108:111], v3, s[4:7], 0 offen offset:2304 sc1
    v_add_u32 v3, 4096, v3
    buffer_load_dwordx4 v[112:115], v3, s[4:7], 0 offen offset:0 sc1
    buffer_load_dwordx4 v[116:119], v3, s[4:7], 0 offen offset:256 sc1
    buffer_load_dwordx4 v[120:123], v3, s[4:7], 0 offen offset:2048 sc1
    buffer_load_dwordx4 v[124:127], v3, s[4:7], 0 offen offset:2304 sc1
    v_add_u32 v3, 4096, v3
    buffer_load_dwordx4 v[128:131], v3, s[4:7], 0 offen offset:0 sc1
    buffer_load_dwordx4 v[132:135], v3, s[4:7], 0 offen offset:256 sc1
    buffer_load_dwordx4 v[136:139], v3, s[4:7], 0 offen offset:2048 sc1
    s_waitcnt lgkmcnt(0)
    s_waitcnt vmcnt(10)
    v_mfma_f32_16x16x32_bf16 v[24:27], a[160:163], v[96:99], 0
    ds_read_b128 a[180:183], v14 offset:1024
    ds_read_b128 a[184:187], v14 offset:6144
    v_mfma_f32_16x16x32_bf16 v[32:35], a[164:167], v[96:99], 0
    buffer_load_dwordx4 v[140:143], v3, s[4:7], 0 offen offset:2304 sc1
    ds_read_b128 a[188:191], v14 offset:41984
    v_mfma_f32_16x16x32_bf16 v[40:43], a[168:171], v[96:99], 0
    ds_read_b128 a[192:195], v14 offset:47104
    ds_read_b128 a[196:199], v1 offset:17408
    v_mfma_f32_16x16x32_bf16 v[48:51], a[172:175], v[96:99], 0
    ds_read_b128 v[76:79], v1 offset:22528
    v_mfma_f32_16x16x32_bf16 v[56:59], a[176:179], v[96:99], 0
    v_add_u32 v3, 4096, v3
    v_mfma_f32_16x16x32_bf16 v[64:67], v[72:75], v[96:99], 0
    buffer_load_dwordx4 v[144:147], v3, s[4:7], 0 offen offset:0 sc1
    s_waitcnt vmcnt(11)
    v_mfma_f32_16x16x32_bf16 v[28:31], a[160:163], v[100:103], 0
    v_mfma_f32_16x16x32_bf16 v[36:39], a[164:167], v[100:103], 0
    v_mfma_f32_16x16x32_bf16 v[44:47], a[168:171], v[100:103], 0
    buffer_load_dwordx4 v[148:151], v3, s[4:7], 0 offen offset:256 sc1
    v_mfma_f32_16x16x32_bf16 v[52:55], a[172:175], v[100:103], 0
    v_mfma_f32_16x16x32_bf16 v[60:63], a[176:179], v[100:103], 0
    v_mfma_f32_16x16x32_bf16 v[68:71], v[72:75], v[100:103], 0
    s_waitcnt vmcnt(10) lgkmcnt(0)
    v_mfma_f32_16x16x32_bf16 v[24:27], a[180:183], v[104:107], v[24:27]
    ds_read_b128 a[160:163], v14 offset:2048
    ds_read_b128 a[164:167], v14 offset:7168
    v_mfma_f32_16x16x32_bf16 v[32:35], a[184:187], v[104:107], v[32:35]
    buffer_load_dwordx4 v[152:155], v3, s[4:7], 0 offen offset:2048 sc1
    ds_read_b128 a[168:171], v14 offset:43008
    v_mfma_f32_16x16x32_bf16 v[40:43], a[188:191], v[104:107], v[40:43]
    ds_read_b128 a[172:175], v14 offset:48128
    ds_read_b128 a[176:179], v1 offset:18432
    v_mfma_f32_16x16x32_bf16 v[48:51], a[192:195], v[104:107], v[48:51]
    ds_read_b128 v[72:75], v1 offset:23552
    v_mfma_f32_16x16x32_bf16 v[56:59], a[196:199], v[104:107], v[56:59]
    buffer_load_dwordx4 v[156:159], v3, s[4:7], 0 offen offset:2304 sc1
    v_mfma_f32_16x16x32_bf16 v[64:67], v[76:79], v[104:107], v[64:67]
    v_mfma_f32_16x16x32_bf16 v[28:31], a[180:183], v[108:111], v[28:31]
    v_mfma_f32_16x16x32_bf16 v[36:39], a[184:187], v[108:111], v[36:39]
    v_mfma_f32_16x16x32_bf16 v[44:47], a[188:191], v[108:111], v[44:47]
    v_add_u32 v3, 4096, v3
    v_mfma_f32_16x16x32_bf16 v[52:55], a[192:195], v[108:111], v[52:55]
    buffer_load_dwordx4 v[160:163], v3, s[4:7], 0 offen offset:0 sc1
    v_mfma_f32_16x16x32_bf16 v[60:63], a[196:199], v[108:111], v[60:63]
    v_mfma_f32_16x16x32_bf16 v[68:71], v[76:79], v[108:111], v[68:71]
    s_waitcnt vmcnt(11) lgkmcnt(0)
    v_mfma_f32_16x16x32_bf16 v[24:27], a[160:163], v[112:115], v[24:27]
    ds_read_b128 a[180:183], v14 offset:3072
    ds_read_b128 a[184:187], v14 offset:8192
    v_mfma_f32_16x16x32_bf16 v[32:35], a[164:167], v[112:115], v[32:35]
    buffer_load_dwordx4 v[164:167], v3, s[4:7], 0 offen offset:256 sc1
    ds_read_b128 a[188:191], v14 offset:44032
    v_mfma_f32_16x16x32_bf16 v[40:43], a[168:171], v[112:115], v[40:43]
    ds_read_b128 a[192:195], v14 offset:49152
    ds_read_b128 a[196:199], v1 offset:19456
    v_mfma_f32_16x16x32_bf16 v[48:51], a[172:175], v[112:115], v[48:51]
    ds_read_b128 v[76:79], v1 offset:24576
    v_mfma_f32_16x16x32_bf16 v[56:59], a[176:179], v[112:115], v[56:59]
    buffer_load_dwordx4 v[168:171], v3, s[4:7], 0 offen offset:2048 sc1
    v_mfma_f32_16x16x32_bf16 v[64:67], v[72:75], v[112:115], v[64:67]
    v_mfma_f32_16x16x32_bf16 v[28:31], a[160:163], v[116:119], v[28:31]
    v_mfma_f32_16x16x32_bf16 v[36:39], a[164:167], v[116:119], v[36:39]
    v_mfma_f32_16x16x32_bf16 v[44:47], a[168:171], v[116:119], v[44:47]
    buffer_load_dwordx4 v[172:175], v3, s[4:7], 0 offen offset:2304 sc1
    v_mfma_f32_16x16x32_bf16 v[52:55], a[172:175], v[116:119], v[52:55]
    v_mfma_f32_16x16x32_bf16 v[60:63], a[176:179], v[116:119], v[60:63]
    v_mfma_f32_16x16x32_bf16 v[68:71], v[72:75], v[116:119], v[68:71]
    s_waitcnt vmcnt(12) lgkmcnt(0)
    v_mfma_f32_16x16x32_bf16 v[24:27], a[180:183], v[120:123], v[24:27]
    ds_read_b128 a[160:163], v14 offset:4096
    ds_read_b128 a[164:167], v14 offset:9216
    v_mfma_f32_16x16x32_bf16 v[32:35], a[184:187], v[120:123], v[32:35]
    ds_read_b128 a[168:171], v14 offset:45056
    ds_read_b128 a[172:175], v14 offset:50176
    v_mfma_f32_16x16x32_bf16 v[40:43], a[188:191], v[120:123], v[40:43]
    ds_read_b128 a[176:179], v1 offset:20480
    ds_read_b128 v[72:75], v1 offset:25600
    v_mfma_f32_16x16x32_bf16 v[48:51], a[192:195], v[120:123], v[48:51]
    v_add_u32 v3, 4096, v3
    v_mfma_f32_16x16x32_bf16 v[56:59], a[196:199], v[120:123], v[56:59]
    buffer_load_dwordx4 v[176:179], v3, s[4:7], 0 offen offset:0 sc1
    buffer_load_dwordx4 v[180:183], v3, s[4:7], 0 offen offset:256 sc1
    v_mfma_f32_16x16x32_bf16 v[64:67], v[76:79], v[120:123], v[64:67]
    v_mfma_f32_16x16x32_bf16 v[28:31], a[180:183], v[124:127], v[28:31]
    v_mfma_f32_16x16x32_bf16 v[36:39], a[184:187], v[124:127], v[36:39]
    v_mfma_f32_16x16x32_bf16 v[44:47], a[188:191], v[124:127], v[44:47]
    buffer_load_dwordx4 v[184:187], v3, s[4:7], 0 offen offset:2048 sc1
    v_mfma_f32_16x16x32_bf16 v[52:55], a[192:195], v[124:127], v[52:55]
    v_mfma_f32_16x16x32_bf16 v[60:63], a[196:199], v[124:127], v[60:63]
    v_mfma_f32_16x16x32_bf16 v[68:71], v[76:79], v[124:127], v[68:71]
    s_waitcnt vmcnt(13) lgkmcnt(0)
    v_mfma_f32_16x16x32_bf16 v[24:27], a[160:163], v[128:131], v[24:27]
    ds_read_b128 a[180:183], v14 offset:10240
    ds_read_b128 a[184:187], v14 offset:15360
    v_mfma_f32_16x16x32_bf16 v[32:35], a[164:167], v[128:131], v[32:35]
    buffer_load_dwordx4 v[188:191], v3, s[4:7], 0 offen offset:2304 sc1
    ds_read_b128 a[188:191], v14 offset:51200
    v_mfma_f32_16x16x32_bf16 v[40:43], a[168:171], v[128:131], v[40:43]
    ds_read_b128 a[192:195], v14 offset:56320
    ds_read_b128 a[196:199], v1 offset:26624
    v_mfma_f32_16x16x32_bf16 v[48:51], a[172:175], v[128:131], v[48:51]
    ds_read_b128 v[76:79], v1 offset:31744
    v_mfma_f32_16x16x32_bf16 v[56:59], a[176:179], v[128:131], v[56:59]
    v_add_u32 v3, 4096, v3
    v_mfma_f32_16x16x32_bf16 v[64:67], v[72:75], v[128:131], v[64:67]
    buffer_load_dwordx4 v[192:195], v3, s[4:7], 0 offen offset:0 sc1
    v_mfma_f32_16x16x32_bf16 v[28:31], a[160:163], v[132:135], v[28:31]
    v_mfma_f32_16x16x32_bf16 v[36:39], a[164:167], v[132:135], v[36:39]
    v_mfma_f32_16x16x32_bf16 v[44:47], a[168:171], v[132:135], v[44:47]
    buffer_load_dwordx4 v[196:199], v3, s[4:7], 0 offen offset:256 sc1
    v_mfma_f32_16x16x32_bf16 v[52:55], a[172:175], v[132:135], v[52:55]
    v_mfma_f32_16x16x32_bf16 v[60:63], a[176:179], v[132:135], v[60:63]
    v_mfma_f32_16x16x32_bf16 v[68:71], v[72:75], v[132:135], v[68:71]
    s_waitcnt vmcnt(14) lgkmcnt(0)
    v_mfma_f32_16x16x32_bf16 v[24:27], a[180:183], v[136:139], v[24:27]
    ds_read_b128 a[160:163], v14 offset:11264
    ds_read_b128 a[164:167], v14 offset:16384
    v_mfma_f32_16x16x32_bf16 v[32:35], a[184:187], v[136:139], v[32:35]
    buffer_load_dwordx4 v[200:203], v3, s[4:7], 0 offen offset:2048 sc1
    ds_read_b128 a[168:171], v14 offset:52224
    v_mfma_f32_16x16x32_bf16 v[40:43], a[188:191], v[136:139], v[40:43]
    ds_read_b128 a[172:175], v14 offset:57344
    ds_read_b128 a[176:179], v1 offset:27648
    v_mfma_f32_16x16x32_bf16 v[48:51], a[192:195], v[136:139], v[48:51]
    ds_read_b128 v[72:75], v1 offset:32768
    v_mfma_f32_16x16x32_bf16 v[56:59], a[196:199], v[136:139], v[56:59]
    buffer_load_dwordx4 v[204:207], v3, s[4:7], 0 offen offset:2304 sc1
    v_mfma_f32_16x16x32_bf16 v[64:67], v[76:79], v[136:139], v[64:67]
    v_mfma_f32_16x16x32_bf16 v[28:31], a[180:183], v[140:143], v[28:31]
    v_mfma_f32_16x16x32_bf16 v[36:39], a[184:187], v[140:143], v[36:39]
    v_mfma_f32_16x16x32_bf16 v[44:47], a[188:191], v[140:143], v[44:47]
    v_add_u32 v3, 4096, v3
    v_mfma_f32_16x16x32_bf16 v[52:55], a[192:195], v[140:143], v[52:55]
    buffer_load_dwordx4 v[208:211], v3, s[4:7], 0 offen offset:0 sc1
    v_mfma_f32_16x16x32_bf16 v[60:63], a[196:199], v[140:143], v[60:63]
    v_mfma_f32_16x16x32_bf16 v[68:71], v[76:79], v[140:143], v[68:71]
    s_waitcnt vmcnt(15) lgkmcnt(0)
    v_mfma_f32_16x16x32_bf16 v[24:27], a[160:163], v[144:147], v[24:27]
    ds_read_b128 a[180:183], v14 offset:12288
    ds_read_b128 a[184:187], v14 offset:17408
    v_mfma_f32_16x16x32_bf16 v[32:35], a[164:167], v[144:147], v[32:35]
    buffer_load_dwordx4 v[212:215], v3, s[4:7], 0 offen offset:256 sc1
    ds_read_b128 a[188:191], v14 offset:53248
    v_mfma_f32_16x16x32_bf16 v[40:43], a[168:171], v[144:147], v[40:43]
    ds_read_b128 a[192:195], v14 offset:58368
    ds_read_b128 a[196:199], v1 offset:28672
    v_mfma_f32_16x16x32_bf16 v[48:51], a[172:175], v[144:147], v[48:51]
    ds_read_b128 v[76:79], v1 offset:33792
    v_mfma_f32_16x16x32_bf16 v[56:59], a[176:179], v[144:147], v[56:59]
    buffer_load_dwordx4 v[216:219], v3, s[4:7], 0 offen offset:2048 sc1
    v_mfma_f32_16x16x32_bf16 v[64:67], v[72:75], v[144:147], v[64:67]
    v_mfma_f32_16x16x32_bf16 v[28:31], a[160:163], v[148:151], v[28:31]
    v_mfma_f32_16x16x32_bf16 v[36:39], a[164:167], v[148:151], v[36:39]
    v_mfma_f32_16x16x32_bf16 v[44:47], a[168:171], v[148:151], v[44:47]
    buffer_load_dwordx4 v[220:223], v3, s[4:7], 0 offen offset:2304 sc1
    v_mfma_f32_16x16x32_bf16 v[52:55], a[172:175], v[148:151], v[52:55]
    v_mfma_f32_16x16x32_bf16 v[60:63], a[176:179], v[148:151], v[60:63]
    v_mfma_f32_16x16x32_bf16 v[68:71], v[72:75], v[148:151], v[68:71]
    s_waitcnt vmcnt(16) lgkmcnt(0)
    v_mfma_f32_16x16x32_bf16 v[24:27], a[180:183], v[152:155], v[24:27]
    ds_read_b128 a[160:163], v14 offset:13312
    ds_read_b128 a[164:167], v14 offset:18432
    v_mfma_f32_16x16x32_bf16 v[32:35], a[184:187], v[152:155], v[32:35]
    ds_read_b128 a[168:171], v14 offset:54272
    ds_read_b128 a[172:175], v14 offset:59392
    v_mfma_f32_16x16x32_bf16 v[40:43], a[188:191], v[152:155], v[40:43]
    ds_read_b128 a[176:179], v1 offset:29696
    ds_read_b128 v[72:75], v1 offset:34816
    v_mfma_f32_16x16x32_bf16 v[48:51], a[192:195], v[152:155], v[48:51]
    v_add_u32 v3, 4096, v3
    v_mfma_f32_16x16x32_bf16 v[56:59], a[196:199], v[152:155], v[56:59]
    buffer_load_dwordx4 v[224:227], v3, s[4:7], 0 offen offset:0 sc1
    buffer_load_dwordx4 v[228:231], v3, s[4:7], 0 offen offset:256 sc1
    v_mfma_f32_16x16x32_bf16 v[64:67], v[76:79], v[152:155], v[64:67]
    v_mfma_f32_16x16x32_bf16 v[28:31], a[180:183], v[156:159], v[28:31]
    v_mfma_f32_16x16x32_bf16 v[36:39], a[184:187], v[156:159], v[36:39]
    v_mfma_f32_16x16x32_bf16 v[44:47], a[188:191], v[156:159], v[44:47]
    buffer_load_dwordx4 v[232:235], v3, s[4:7], 0 offen offset:2048 sc1
    v_mfma_f32_16x16x32_bf16 v[52:55], a[192:195], v[156:159], v[52:55]
    v_mfma_f32_16x16x32_bf16 v[60:63], a[196:199], v[156:159], v[60:63]
    v_mfma_f32_16x16x32_bf16 v[68:71], v[76:79], v[156:159], v[68:71]
    s_waitcnt vmcnt(17) lgkmcnt(0)
    v_mfma_f32_16x16x32_bf16 v[24:27], a[160:163], v[160:163], v[24:27]
    ds_read_b128 a[180:183], v14 offset:14336
    ds_read_b128 a[184:187], v14 offset:19456
    v_mfma_f32_16x16x32_bf16 v[32:35], a[164:167], v[160:163], v[32:35]
    buffer_load_dwordx4 v[236:239], v3, s[4:7], 0 offen offset:2304 sc1
    ds_read_b128 a[188:191], v14 offset:55296
    v_mfma_f32_16x16x32_bf16 v[40:43], a[168:171], v[160:163], v[40:43]
    ds_read_b128 a[192:195], v14 offset:60416
    ds_read_b128 a[196:199], v1 offset:30720
    v_mfma_f32_16x16x32_bf16 v[48:51], a[172:175], v[160:163], v[48:51]
    ds_read_b128 v[76:79], v1 offset:35840
    v_mfma_f32_16x16x32_bf16 v[56:59], a[176:179], v[160:163], v[56:59]
    v_add_u32 v3, 4096, v3
    v_mfma_f32_16x16x32_bf16 v[64:67], v[72:75], v[160:163], v[64:67]
    buffer_load_dwordx4 v[240:243], v3, s[4:7], 0 offen offset:0 sc1
    v_mfma_f32_16x16x32_bf16 v[28:31], a[160:163], v[164:167], v[28:31]
    v_mfma_f32_16x16x32_bf16 v[36:39], a[164:167], v[164:167], v[36:39]
    v_mfma_f32_16x16x32_bf16 v[44:47], a[168:171], v[164:167], v[44:47]
    buffer_load_dwordx4 v[244:247], v3, s[4:7], 0 offen offset:256 sc1
    v_mfma_f32_16x16x32_bf16 v[52:55], a[172:175], v[164:167], v[52:55]
    v_mfma_f32_16x16x32_bf16 v[60:63], a[176:179], v[164:167], v[60:63]
    v_mfma_f32_16x16x32_bf16 v[68:71], v[72:75], v[164:167], v[68:71]
    s_waitcnt vmcnt(18) lgkmcnt(0)
    s_barrier
    v_mfma_f32_16x16x32_bf16 v[24:27], a[180:183], v[168:171], v[24:27]
    ds_read_b128 a[160:163], v14 offset:20480
    ds_read_b128 a[164:167], v14 offset:21504
    v_mfma_f32_16x16x32_bf16 v[32:35], a[184:187], v[168:171], v[32:35]
    buffer_load_dwordx4 v[248:251], v3, s[4:7], 0 offen offset:2048 sc1
    ds_read_b128 a[168:171], v14 offset:22528
    v_mfma_f32_16x16x32_bf16 v[40:43], a[188:191], v[168:171], v[40:43]
    ds_read_b128 a[172:175], v14 offset:23552
    ds_read_b128 a[176:179], v14 offset:24576
    v_mfma_f32_16x16x32_bf16 v[48:51], a[192:195], v[168:171], v[48:51]
    v_mfma_f32_16x16x32_bf16 v[56:59], a[196:199], v[168:171], v[56:59]
    buffer_load_dwordx4 v[252:255], v3, s[4:7], 0 offen offset:2304 sc1
    v_mfma_f32_16x16x32_bf16 v[64:67], v[76:79], v[168:171], v[64:67]
    v_mfma_f32_16x16x32_bf16 v[28:31], a[180:183], v[172:175], v[28:31]
    v_mfma_f32_16x16x32_bf16 v[36:39], a[184:187], v[172:175], v[36:39]
    v_mfma_f32_16x16x32_bf16 v[44:47], a[188:191], v[172:175], v[44:47]
    s_add_u32 m0, s29, 0
    v_add_u32 v11, 0x28000, v11
    v_add_u32 v13, m0, v11
    v_mfma_f32_16x16x32_bf16 v[52:55], a[192:195], v[172:175], v[52:55]
    buffer_load_dwordx4 v13, s[4:7], 0 offen offset:0 sc1 lds
    v_mfma_f32_16x16x32_bf16 v[60:63], a[196:199], v[172:175], v[60:63]
    v_mfma_f32_16x16x32_bf16 v[68:71], v[76:79], v[172:175], v[68:71]
    s_waitcnt vmcnt(11) lgkmcnt(0)
    v_mfma_f32_16x16x32_bf16 v[24:27], a[160:163], v[176:179], v[24:27]
    ds_read_b128 a[180:183], v14 offset:25600
    ds_read_b128 a[184:187], v14 offset:26624
    v_mfma_f32_16x16x32_bf16 v[24:27], a[164:167], v[184:187], v[24:27]
    buffer_load_dwordx4 v13, s[4:7], 0 offen offset:1024 sc1 lds
    ds_read_b128 a[188:191], v14 offset:27648
    v_mfma_f32_16x16x32_bf16 v[24:27], a[168:171], v[192:195], v[24:27]
    ds_read_b128 a[192:195], v14 offset:28672
    ds_read_b128 a[196:199], v14 offset:29696
    v_mfma_f32_16x16x32_bf16 v[24:27], a[172:175], v[200:203], v[24:27]
    v_mfma_f32_16x16x32_bf16 v[24:27], a[176:179], v[208:211], v[24:27]
    buffer_load_dwordx4 v13, s[4:7], 0 offen offset:2048 sc1 lds
    v_mfma_f32_16x16x32_bf16 v[28:31], a[160:163], v[180:183], v[28:31]
    v_mfma_f32_16x16x32_bf16 v[28:31], a[164:167], v[188:191], v[28:31]
    v_mfma_f32_16x16x32_bf16 v[28:31], a[168:171], v[196:199], v[28:31]
    v_mfma_f32_16x16x32_bf16 v[28:31], a[172:175], v[204:207], v[28:31]
    buffer_load_dwordx4 v13, s[4:7], 0 offen offset:3072 sc1 lds
    v_mfma_f32_16x16x32_bf16 v[28:31], a[176:179], v[212:215], v[28:31]
    s_waitcnt lgkmcnt(0)
    v_mfma_f32_16x16x32_bf16 v[32:35], a[180:183], v[176:179], v[32:35]
    ds_read_b128 a[160:163], v14 offset:61440
    ds_read_b128 a[164:167], v14 offset:62464
    v_mfma_f32_16x16x32_bf16 v[32:35], a[184:187], v[184:187], v[32:35]
    ds_read_b128 a[168:171], v14 offset:63488
    ds_read_b128 a[172:175], v14 offset:64512
    v_mfma_f32_16x16x32_bf16 v[32:35], a[188:191], v[192:195], v[32:35]
    s_add_u32 m0, s29, 4096
    ds_read_b128 a[176:179], v1 offset:0
    v_add_u32 v13, m0, v11
    v_mfma_f32_16x16x32_bf16 v[32:35], a[192:195], v[200:203], v[32:35]
    buffer_load_dwordx4 v13, s[4:7], 0 offen offset:0 sc1 lds
    v_mfma_f32_16x16x32_bf16 v[32:35], a[196:199], v[208:211], v[32:35]
    v_mfma_f32_16x16x32_bf16 v[36:39], a[180:183], v[180:183], v[36:39]
    v_mfma_f32_16x16x32_bf16 v[36:39], a[184:187], v[188:191], v[36:39]
    s_add_u32 m0, s29, 40960
    v_add_u32 v11, 0xffffb000, v11
    v_add_u32 v13, m0, v11
    v_mfma_f32_16x16x32_bf16 v[36:39], a[188:191], v[196:199], v[36:39]
    buffer_load_dwordx4 v13, s[4:7], 0 offen offset:0 sc1 lds
    v_mfma_f32_16x16x32_bf16 v[36:39], a[192:195], v[204:207], v[36:39]
    v_mfma_f32_16x16x32_bf16 v[36:39], a[196:199], v[212:215], v[36:39]
    s_waitcnt lgkmcnt(0)
    v_mfma_f32_16x16x32_bf16 v[40:43], a[160:163], v[176:179], v[40:43]
    ds_read_b128 a[180:183], v1 offset:1024
    ds_read_b128 a[184:187], v1 offset:2048
    v_mfma_f32_16x16x32_bf16 v[40:43], a[164:167], v[184:187], v[40:43]
    ds_read_b128 a[188:191], v1 offset:3072
    buffer_load_dwordx4 v13, s[4:7], 0 offen offset:1024 sc1 lds
    v_mfma_f32_16x16x32_bf16 v[40:43], a[168:171], v[192:195], v[40:43]
    ds_read_b128 a[192:195], v1 offset:4096
    ds_read_b128 a[196:199], v1 offset:5120
    v_mfma_f32_16x16x32_bf16 v[40:43], a[172:175], v[200:203], v[40:43]
    v_mfma_f32_16x16x32_bf16 v[40:43], a[176:179], v[208:211], v[40:43]
    v_mfma_f32_16x16x32_bf16 v[44:47], a[160:163], v[180:183], v[44:47]
    buffer_load_dwordx4 v13, s[4:7], 0 offen offset:2048 sc1 lds
    v_mfma_f32_16x16x32_bf16 v[44:47], a[164:167], v[188:191], v[44:47]
    v_mfma_f32_16x16x32_bf16 v[44:47], a[168:171], v[196:199], v[44:47]
    v_mfma_f32_16x16x32_bf16 v[44:47], a[172:175], v[204:207], v[44:47]
    v_mfma_f32_16x16x32_bf16 v[44:47], a[176:179], v[212:215], v[44:47]
    s_waitcnt lgkmcnt(0)
    buffer_load_dwordx4 v13, s[4:7], 0 offen offset:3072 sc1 lds
    v_mfma_f32_16x16x32_bf16 v[48:51], a[180:183], v[176:179], v[48:51]
    ds_read_b128 a[160:163], v1 offset:36864
    ds_read_b128 a[164:167], v1 offset:37888
    v_mfma_f32_16x16x32_bf16 v[48:51], a[184:187], v[184:187], v[48:51]
    ds_read_b128 a[168:171], v1 offset:38912
    ds_read_b128 a[172:175], v1 offset:39936
    v_mfma_f32_16x16x32_bf16 v[48:51], a[188:191], v[192:195], v[48:51]
    ds_read_b128 a[176:179], v1 offset:40960
    v_mfma_f32_16x16x32_bf16 v[48:51], a[192:195], v[200:203], v[48:51]
    s_add_u32 m0, s29, 45056
    v_add_u32 v13, m0, v11
    v_mfma_f32_16x16x32_bf16 v[48:51], a[196:199], v[208:211], v[48:51]
    buffer_load_dwordx4 v13, s[4:7], 0 offen offset:0 sc1 lds
    v_mfma_f32_16x16x32_bf16 v[52:55], a[180:183], v[180:183], v[52:55]
    v_mfma_f32_16x16x32_bf16 v[52:55], a[184:187], v[188:191], v[52:55]
    v_mfma_f32_16x16x32_bf16 v[52:55], a[188:191], v[196:199], v[52:55]
    s_add_u32 m0, s29, 81920
    v_add_u32 v11, 0xffffb000, v11
    v_add_u32 v13, m0, v11
    v_mfma_f32_16x16x32_bf16 v[52:55], a[192:195], v[204:207], v[52:55]
    buffer_load_dwordx4 v13, s[4:7], 0 offen offset:0 sc1 lds
    v_mfma_f32_16x16x32_bf16 v[52:55], a[196:199], v[212:215], v[52:55]
    s_waitcnt lgkmcnt(0)
    v_mfma_f32_16x16x32_bf16 v[56:59], a[160:163], v[176:179], v[56:59]
    ds_read_b128 a[180:183], v1 offset:41984
    ds_read_b128 a[184:187], v1 offset:43008
    v_mfma_f32_16x16x32_bf16 v[56:59], a[164:167], v[184:187], v[56:59]
    ds_read_b128 a[188:191], v1 offset:44032
    ds_read_b128 a[192:195], v1 offset:45056
    v_mfma_f32_16x16x32_bf16 v[56:59], a[168:171], v[192:195], v[56:59]
    buffer_load_dwordx4 v13, s[4:7], 0 offen offset:1024 sc1 lds
    ds_read_b128 a[196:199], v1 offset:46080
    v_mfma_f32_16x16x32_bf16 v[56:59], a[172:175], v[200:203], v[56:59]
    v_mfma_f32_16x16x32_bf16 v[56:59], a[176:179], v[208:211], v[56:59]
    v_mfma_f32_16x16x32_bf16 v[60:63], a[160:163], v[180:183], v[60:63]
    v_mfma_f32_16x16x32_bf16 v[60:63], a[164:167], v[188:191], v[60:63]
    buffer_load_dwordx4 v13, s[4:7], 0 offen offset:2048 sc1 lds
    v_mfma_f32_16x16x32_bf16 v[60:63], a[168:171], v[196:199], v[60:63]
    v_mfma_f32_16x16x32_bf16 v[60:63], a[172:175], v[204:207], v[60:63]
    v_mfma_f32_16x16x32_bf16 v[60:63], a[176:179], v[212:215], v[60:63]
    s_waitcnt lgkmcnt(0)
    v_mfma_f32_16x16x32_bf16 v[64:67], a[180:183], v[176:179], v[64:67]
    ds_read_b128 a[160:163], v14 offset:30720
    ds_read_b128 a[164:167], v14 offset:31744
    v_mfma_f32_16x16x32_bf16 v[64:67], a[184:187], v[184:187], v[64:67]
    buffer_load_dwordx4 v13, s[4:7], 0 offen offset:3072 sc1 lds
    ds_read_b128 a[168:171], v14 offset:32768
    v_mfma_f32_16x16x32_bf16 v[64:67], a[188:191], v[192:195], v[64:67]
    ds_read_b128 a[172:175], v14 offset:33792
    ds_read_b128 a[176:179], v14 offset:34816
    v_mfma_f32_16x16x32_bf16 v[64:67], a[192:195], v[200:203], v[64:67]
    v_mfma_f32_16x16x32_bf16 v[64:67], a[196:199], v[208:211], v[64:67]
    s_add_u32 m0, s29, 86016
    v_add_u32 v13, m0, v11
    v_mfma_f32_16x16x32_bf16 v[68:71], a[180:183], v[180:183], v[68:71]
    buffer_load_dwordx4 v13, s[4:7], 0 offen offset:0 sc1 lds
    v_mfma_f32_16x16x32_bf16 v[68:71], a[184:187], v[188:191], v[68:71]
    v_mfma_f32_16x16x32_bf16 v[68:71], a[188:191], v[196:199], v[68:71]
    v_mfma_f32_16x16x32_bf16 v[68:71], a[192:195], v[204:207], v[68:71]
    buffer_load_dwordx4 a[76:79], v15, s[4:7], 0 offen offset:3072 sc1
    v_mfma_f32_16x16x32_bf16 v[68:71], a[196:199], v[212:215], v[68:71]
    s_waitcnt vmcnt(16) lgkmcnt(0)
    v_mfma_f32_16x16x32_bf16 v[24:27], a[160:163], v[216:219], v[24:27]
    ds_read_b128 a[180:183], v1 offset:6144
    ds_read_b128 a[184:187], v1 offset:7168
    v_mfma_f32_16x16x32_bf16 v[24:27], a[164:167], v[224:227], v[24:27]
    ds_read_b128 a[188:191], v1 offset:8192
    ds_read_b128 a[192:195], v1 offset:9216
    v_mfma_f32_16x16x32_bf16 v[24:27], a[168:171], v[232:235], v[24:27]
    ds_read_b128 a[196:199], v1 offset:10240
    v_add_u32 v15, 4096, v15
    v_mfma_f32_16x16x32_bf16 v[24:27], a[172:175], v[240:243], v[24:27]
    buffer_load_dwordx4 a[80:83], v15, s[4:7], 0 offen offset:0 sc1
    v_mfma_f32_16x16x32_bf16 v[24:27], a[176:179], v[248:251], v[24:27]
    v_mfma_f32_16x16x32_bf16 v[28:31], a[160:163], v[220:223], v[28:31]
    v_mfma_f32_16x16x32_bf16 v[28:31], a[164:167], v[228:231], v[28:31]
    v_mfma_f32_16x16x32_bf16 v[28:31], a[168:171], v[236:239], v[28:31]
    buffer_load_dwordx4 a[84:87], v15, s[4:7], 0 offen offset:1024 sc1
    v_mfma_f32_16x16x32_bf16 v[28:31], a[172:175], v[244:247], v[28:31]
    v_mfma_f32_16x16x32_bf16 v[28:31], a[176:179], v[252:255], v[28:31]
    s_waitcnt lgkmcnt(0)
    v_mfma_f32_16x16x32_bf16 v[40:43], a[180:183], v[216:219], v[40:43]
    ds_read_b128 a[160:163], v1 offset:47104
    ds_read_b128 a[164:167], v1 offset:48128
    v_mfma_f32_16x16x32_bf16 v[40:43], a[184:187], v[224:227], v[40:43]
    ds_read_b128 a[168:171], v1 offset:49152
    buffer_load_dwordx4 a[88:91], v15, s[4:7], 0 offen offset:2048 sc1
    v_mfma_f32_16x16x32_bf16 v[40:43], a[188:191], v[232:235], v[40:43]
    ds_read_b128 a[172:175], v1 offset:50176
    ds_read_b128 a[176:179], v1 offset:51200
    v_mfma_f32_16x16x32_bf16 v[40:43], a[192:195], v[240:243], v[40:43]
    v_mfma_f32_16x16x32_bf16 v[40:43], a[196:199], v[248:251], v[40:43]
    v_mfma_f32_16x16x32_bf16 v[44:47], a[180:183], v[220:223], v[44:47]
    buffer_load_dwordx4 a[92:95], v15, s[4:7], 0 offen offset:3072 sc1
    v_mfma_f32_16x16x32_bf16 v[44:47], a[184:187], v[228:231], v[44:47]
    v_exp_f32_e64 v88, -v24
    v_mfma_f32_16x16x32_bf16 v[44:47], a[188:191], v[236:239], v[44:47]
    v_exp_f32_e64 v89, -v25
    v_mfma_f32_16x16x32_bf16 v[44:47], a[192:195], v[244:247], v[44:47]
    v_exp_f32_e64 v90, -v26
    v_mfma_f32_16x16x32_bf16 v[44:47], a[196:199], v[252:255], v[44:47]
    s_waitcnt lgkmcnt(0)
    v_add_u32 v15, 4096, v15
    v_fma_f32 v88, v88, s31, s31
    v_mfma_f32_16x16x32_bf16 v[56:59], a[160:163], v[216:219], v[56:59]
    buffer_load_dwordx4 a[96:99], v15, s[4:7], 0 offen offset:0 sc1
    ds_read_b128 a[180:183], v14 offset:35840
    v_mfma_f32_16x16x32_bf16 v[56:59], a[164:167], v[224:227], v[56:59]
    ds_read_b128 a[184:187], v14 offset:36864
    ds_read_b128 a[188:191], v14 offset:37888
    v_mfma_f32_16x16x32_bf16 v[56:59], a[168:171], v[232:235], v[56:59]
    ds_read_b128 a[192:195], v14 offset:38912
    ds_read_b128 a[196:199], v14 offset:39936
    v_mfma_f32_16x16x32_bf16 v[56:59], a[172:175], v[240:243], v[56:59]
    buffer_load_dwordx4 a[100:103], v15, s[4:7], 0 offen offset:1024 sc1
    v_fma_f32 v89, v89, s31, s31
    v_mfma_f32_16x16x32_bf16 v[56:59], a[176:179], v[248:251], v[56:59]
    v_exp_f32_e64 v91, -v27
    v_mfma_f32_16x16x32_bf16 v[60:63], a[160:163], v[220:223], v[60:63]
    v_exp_f32_e64 v92, -v28
    v_mfma_f32_16x16x32_bf16 v[60:63], a[164:167], v[228:231], v[60:63]
    v_exp_f32_e64 v93, -v29
    v_mfma_f32_16x16x32_bf16 v[60:63], a[168:171], v[236:239], v[60:63]
    v_exp_f32_e64 v94, -v30
    v_mfma_f32_16x16x32_bf16 v[60:63], a[172:175], v[244:247], v[60:63]
    buffer_load_dwordx4 a[104:107], v15, s[4:7], 0 offen offset:2048 sc1
    v_fma_f32 v90, v90, s31, s31
    v_mfma_f32_16x16x32_bf16 v[60:63], a[176:179], v[252:255], v[60:63]
    s_waitcnt lgkmcnt(0)
    v_exp_f32_e64 v95, -v31
    v_mfma_f32_16x16x32_bf16 v[32:35], a[180:183], v[216:219], v[32:35]
    ds_read_b128 a[160:163], v1 offset:11264
    ds_read_b128 a[164:167], v1 offset:12288
    v_mfma_f32_16x16x32_bf16 v[32:35], a[184:187], v[224:227], v[32:35]
    ds_read_b128 a[168:171], v1 offset:13312
    ds_read_b128 a[172:175], v1 offset:14336
    v_mfma_f32_16x16x32_bf16 v[32:35], a[188:191], v[232:235], v[32:35]
    s_branch .Lps2536
hop1_2:
.Lpd2536:
    s_branch .Lpd4322
.Lps2536:
    buffer_load_dwordx4 a[108:111], v15, s[4:7], 0 offen offset:3072 sc1
    ds_read_b128 a[176:179], v1 offset:15360
    v_mfma_f32_16x16x32_bf16 v[32:35], a[192:195], v[240:243], v[32:35]
    v_rcp_f32 v88, v88
    v_mfma_f32_16x16x32_bf16 v[32:35], a[196:199], v[248:251], v[32:35]
    v_rcp_f32 v89, v89
    v_mfma_f32_16x16x32_bf16 v[36:39], a[180:183], v[220:223], v[36:39]
    v_rcp_f32 v90, v90
    v_mfma_f32_16x16x32_bf16 v[36:39], a[184:187], v[228:231], v[36:39]
    v_add_u32 v15, 4096, v15
    v_fma_f32 v91, v91, s31, s31
    v_mfma_f32_16x16x32_bf16 v[36:39], a[188:191], v[236:239], v[36:39]
    buffer_load_dwordx4 a[112:115], v15, s[4:7], 0 offen offset:0 sc1
    v_fma_f32 v92, v92, s31, s31
    v_mfma_f32_16x16x32_bf16 v[36:39], a[192:195], v[244:247], v[36:39]
    v_rcp_f32 v91, v91
    v_mfma_f32_16x16x32_bf16 v[36:39], a[196:199], v[252:255], v[36:39]
    s_waitcnt lgkmcnt(0)
    v_rcp_f32 v92, v92
    v_mfma_f32_16x16x32_bf16 v[48:51], a[160:163], v[216:219], v[48:51]
    ds_read_b128 a[180:183], v1 offset:52224
    ds_read_b128 a[184:187], v1 offset:53248
    v_mfma_f32_16x16x32_bf16 v[48:51], a[164:167], v[224:227], v[48:51]
    buffer_load_dwordx4 a[116:119], v15, s[4:7], 0 offen offset:1024 sc1
    ds_read_b128 a[188:191], v1 offset:54272
    v_mfma_f32_16x16x32_bf16 v[48:51], a[168:171], v[232:235], v[48:51]
    ds_read_b128 a[192:195], v1 offset:55296
    ds_read_b128 a[196:199], v1 offset:56320
    v_mfma_f32_16x16x32_bf16 v[48:51], a[172:175], v[240:243], v[48:51]
    v_fma_f32 v93, v93, s31, s31
    v_fma_f32 v94, v94, s31, s31
    v_mfma_f32_16x16x32_bf16 v[48:51], a[176:179], v[248:251], v[48:51]
    buffer_load_dwordx4 a[120:123], v15, s[4:7], 0 offen offset:2048 sc1
    v_fma_f32 v95, v95, s31, s31
    v_mfma_f32_16x16x32_bf16 v[52:55], a[160:163], v[220:223], v[52:55]
    v_rcp_f32 v93, v93
    v_mfma_f32_16x16x32_bf16 v[52:55], a[164:167], v[228:231], v[52:55]
    v_rcp_f32 v94, v94
    v_mfma_f32_16x16x32_bf16 v[52:55], a[168:171], v[236:239], v[52:55]
    v_rcp_f32 v95, v95
    v_mfma_f32_16x16x32_bf16 v[52:55], a[172:175], v[244:247], v[52:55]
    v_mul_f32 v24, v24, v88
    v_mul_f32 v25, v25, v89
    v_mfma_f32_16x16x32_bf16 v[52:55], a[176:179], v[252:255], v[52:55]
    s_waitcnt lgkmcnt(0)
    s_barrier
    v_mul_f32 v26, v26, v90
    v_mfma_f32_16x16x32_bf16 v[64:67], a[180:183], v[216:219], v[64:67]
    ds_read_b128 a[160:163], v1 offset:57344
    ds_read_b128 a[164:167], v1 offset:58368
    v_mfma_f32_16x16x32_bf16 v[64:67], a[184:187], v[224:227], v[64:67]
    ds_read_b128 a[168:171], v1 offset:59392
    ds_read_b128 a[172:175], v1 offset:60416
    v_mfma_f32_16x16x32_bf16 v[64:67], a[188:191], v[232:235], v[64:67]
    s_add_u32 m0, s29, 20480
    ds_read_b128 a[176:179], v1 offset:61440
    v_add_u32 v11, 0x14000, v11
    v_mfma_f32_16x16x32_bf16 v[64:67], a[192:195], v[240:243], v[64:67]
    v_add_u32 v13, m0, v11
    v_mul_f32 v27, v27, v91
    v_mfma_f32_16x16x32_bf16 v[64:67], a[196:199], v[248:251], v[64:67]
    buffer_load_dwordx4 v13, s[4:7], 0 offen offset:0 sc1 lds
    v_mul_f32 v28, v28, v92
    v_mfma_f32_16x16x32_bf16 v[68:71], a[180:183], v[220:223], v[68:71]
    v_exp_f32_e64 v88, -v40
    v_mfma_f32_16x16x32_bf16 v[68:71], a[184:187], v[228:231], v[68:71]
    buffer_load_dwordx4 v13, s[4:7], 0 offen offset:1024 sc1 lds
    v_mul_f32 v29, v29, v93
    v_mfma_f32_16x16x32_bf16 v[68:71], a[188:191], v[236:239], v[68:71]
    v_exp_f32_e64 v89, -v41
    v_mfma_f32_16x16x32_bf16 v[68:71], a[192:195], v[244:247], v[68:71]
    v_exp_f32_e64 v90, -v42
    v_mfma_f32_16x16x32_bf16 v[68:71], a[196:199], v[252:255], v[68:71]
    s_waitcnt lgkmcnt(0)
    v_exp_f32_e64 v91, -v43
    v_mfma_f32_16x16x32_bf16 v[72:75], a[160:163], v[96:99], 0
    ds_read_b128 a[180:183], v2 offset:2048
    ds_read_b128 a[184:187], v2 offset:3072
    v_mfma_f32_16x16x32_bf16 v[72:75], a[164:167], v[104:107], v[72:75]
    ds_read_b128 a[188:191], v2 offset:4096
    buffer_load_dwordx4 v13, s[4:7], 0 offen offset:2048 sc1 lds
    v_mfma_f32_16x16x32_bf16 v[72:75], a[168:171], v[112:115], v[72:75]
    ds_read_b128 a[192:195], v2 offset:5120
    ds_read_b128 a[196:199], v2 offset:6144
    v_mfma_f32_16x16x32_bf16 v[72:75], a[172:175], v[120:123], v[72:75]
    v_exp_f32_e64 v92, -v44
    v_mfma_f32_16x16x32_bf16 v[72:75], a[176:179], v[128:131], v[72:75]
    v_exp_f32_e64 v93, -v45
    v_mfma_f32_16x16x32_bf16 v[76:79], a[160:163], v[100:103], 0
    buffer_load_dwordx4 v13, s[4:7], 0 offen offset:3072 sc1 lds
    v_fma_f32 v88, v88, s31, s31
    v_mfma_f32_16x16x32_bf16 v[76:79], a[164:167], v[108:111], v[76:79]
    v_rcp_f32 v88, v88
    v_mfma_f32_16x16x32_bf16 v[76:79], a[168:171], v[116:119], v[76:79]
    v_mul_f32 v30, v30, v94
    v_mul_f32 v31, v31, v95
    v_mfma_f32_16x16x32_bf16 v[76:79], a[172:175], v[124:127], v[76:79]
    v_exp_f32_e64 v94, -v46
    v_mfma_f32_16x16x32_bf16 v[76:79], a[176:179], v[132:135], v[76:79]
    s_waitcnt lgkmcnt(0)
    v_fma_f32 v89, v89, s31, s31
    v_fma_f32 v90, v90, s31, s31
    v_mfma_f32_16x16x32_bf16 v[72:75], a[180:183], v[136:139], v[72:75]
    s_add_u32 m0, s29, 24576
    ds_read_b128 a[160:163], v2 offset:12288
    ds_read_b128 a[164:167], v2 offset:13312
    v_mfma_f32_16x16x32_bf16 v[72:75], a[184:187], v[144:147], v[72:75]
    ds_read_b128 a[168:171], v2 offset:14336
    ds_read_b128 a[172:175], v2 offset:15360
    v_mfma_f32_16x16x32_bf16 v[72:75], a[188:191], v[152:155], v[72:75]
    ds_read_b128 a[176:179], v2 offset:16384
    v_add_u32 v13, m0, v11
    v_mfma_f32_16x16x32_bf16 v[72:75], a[192:195], v[160:163], v[72:75]
    buffer_load_dwordx4 v13, s[4:7], 0 offen offset:0 sc1 lds
    v_fma_f32 v91, v91, s31, s31
    v_mfma_f32_16x16x32_bf16 v[72:75], a[196:199], v[168:171], v[72:75]
    s_add_u32 m0, s29, 61440
    v_add_u32 v11, 0xffffb000, v11
    v_add_u32 v11, s30, v11
    v_mfma_f32_16x16x32_bf16 v[76:79], a[180:183], v[140:143], v[76:79]
    v_add_u32 v13, m0, v11
    v_fma_f32 v92, v92, s31, s31
    v_mfma_f32_16x16x32_bf16 v[76:79], a[184:187], v[148:151], v[76:79]
    buffer_load_dwordx4 v13, s[4:7], 0 offen offset:0 sc1 lds
    v_fma_f32 v93, v93, s31, s31
    v_mfma_f32_16x16x32_bf16 v[76:79], a[188:191], v[156:159], v[76:79]
    v_exp_f32_e64 v95, -v47
    v_mfma_f32_16x16x32_bf16 v[76:79], a[192:195], v[164:167], v[76:79]
    v_rcp_f32 v89, v89
    v_mfma_f32_16x16x32_bf16 v[76:79], a[196:199], v[172:175], v[76:79]
    s_waitcnt lgkmcnt(0)
    buffer_load_dwordx4 v13, s[4:7], 0 offen offset:1024 sc1 lds
    v_fma_f32 v94, v94, s31, s31
    v_mfma_f32_16x16x32_bf16 v[72:75], a[160:163], v[176:179], v[72:75]
    ds_read_b128 a[180:183], v2 offset:22528
    ds_read_b128 a[184:187], v2 offset:23552
    v_mfma_f32_16x16x32_bf16 v[72:75], a[164:167], v[184:187], v[72:75]
    ds_read_b128 a[188:191], v2 offset:24576
    ds_read_b128 a[192:195], v2 offset:25600
    v_mfma_f32_16x16x32_bf16 v[72:75], a[168:171], v[192:195], v[72:75]
    ds_read_b128 a[196:199], v2 offset:26624
    v_fma_f32 v95, v95, s31, s31
    v_mfma_f32_16x16x32_bf16 v[72:75], a[172:175], v[200:203], v[72:75]
    buffer_load_dwordx4 v13, s[4:7], 0 offen offset:2048 sc1 lds
    v_mul_f32 v40, v40, v88
    v_mfma_f32_16x16x32_bf16 v[72:75], a[176:179], v[208:211], v[72:75]
    v_rcp_f32 v90, v90
    v_mfma_f32_16x16x32_bf16 v[76:79], a[160:163], v[180:183], v[76:79]
    v_rcp_f32 v91, v91
    v_mfma_f32_16x16x32_bf16 v[76:79], a[164:167], v[188:191], v[76:79]
    v_mul_f32 v41, v41, v89
    v_mul_f32 v42, v42, v90
    v_mfma_f32_16x16x32_bf16 v[76:79], a[168:171], v[196:199], v[76:79]
    v_rcp_f32 v92, v92
    v_mfma_f32_16x16x32_bf16 v[76:79], a[172:175], v[204:207], v[76:79]
    buffer_load_dwordx4 v13, s[4:7], 0 offen offset:3072 sc1 lds
    v_mul_f32 v32, v32, v24
    v_mfma_f32_16x16x32_bf16 v[76:79], a[176:179], v[212:215], v[76:79]
    s_waitcnt lgkmcnt(0)
    v_mul_f32 v33, v33, v25
    v_mul_f32 v43, v43, v91
    v_mfma_f32_16x16x32_bf16 v[72:75], a[180:183], v[216:219], v[72:75]
    ds_read_b128 a[160:163], v1 offset:62464
    ds_read_b128 a[164:167], v1 offset:63488
    v_mfma_f32_16x16x32_bf16 v[72:75], a[184:187], v[224:227], v[72:75]
    ds_read_b128 a[168:171], v1 offset:64512
    ds_read_b128 a[172:175], v2 offset:0
    v_mfma_f32_16x16x32_bf16 v[72:75], a[188:191], v[232:235], v[72:75]
    s_add_u32 m0, s29, 65536
    ds_read_b128 a[176:179], v2 offset:1024
    v_cvt_pk_bf16_f32 v16, v32, v33
    v_mfma_f32_16x16x32_bf16 v[72:75], a[192:195], v[240:243], v[72:75]
    v_mul_f32 v34, v34, v26
    v_mul_f32 v35, v35, v27
    v_mfma_f32_16x16x32_bf16 v[72:75], a[196:199], v[248:251], v[72:75]
    v_add_u32 v13, m0, v11
    v_mul_f32 v44, v44, v92
    v_mfma_f32_16x16x32_bf16 v[76:79], a[180:183], v[220:223], v[76:79]
    buffer_load_dwordx4 v13, s[4:7], 0 offen offset:0 sc1 lds
    v_cvt_pk_bf16_f32 v17, v34, v35
    v_mfma_f32_16x16x32_bf16 v[76:79], a[184:187], v[228:231], v[76:79]
    v_rcp_f32 v93, v93
    v_mfma_f32_16x16x32_bf16 v[76:79], a[188:191], v[236:239], v[76:79]
    s_add_u32 m0, s29, 102400
    v_mul_f32 v36, v36, v28
    v_mul_f32 v45, v45, v93
    v_mfma_f32_16x16x32_bf16 v[76:79], a[192:195], v[244:247], v[76:79]
    v_mul_f32 v37, v37, v29
    v_cvt_pk_bf16_f32 v20, v36, v37
    v_mfma_f32_16x16x32_bf16 v[76:79], a[196:199], v[252:255], v[76:79]
    s_waitcnt lgkmcnt(0)
    v_mul_f32 v38, v38, v30
    v_mul_f32 v39, v39, v31
    v_mfma_f32_16x16x32_bf16 v[80:83], a[160:163], v[96:99], 0
    ds_read_b128 a[180:183], v2 offset:7168
    ds_read_b128 a[184:187], v2 offset:8192
    v_mfma_f32_16x16x32_bf16 v[80:83], a[164:167], v[104:107], v[80:83]
    ds_read_b128 a[188:191], v2 offset:9216
    ds_read_b128 a[192:195], v2 offset:10240
    v_mfma_f32_16x16x32_bf16 v[80:83], a[168:171], v[112:115], v[80:83]
    ds_read_b128 a[196:199], v2 offset:11264
    v_cvt_pk_bf16_f32 v21, v38, v39
    v_mfma_f32_16x16x32_bf16 v[80:83], a[172:175], v[120:123], v[80:83]
    v_rcp_f32 v94, v94
    v_mfma_f32_16x16x32_bf16 v[80:83], a[176:179], v[128:131], v[80:83]
    v_mul_f32 v46, v46, v94
    v_add_u32 v11, 0xffffb000, v11
    v_mfma_f32_16x16x32_bf16 v[84:87], a[160:163], v[100:103], 0
    v_add_u32 v13, m0, v11
    v_mul_f32 v48, v48, v40
    v_mfma_f32_16x16x32_bf16 v[84:87], a[164:167], v[108:111], v[84:87]
    buffer_load_dwordx4 v13, s[4:7], 0 offen offset:0 sc1 lds
    buffer_load_dwordx4 v13, s[4:7], 0 offen offset:1024 sc1 lds
    v_rcp_f32 v95, v95
    s_nop 0
    v_mul_f32 v47, v47, v95
    v_mfma_f32_16x16x32_bf16 v[84:87], a[168:171], v[116:119], v[84:87]
    v_mul_f32 v49, v49, v41
    v_cvt_pk_bf16_f32 v18, v48, v49
    v_mfma_f32_16x16x32_bf16 v[84:87], a[172:175], v[124:127], v[84:87]
    v_mul_f32 v50, v50, v42
    v_mul_f32 v51, v51, v43
    v_mfma_f32_16x16x32_bf16 v[84:87], a[176:179], v[132:135], v[84:87]
    s_waitcnt lgkmcnt(0)
    v_cvt_pk_bf16_f32 v19, v50, v51
    v_mul_f32 v52, v52, v44
    v_mfma_f32_16x16x32_bf16 v[80:83], a[180:183], v[136:139], v[80:83]
    buffer_store_dwordx4 v[16:19], v14, s[4:7], s27 offen offset:0 sc1
    v_mfma_f32_16x16x32_bf16 v[80:83], a[184:187], v[144:147], v[80:83]
    ds_read_b128 a[160:163], v2 offset:17408
    ds_read_b128 a[164:167], v2 offset:18432
    v_mfma_f32_16x16x32_bf16 v[80:83], a[188:191], v[152:155], v[80:83]
    ds_read_b128 a[168:171], v2 offset:19456
    ds_read_b128 a[172:175], v2 offset:20480
    v_mfma_f32_16x16x32_bf16 v[80:83], a[192:195], v[160:163], v[80:83]
    ds_read_b128 a[176:179], v2 offset:21504
    v_mul_f32 v53, v53, v45
    v_mfma_f32_16x16x32_bf16 v[80:83], a[196:199], v[168:171], v[80:83]
    v_cvt_pk_bf16_f32 v22, v52, v53
    v_mul_f32 v54, v54, v46
    v_mul_f32 v55, v55, v47
    v_cvt_pk_bf16_f32 v23, v54, v55
    v_mfma_f32_16x16x32_bf16 v[84:87], a[180:183], v[140:143], v[84:87]
    buffer_store_dwordx4 v[20:23], v14, s[4:7], s27 offen offset:1024 sc1
    v_mfma_f32_16x16x32_bf16 v[84:87], a[184:187], v[148:151], v[84:87]
    s_add_u32 s27, s27, 8192
    v_exp_f32_e64 v88, -v56
    v_mfma_f32_16x16x32_bf16 v[84:87], a[188:191], v[156:159], v[84:87]
    buffer_load_dwordx4 v13, s[4:7], 0 offen offset:2048 sc1 lds
    buffer_load_dwordx4 v13, s[4:7], 0 offen offset:3072 sc1 lds
    v_mfma_f32_16x16x32_bf16 v[84:87], a[192:195], v[164:167], v[84:87]
    v_exp_f32_e64 v89, -v57
    v_mfma_f32_16x16x32_bf16 v[84:87], a[196:199], v[172:175], v[84:87]
    s_waitcnt lgkmcnt(0)
    v_exp_f32_e64 v90, -v58
    v_mfma_f32_16x16x32_bf16 v[80:83], a[160:163], v[176:179], v[80:83]
    ds_read_b128 a[180:183], v2 offset:27648
    ds_read_b128 a[184:187], v2 offset:28672
    v_mfma_f32_16x16x32_bf16 v[80:83], a[164:167], v[184:187], v[80:83]
    ds_read_b128 a[188:191], v2 offset:29696
    ds_read_b128 a[192:195], v2 offset:30720
    v_mfma_f32_16x16x32_bf16 v[80:83], a[168:171], v[192:195], v[80:83]
    ds_read_b128 a[196:199], v2 offset:31744
    v_fma_f32 v88, v88, s31, s31
    v_mfma_f32_16x16x32_bf16 v[80:83], a[172:175], v[200:203], v[80:83]
    s_add_u32 m0, s29, 106496
    v_add_u32 v13, m0, v11
    v_fma_f32 v89, v89, s31, s31
    v_mfma_f32_16x16x32_bf16 v[80:83], a[176:179], v[208:211], v[80:83]
    buffer_load_dwordx4 v13, s[4:7], 0 offen offset:0 sc1 lds
    v_fma_f32 v90, v90, s31, s31
    v_mfma_f32_16x16x32_bf16 v[84:87], a[160:163], v[180:183], v[84:87]
    v_exp_f32_e64 v91, -v59
    v_mfma_f32_16x16x32_bf16 v[84:87], a[164:167], v[188:191], v[84:87]
    v_exp_f32_e64 v92, -v60
    v_mfma_f32_16x16x32_bf16 v[84:87], a[168:171], v[196:199], v[84:87]
    v_exp_f32_e64 v93, -v61
    v_mfma_f32_16x16x32_bf16 v[84:87], a[172:175], v[204:207], v[84:87]
    v_exp_f32_e64 v94, -v62
    v_mfma_f32_16x16x32_bf16 v[84:87], a[176:179], v[212:215], v[84:87]
    s_waitcnt vmcnt(34) lgkmcnt(0)
    s_barrier
    buffer_load_dwordx4 a[124:127], v15, s[4:7], 0 offen offset:3072 sc1
    v_mfma_f32_16x16x32_bf16 v[80:83], a[180:183], v[216:219], v[80:83]
    ds_read_b128 a[160:163], v14 offset:0
    ds_read_b128 a[164:167], v14 offset:1024
    v_mfma_f32_16x16x32_bf16 v[80:83], a[184:187], v[224:227], v[80:83]
    ds_read_b128 a[168:171], v14 offset:2048
    ds_read_b128 a[172:175], v14 offset:3072
    v_mfma_f32_16x16x32_bf16 v[80:83], a[188:191], v[232:235], v[80:83]
    ds_read_b128 a[176:179], v14 offset:4096
    v_fma_f32 v91, v91, s31, s31
    v_mfma_f32_16x16x32_bf16 v[80:83], a[192:195], v[240:243], v[80:83]
    v_fma_f32 v92, v92, s31, s31
    v_fma_f32 v93, v93, s31, s31
    v_mfma_f32_16x16x32_bf16 v[80:83], a[196:199], v[248:251], v[80:83]
    v_exp_f32_e64 v95, -v63
    v_mfma_f32_16x16x32_bf16 v[84:87], a[180:183], v[220:223], v[84:87]
    v_add_u32 v15, 4096, v15
    v_fma_f32 v94, v94, s31, s31
    v_mfma_f32_16x16x32_bf16 v[84:87], a[184:187], v[228:231], v[84:87]
    buffer_load_dwordx4 a[128:131], v15, s[4:7], 0 offen offset:0 sc1
    v_fma_f32 v95, v95, s31, s31
    v_mfma_f32_16x16x32_bf16 v[84:87], a[188:191], v[236:239], v[84:87]
    v_rcp_f32 v88, v88
    v_mfma_f32_16x16x32_bf16 v[84:87], a[192:195], v[244:247], v[84:87]
    v_rcp_f32 v89, v89
    v_mfma_f32_16x16x32_bf16 v[84:87], a[196:199], v[252:255], v[84:87]
    s_waitcnt lgkmcnt(0)
    v_rcp_f32 v90, v90
    v_mfma_f32_16x16x32_bf16 v[24:27], a[160:163], v[96:99], 0
    ds_read_b128 a[180:183], v14 offset:10240
    ds_read_b128 a[184:187], v14 offset:11264
    v_mfma_f32_16x16x32_bf16 v[24:27], a[164:167], v[104:107], v[24:27]
    ds_read_b128 a[188:191], v14 offset:12288
    buffer_load_dwordx4 a[132:135], v15, s[4:7], 0 offen offset:1024 sc1
    v_mfma_f32_16x16x32_bf16 v[24:27], a[168:171], v[112:115], v[24:27]
    ds_read_b128 a[192:195], v14 offset:13312
    ds_read_b128 a[196:199], v14 offset:14336
    v_mfma_f32_16x16x32_bf16 v[24:27], a[172:175], v[120:123], v[24:27]
    v_mul_f32 v56, v56, v88
    v_mul_f32 v57, v57, v89
    v_mfma_f32_16x16x32_bf16 v[24:27], a[176:179], v[128:131], v[24:27]
    v_mul_f32 v58, v58, v90
    v_mul_f32 v64, v64, v56
    v_mfma_f32_16x16x32_bf16 v[28:31], a[160:163], v[100:103], 0
    v_rcp_f32 v91, v91
    v_mfma_f32_16x16x32_bf16 v[28:31], a[164:167], v[108:111], v[28:31]
    v_mul_f32 v59, v59, v91
    v_mul_f32 v65, v65, v57
    v_mfma_f32_16x16x32_bf16 v[28:31], a[168:171], v[116:119], v[28:31]
    buffer_load_dwordx4 a[136:139], v15, s[4:7], 0 offen offset:2048 sc1
    v_cvt_pk_bf16_f32 v16, v64, v65
    v_mfma_f32_16x16x32_bf16 v[28:31], a[172:175], v[124:127], v[28:31]
    v_rcp_f32 v92, v92
    v_mfma_f32_16x16x32_bf16 v[28:31], a[176:179], v[132:135], v[28:31]
    s_waitcnt lgkmcnt(0)
    v_mul_f32 v60, v60, v92
    v_mul_f32 v66, v66, v58
    v_mfma_f32_16x16x32_bf16 v[24:27], a[180:183], v[136:139], v[24:27]
    ds_read_b128 a[160:163], v14 offset:40960
    ds_read_b128 a[164:167], v14 offset:41984
    v_mfma_f32_16x16x32_bf16 v[24:27], a[184:187], v[144:147], v[24:27]
    ds_read_b128 a[168:171], v14 offset:43008
    ds_read_b128 a[172:175], v14 offset:44032
    v_mfma_f32_16x16x32_bf16 v[24:27], a[188:191], v[152:155], v[24:27]
    ds_read_b128 a[176:179], v14 offset:45056
    v_mul_f32 v67, v67, v59
    v_mfma_f32_16x16x32_bf16 v[24:27], a[192:195], v[160:163], v[24:27]
    buffer_load_dwordx4 a[140:143], v15, s[4:7], 0 offen offset:3072 sc1
    v_cvt_pk_bf16_f32 v17, v66, v67
    v_mfma_f32_16x16x32_bf16 v[24:27], a[196:199], v[168:171], v[24:27]
    v_rcp_f32 v93, v93
    v_mfma_f32_16x16x32_bf16 v[28:31], a[180:183], v[140:143], v[28:31]
    v_mul_f32 v61, v61, v93
    v_mul_f32 v68, v68, v60
    v_mfma_f32_16x16x32_bf16 v[28:31], a[184:187], v[148:151], v[28:31]
    v_rcp_f32 v94, v94
    v_mfma_f32_16x16x32_bf16 v[28:31], a[188:191], v[156:159], v[28:31]
    v_mul_f32 v62, v62, v94
    v_mul_f32 v69, v69, v61
    v_mfma_f32_16x16x32_bf16 v[28:31], a[192:195], v[164:167], v[28:31]
    v_rcp_f32 v95, v95
    v_mfma_f32_16x16x32_bf16 v[28:31], a[196:199], v[172:175], v[28:31]
    s_waitcnt lgkmcnt(0)
    v_mul_f32 v63, v63, v95
    v_add_u32 v15, 4096, v15
    v_mfma_f32_16x16x32_bf16 v[24:27], a[160:163], v[176:179], v[24:27]
    buffer_load_dwordx4 a[144:147], v15, s[4:7], 0 offen offset:0 sc1
    ds_read_b128 a[180:183], v14 offset:51200
    v_mfma_f32_16x16x32_bf16 v[24:27], a[164:167], v[184:187], v[24:27]
    ds_read_b128 a[184:187], v14 offset:52224
    ds_read_b128 a[188:191], v14 offset:53248
    v_mfma_f32_16x16x32_bf16 v[24:27], a[168:171], v[192:195], v[24:27]
    ds_read_b128 a[192:195], v14 offset:54272
    ds_read_b128 a[196:199], v14 offset:55296
    v_mfma_f32_16x16x32_bf16 v[24:27], a[172:175], v[200:203], v[24:27]
    v_exp_f32_e64 v88, -v72
    v_mfma_f32_16x16x32_bf16 v[24:27], a[176:179], v[208:211], v[24:27]
    v_fma_f32 v88, v88, s31, s31
    v_mov_b32 v6, 0x1
    v_mfma_f32_16x16x32_bf16 v[28:31], a[160:163], v[180:183], v[28:31]
    s_waitcnt vmcnt(9)
    buffer_atomic_add v6, v12, s[4:7], s46 offen offset:0 sc1
    v_mfma_f32_16x16x32_bf16 v[28:31], a[164:167], v[188:191], v[28:31]
    buffer_load_dwordx4 a[148:151], v15, s[4:7], 0 offen offset:1024 sc1
    v_cvt_pk_bf16_f32 v20, v68, v69
    v_mfma_f32_16x16x32_bf16 v[28:31], a[168:171], v[196:199], v[28:31]
    v_exp_f32_e64 v89, -v73
    v_mfma_f32_16x16x32_bf16 v[28:31], a[172:175], v[204:207], v[28:31]
    v_fma_f32 v89, v89, s31, s31
    v_mul_f32 v70, v70, v62
    v_mfma_f32_16x16x32_bf16 v[28:31], a[176:179], v[212:215], v[28:31]
    s_waitcnt lgkmcnt(0)
    v_exp_f32_e64 v90, -v74
    v_mfma_f32_16x16x32_bf16 v[24:27], a[180:183], v[216:219], v[24:27]
    ds_read_b128 a[160:163], v14 offset:5120
    ds_read_b128 a[164:167], v14 offset:6144
    v_mfma_f32_16x16x32_bf16 v[24:27], a[184:187], v[224:227], v[24:27]
    buffer_load_dwordx4 a[152:155], v15, s[4:7], 0 offen offset:2048 sc1
    ds_read_b128 a[168:171], v14 offset:7168
    v_mfma_f32_16x16x32_bf16 v[24:27], a[188:191], v[232:235], v[24:27]
    ds_read_b128 a[172:175], v14 offset:8192
    ds_read_b128 a[176:179], v14 offset:9216
    v_mfma_f32_16x16x32_bf16 v[24:27], a[192:195], v[240:243], v[24:27]
    v_fma_f32 v90, v90, s31, s31
    v_mul_f32 v71, v71, v63
    v_mfma_f32_16x16x32_bf16 v[24:27], a[196:199], v[248:251], v[24:27]
    v_exp_f32_e64 v91, -v75
    v_mfma_f32_16x16x32_bf16 v[28:31], a[180:183], v[220:223], v[28:31]
    v_fma_f32 v91, v91, s31, s31
    v_cvt_pk_bf16_f32 v21, v70, v71
    v_mfma_f32_16x16x32_bf16 v[28:31], a[184:187], v[228:231], v[28:31]
    v_exp_f32_e64 v92, -v76
    v_mfma_f32_16x16x32_bf16 v[28:31], a[188:191], v[236:239], v[28:31]
    buffer_load_dwordx4 a[156:159], v15, s[4:7], 0 offen offset:3072 sc1
    v_fma_f32 v92, v92, s31, s31
    v_mfma_f32_16x16x32_bf16 v[28:31], a[192:195], v[244:247], v[28:31]
    v_exp_f32_e64 v93, -v77
    v_mfma_f32_16x16x32_bf16 v[28:31], a[196:199], v[252:255], v[28:31]
    s_waitcnt lgkmcnt(0)
    v_exp_f32_e64 v94, -v78
    v_mfma_f32_16x16x32_bf16 v[32:35], a[160:163], v[96:99], 0
    ds_read_b128 a[180:183], v14 offset:15360
    ds_read_b128 a[184:187], v14 offset:16384
    v_mfma_f32_16x16x32_bf16 v[32:35], a[164:167], v[104:107], v[32:35]
    ds_read_b128 a[188:191], v14 offset:17408
    ds_read_b128 a[192:195], v14 offset:18432
    v_mfma_f32_16x16x32_bf16 v[32:35], a[168:171], v[112:115], v[32:35]
    ds_read_b128 a[196:199], v14 offset:19456
    v_fma_f32 v93, v93, s31, s31
    v_mfma_f32_16x16x32_bf16 v[32:35], a[172:175], v[120:123], v[32:35]
    v_fma_f32 v94, v94, s31, s31
    v_add_u32 v15, 4096, v15
    v_mfma_f32_16x16x32_bf16 v[32:35], a[176:179], v[128:131], v[32:35]
    v_exp_f32_e64 v95, -v79
    v_mfma_f32_16x16x32_bf16 v[36:39], a[160:163], v[100:103], 0
    buffer_load_dwordx4 a[200:203], v15, s[4:7], 0 offen offset:0 sc1
    v_fma_f32 v95, v95, s31, s31
    v_mfma_f32_16x16x32_bf16 v[36:39], a[164:167], v[108:111], v[36:39]
    v_rcp_f32 v88, v88
    v_mfma_f32_16x16x32_bf16 v[36:39], a[168:171], v[116:119], v[36:39]
    v_mul_f32 v72, v72, v88
    v_mul_f32 v80, v80, v72
    v_mfma_f32_16x16x32_bf16 v[36:39], a[172:175], v[124:127], v[36:39]
    v_rcp_f32 v89, v89
    v_mfma_f32_16x16x32_bf16 v[36:39], a[176:179], v[132:135], v[36:39]
    s_waitcnt lgkmcnt(0)
    buffer_load_dwordx4 a[204:207], v15, s[4:7], 0 offen offset:1024 sc1
    v_mul_f32 v73, v73, v89
    v_mfma_f32_16x16x32_bf16 v[32:35], a[180:183], v[136:139], v[32:35]
    ds_read_b128 a[160:163], v14 offset:46080
    ds_read_b128 a[164:167], v14 offset:47104
    v_mfma_f32_16x16x32_bf16 v[32:35], a[184:187], v[144:147], v[32:35]
    ds_read_b128 a[168:171], v14 offset:48128
    ds_read_b128 a[172:175], v14 offset:49152
    v_mfma_f32_16x16x32_bf16 v[32:35], a[188:191], v[152:155], v[32:35]
    ds_read_b128 a[176:179], v14 offset:50176
    v_mul_f32 v81, v81, v73
    v_mfma_f32_16x16x32_bf16 v[32:35], a[192:195], v[160:163], v[32:35]
    v_rcp_f32 v90, v90
    v_mfma_f32_16x16x32_bf16 v[32:35], a[196:199], v[168:171], v[32:35]
    v_mul_f32 v74, v74, v90
    v_cvt_pk_bf16_f32 v18, v80, v81
    v_mfma_f32_16x16x32_bf16 v[36:39], a[180:183], v[140:143], v[36:39]
    v_rcp_f32 v91, v91
    v_mfma_f32_16x16x32_bf16 v[36:39], a[184:187], v[148:151], v[36:39]
    v_mul_f32 v75, v75, v91
    v_mul_f32 v82, v82, v74
    v_mfma_f32_16x16x32_bf16 v[36:39], a[188:191], v[156:159], v[36:39]
    v_rcp_f32 v92, v92
    v_mfma_f32_16x16x32_bf16 v[36:39], a[192:195], v[164:167], v[36:39]
    v_mul_f32 v76, v76, v92
    v_mul_f32 v83, v83, v75
    v_mfma_f32_16x16x32_bf16 v[36:39], a[196:199], v[172:175], v[36:39]
    s_waitcnt lgkmcnt(0)
    v_rcp_f32 v93, v93
    v_mfma_f32_16x16x32_bf16 v[32:35], a[160:163], v[176:179], v[32:35]
    s_mul_i32 s43, s16, 7680
    ds_read_b128 a[180:183], v14 offset:56320
    ds_read_b128 a[184:187], v14 offset:57344
    v_mul_f32 v77, v77, v93
    v_rcp_f32 v94, v94
    s_nop 0
    v_mul_f32 v78, v78, v94
    v_rcp_f32 v95, v95
    s_nop 0
    v_mul_f32 v79, v79, v95
    v_mfma_f32_16x16x32_bf16 v[32:35], a[164:167], v[184:187], v[32:35]
    s_mul_i32 s3, s20, 276480
    ds_read_b128 a[188:191], v14 offset:58368
    ds_read_b128 a[192:195], v14 offset:59392
    v_mfma_f32_16x16x32_bf16 v[32:35], a[168:171], v[192:195], v[32:35]
    s_add_u32 s3, s3, 0x45e000
    ds_read_b128 a[196:199], v14 offset:60416
    v_cvt_pk_bf16_f32 v19, v82, v83
    v_mfma_f32_16x16x32_bf16 v[32:35], a[172:175], v[200:203], v[32:35]
    buffer_store_dwordx4 v[16:19], v14, s[4:7], s27 offen offset:0 sc1
    v_mfma_f32_16x16x32_bf16 v[32:35], a[176:179], v[208:211], v[32:35]
    s_add_u32 m0, s43, 122880
    v_mul_f32 v84, v84, v76
    v_mul_f32 v85, v85, v77
    v_mfma_f32_16x16x32_bf16 v[36:39], a[160:163], v[180:183], v[36:39]
    v_cvt_pk_bf16_f32 v22, v84, v85
    v_mul_f32 v86, v86, v78
    v_mfma_f32_16x16x32_bf16 v[36:39], a[164:167], v[188:191], v[36:39]
    v_mul_f32 v87, v87, v79
    v_cvt_pk_bf16_f32 v23, v86, v87
    v_mfma_f32_16x16x32_bf16 v[36:39], a[168:171], v[196:199], v[36:39]
    buffer_store_dwordx4 v[20:23], v14, s[4:7], s27 offen offset:1024 sc1
    v_mfma_f32_16x16x32_bf16 v[36:39], a[172:175], v[204:207], v[36:39]
    s_add_u32 s27, s27, 8192
    v_add_u32 v9, s3, v14
    v_add_u32 v13, m0, v9
    v_mfma_f32_16x16x32_bf16 v[36:39], a[176:179], v[212:215], v[36:39]
    s_waitcnt vmcnt(14) lgkmcnt(0)
    s_barrier
    buffer_load_dwordx4 v13, s[4:7], 0 offen offset:0 sc1 lds
    v_mfma_f32_16x16x32_bf16 v[32:35], a[180:183], v[216:219], v[32:35]
    ds_read_b128 a[160:163], v1 offset:16384
    ds_read_b128 a[164:167], v1 offset:17408
    v_mfma_f32_16x16x32_bf16 v[32:35], a[184:187], v[224:227], v[32:35]
    ds_read_b128 a[168:171], v1 offset:18432
    ds_read_b128 a[172:175], v1 offset:19456
    v_mfma_f32_16x16x32_bf16 v[32:35], a[188:191], v[232:235], v[32:35]
    ds_read_b128 a[176:179], v1 offset:20480
    v_mov_b32 v5, 0
    v_mfma_f32_16x16x32_bf16 v[32:35], a[192:195], v[240:243], v[32:35]
    buffer_atomic_add v5, v12, s[4:7], s47 offen sc0 sc1
    v_mfma_f32_16x16x32_bf16 v[32:35], a[196:199], v[248:251], v[32:35]
    buffer_load_dwordx4 v13, s[4:7], 0 offen offset:1024 sc1 lds
    buffer_load_dwordx4 v13, s[4:7], 0 offen offset:2048 sc1 lds
    v_mfma_f32_16x16x32_bf16 v[36:39], a[180:183], v[220:223], v[36:39]
    v_exp_f32_e64 v88, -v24
    v_mfma_f32_16x16x32_bf16 v[36:39], a[184:187], v[228:231], v[36:39]
    buffer_load_dwordx4 v13, s[4:7], 0 offen offset:3072 sc1 lds
    v_fma_f32 v88, v88, s31, s31
    v_mfma_f32_16x16x32_bf16 v[36:39], a[188:191], v[236:239], v[36:39]
    v_exp_f32_e64 v89, -v25
    v_mfma_f32_16x16x32_bf16 v[36:39], a[192:195], v[244:247], v[36:39]
    v_exp_f32_e64 v90, -v26
    v_mfma_f32_16x16x32_bf16 v[36:39], a[196:199], v[252:255], v[36:39]
    s_waitcnt lgkmcnt(0)
    v_fma_f32 v89, v89, s31, s31
    v_fma_f32 v90, v90, s31, s31
    v_mfma_f32_16x16x32_bf16 v[40:43], a[160:163], v[96:99], 0
    s_add_u32 m0, s43, 126976
    ds_read_b128 a[180:183], v1 offset:26624
    ds_read_b128 a[184:187], v1 offset:27648
    v_mfma_f32_16x16x32_bf16 v[40:43], a[164:167], v[104:107], v[40:43]
    ds_read_b128 a[188:191], v1 offset:28672
    ds_read_b128 a[192:195], v1 offset:29696
    v_mfma_f32_16x16x32_bf16 v[40:43], a[168:171], v[112:115], v[40:43]
    ds_read_b128 a[196:199], v1 offset:30720
    v_add_u32 v13, m0, v9
    v_mfma_f32_16x16x32_bf16 v[40:43], a[172:175], v[120:123], v[40:43]
    buffer_load_dwordx4 v13, s[4:7], 0 offen offset:0 sc1 lds
    v_mfma_f32_16x16x32_bf16 v[40:43], a[176:179], v[128:131], v[40:43]
    v_exp_f32_e64 v91, -v27
    v_mfma_f32_16x16x32_bf16 v[44:47], a[160:163], v[100:103], 0
    buffer_load_dwordx4 v13, s[4:7], 0 offen offset:1024 sc1 lds
    v_fma_f32 v91, v91, s31, s31
    v_mfma_f32_16x16x32_bf16 v[44:47], a[164:167], v[108:111], v[44:47]
    v_exp_f32_e64 v92, -v28
    v_mfma_f32_16x16x32_bf16 v[44:47], a[168:171], v[116:119], v[44:47]
    v_exp_f32_e64 v93, -v29
    v_mfma_f32_16x16x32_bf16 v[44:47], a[172:175], v[124:127], v[44:47]
    buffer_load_dwordx4 v13, s[4:7], 0 offen offset:2048 sc1 lds
    v_fma_f32 v92, v92, s31, s31
    v_mfma_f32_16x16x32_bf16 v[44:47], a[176:179], v[132:135], v[44:47]
    s_waitcnt lgkmcnt(0)
    v_exp_f32_e64 v94, -v30
    v_mfma_f32_16x16x32_bf16 v[40:43], a[180:183], v[136:139], v[40:43]
    ds_read_b128 a[160:163], v14 offset:20480
    ds_read_b128 a[164:167], v14 offset:21504
    v_mfma_f32_16x16x32_bf16 v[40:43], a[184:187], v[144:147], v[40:43]
    ds_read_b128 a[168:171], v14 offset:22528
    ds_read_b128 a[172:175], v14 offset:23552
    v_mfma_f32_16x16x32_bf16 v[40:43], a[188:191], v[152:155], v[40:43]
    s_branch .Lps3115
hop1_3:
.Lpd3115:
    s_branch hop1_ret
.Lps3115:
    ds_read_b128 a[176:179], v14 offset:24576
    v_fma_f32 v93, v93, s31, s31
    v_mfma_f32_16x16x32_bf16 v[40:43], a[192:195], v[160:163], v[40:43]
    buffer_load_dwordx4 v13, s[4:7], 0 offen offset:3072 sc1 lds
    v_fma_f32 v94, v94, s31, s31
    v_mfma_f32_16x16x32_bf16 v[40:43], a[196:199], v[168:171], v[40:43]
    v_exp_f32_e64 v95, -v31
    v_mfma_f32_16x16x32_bf16 v[44:47], a[180:183], v[140:143], v[44:47]
    v_rcp_f32 v88, v88
    v_mfma_f32_16x16x32_bf16 v[44:47], a[184:187], v[148:151], v[44:47]
    v_fma_f32 v95, v95, s31, s31
    v_mul_f32 v24, v24, v88
    v_mfma_f32_16x16x32_bf16 v[44:47], a[188:191], v[156:159], v[44:47]
    v_rcp_f32 v89, v89
    v_mfma_f32_16x16x32_bf16 v[44:47], a[192:195], v[164:167], v[44:47]
    buffer_load_dwordx4 a[208:211], v15, s[4:7], 0 offen offset:2048 sc1
    v_mul_f32 v25, v25, v89
    v_mfma_f32_16x16x32_bf16 v[44:47], a[196:199], v[172:175], v[44:47]
    s_waitcnt lgkmcnt(0)
    v_rcp_f32 v90, v90
    v_mfma_f32_16x16x32_bf16 v[40:43], a[160:163], v[176:179], v[40:43]
    ds_read_b128 a[180:183], v14 offset:30720
    ds_read_b128 a[184:187], v14 offset:31744
    v_mfma_f32_16x16x32_bf16 v[40:43], a[164:167], v[184:187], v[40:43]
    ds_read_b128 a[188:191], v14 offset:32768
    ds_read_b128 a[192:195], v14 offset:33792
    v_mfma_f32_16x16x32_bf16 v[40:43], a[168:171], v[192:195], v[40:43]
    ds_read_b128 a[196:199], v14 offset:34816
    v_mul_f32 v26, v26, v90
    v_mfma_f32_16x16x32_bf16 v[40:43], a[172:175], v[200:203], v[40:43]
    buffer_load_dwordx4 a[212:215], v15, s[4:7], 0 offen offset:3072 sc1
    v_mul_f32 v32, v32, v24
    v_mfma_f32_16x16x32_bf16 v[40:43], a[176:179], v[208:211], v[40:43]
    v_rcp_f32 v91, v91
    v_mfma_f32_16x16x32_bf16 v[44:47], a[160:163], v[180:183], v[44:47]
    v_mul_f32 v27, v27, v91
    v_mul_f32 v33, v33, v25
    v_mfma_f32_16x16x32_bf16 v[44:47], a[164:167], v[188:191], v[44:47]
    v_rcp_f32 v92, v92
    v_mfma_f32_16x16x32_bf16 v[44:47], a[168:171], v[196:199], v[44:47]
    v_mul_f32 v28, v28, v92
    v_cvt_pk_bf16_f32 v16, v32, v33
    v_mfma_f32_16x16x32_bf16 v[44:47], a[172:175], v[204:207], v[44:47]
    v_rcp_f32 v93, v93
    v_mfma_f32_16x16x32_bf16 v[44:47], a[176:179], v[212:215], v[44:47]
    s_waitcnt lgkmcnt(0)
    v_mul_f32 v29, v29, v93
    v_mul_f32 v34, v34, v26
    v_mfma_f32_16x16x32_bf16 v[40:43], a[180:183], v[216:219], v[40:43]
    ds_read_b128 a[160:163], v1 offset:21504
    ds_read_b128 a[164:167], v1 offset:22528
    v_mfma_f32_16x16x32_bf16 v[40:43], a[184:187], v[224:227], v[40:43]
    ds_read_b128 a[168:171], v1 offset:23552
    ds_read_b128 a[172:175], v1 offset:24576
    v_mfma_f32_16x16x32_bf16 v[40:43], a[188:191], v[232:235], v[40:43]
    ds_read_b128 a[176:179], v1 offset:25600
    v_mul_f32 v35, v35, v27
    v_mfma_f32_16x16x32_bf16 v[40:43], a[192:195], v[240:243], v[40:43]
    v_rcp_f32 v94, v94
    v_mfma_f32_16x16x32_bf16 v[40:43], a[196:199], v[248:251], v[40:43]
    v_mul_f32 v30, v30, v94
    v_cvt_pk_bf16_f32 v17, v34, v35
    v_mfma_f32_16x16x32_bf16 v[44:47], a[180:183], v[220:223], v[44:47]
    v_rcp_f32 v95, v95
    v_mfma_f32_16x16x32_bf16 v[44:47], a[184:187], v[228:231], v[44:47]
    s_waitcnt vmcnt(9)
    v_readfirstlane_b32 s48, v5
    v_mul_f32 v31, v31, v95
    v_mfma_f32_16x16x32_bf16 v[44:47], a[188:191], v[236:239], v[44:47]
    s_lshr_b32 s43, s16, 1
    v_mul_f32 v36, v36, v28
    v_mul_f32 v37, v37, v29
    v_mfma_f32_16x16x32_bf16 v[44:47], a[192:195], v[244:247], v[44:47]
    s_mul_i32 s43, s43, 20480
    v_cvt_pk_bf16_f32 v20, v36, v37
    v_mul_f32 v38, v38, v30
    v_mov_b32 v6, 0x100
    buffer_atomic_add v6, v12, s[4:7], s46 offen offset:0 sc1
    v_mfma_f32_16x16x32_bf16 v[44:47], a[196:199], v[252:255], v[44:47]
    s_waitcnt lgkmcnt(0)
    v_mul_f32 v39, v39, v31
    v_cvt_pk_bf16_f32 v21, v38, v39
    v_mfma_f32_16x16x32_bf16 v[48:51], a[160:163], v[96:99], 0
    s_bitcmp1_b32 s48, 3
    s_cbranch_scc0 h00_slow
h00_ok:
    ds_read_b128 a[180:183], v1 offset:31744
    v_mfma_f32_16x16x32_bf16 v[48:51], a[164:167], v[104:107], v[48:51]
    s_mul_i32 s3, s16, 10240
    ds_read_b128 a[184:187], v1 offset:32768
    ds_read_b128 a[188:191], v1 offset:33792
    v_mfma_f32_16x16x32_bf16 v[48:51], a[168:171], v[112:115], v[48:51]
    s_add_u32 s43, s43, s3
    ds_read_b128 a[192:195], v1 offset:34816
    ds_read_b128 a[196:199], v1 offset:35840
    v_mfma_f32_16x16x32_bf16 v[48:51], a[172:175], v[120:123], v[48:51]
    s_min_u32 s3, s39, s40
    v_add_u32 v7, s37, v14
    s_add_u32 s37, s37, 4096
    v_mfma_f32_16x16x32_bf16 v[48:51], a[176:179], v[128:131], v[48:51]
    buffer_load_dwordx4 v[72:75], v7, s[4:7], 0 offen offset:0 sc1
    buffer_load_dwordx4 v[76:79], v7, s[4:7], 0 offen offset:2048 sc1
    v_mfma_f32_16x16x32_bf16 v[52:55], a[160:163], v[100:103], 0
    s_sub_u32 s3, s3, s43
    v_add_u32 v7, s37, v14
    v_add_u32 v9, s3, v14
    v_mfma_f32_16x16x32_bf16 v[52:55], a[164:167], v[108:111], v[52:55]
    s_add_u32 s37, s37, 4096
    v_exp_f32_e64 v88, -v40
    v_mfma_f32_16x16x32_bf16 v[52:55], a[168:171], v[116:119], v[52:55]
    buffer_load_dwordx4 v[80:83], v7, s[4:7], 0 offen offset:0 sc1
    v_fma_f32 v88, v88, s31, s31
    v_mfma_f32_16x16x32_bf16 v[52:55], a[172:175], v[124:127], v[52:55]
    v_exp_f32_e64 v89, -v41
    v_mfma_f32_16x16x32_bf16 v[52:55], a[176:179], v[132:135], v[52:55]
    s_waitcnt lgkmcnt(0)
    buffer_load_dwordx4 v[84:87], v7, s[4:7], 0 offen offset:2048 sc1
    v_fma_f32 v89, v89, s31, s31
    v_mfma_f32_16x16x32_bf16 v[48:51], a[180:183], v[136:139], v[48:51]
    s_sub_u32 s3, s39, s3
    ds_read_b128 a[160:163], v14 offset:25600
    ds_read_b128 a[164:167], v14 offset:26624
    v_mfma_f32_16x16x32_bf16 v[48:51], a[184:187], v[144:147], v[48:51]
    s_add_u32 s39, s39, 8192
    ds_read_b128 a[168:171], v14 offset:27648
    ds_read_b128 a[172:175], v14 offset:28672
    v_mfma_f32_16x16x32_bf16 v[48:51], a[188:191], v[152:155], v[48:51]
    s_add_u32 s40, s40, 8192
    ds_read_b128 a[176:179], v14 offset:29696
    v_add_u32 v7, s38, v14
    v_mfma_f32_16x16x32_bf16 v[48:51], a[192:195], v[160:163], v[48:51]
    s_add_u32 s38, s38, 4096
    v_exp_f32_e64 v90, -v42
    v_mfma_f32_16x16x32_bf16 v[48:51], a[196:199], v[168:171], v[48:51]
    buffer_load_dwordx4 v[24:27], v7, s[4:7], 0 offen offset:0 sc1
    v_add_u32 v10, s3, v14
    v_mfma_f32_16x16x32_bf16 v[52:55], a[180:183], v[140:143], v[52:55]
    buffer_load_dwordx4 v[28:31], v7, s[4:7], 0 offen offset:2048 sc1
    v_fma_f32 v90, v90, s31, s31
    v_mfma_f32_16x16x32_bf16 v[52:55], a[184:187], v[148:151], v[52:55]
    v_exp_f32_e64 v91, -v43
    v_mfma_f32_16x16x32_bf16 v[52:55], a[188:191], v[156:159], v[52:55]
    v_exp_f32_e64 v92, -v44
    v_mfma_f32_16x16x32_bf16 v[52:55], a[192:195], v[164:167], v[52:55]
    v_add_u32 v7, s38, v14
    v_fma_f32 v91, v91, s31, s31
    v_mfma_f32_16x16x32_bf16 v[52:55], a[196:199], v[172:175], v[52:55]
    s_waitcnt lgkmcnt(0)
    buffer_load_dwordx4 v[32:35], v7, s[4:7], 0 offen offset:0 sc1
    v_fma_f32 v92, v92, s31, s31
    v_mfma_f32_16x16x32_bf16 v[48:51], a[160:163], v[176:179], v[48:51]
    s_add_u32 s38, s38, 4096
    ds_read_b128 a[180:183], v14 offset:35840
    ds_read_b128 a[184:187], v14 offset:36864
    v_mfma_f32_16x16x32_bf16 v[48:51], a[164:167], v[184:187], v[48:51]
    ds_read_b128 a[188:191], v14 offset:37888
    ds_read_b128 a[192:195], v14 offset:38912
    v_mfma_f32_16x16x32_bf16 v[48:51], a[168:171], v[192:195], v[48:51]
    buffer_load_dwordx4 v[36:39], v7, s[4:7], 0 offen offset:2048 sc1
    ds_read_b128 a[196:199], v14 offset:39936
    v_mfma_f32_16x16x32_bf16 v[48:51], a[172:175], v[200:203], v[48:51]
    v_exp_f32_e64 v93, -v45
    v_mfma_f32_16x16x32_bf16 v[48:51], a[176:179], v[208:211], v[48:51]
    v_exp_f32_e64 v94, -v46
    v_mfma_f32_16x16x32_bf16 v[52:55], a[160:163], v[180:183], v[52:55]
    s_add_u32 m0, s43, 0
    v_add_u32 v13, m0, v9
    v_fma_f32 v93, v93, s31, s31
    v_mfma_f32_16x16x32_bf16 v[52:55], a[164:167], v[188:191], v[52:55]
    buffer_load_dwordx4 v13, s[4:7], 0 offen offset:0 sc1 lds
    v_fma_f32 v94, v94, s31, s31
    v_mfma_f32_16x16x32_bf16 v[52:55], a[168:171], v[196:199], v[52:55]
    v_exp_f32_e64 v95, -v47
    v_mfma_f32_16x16x32_bf16 v[52:55], a[172:175], v[204:207], v[52:55]
    buffer_load_dwordx4 v13, s[4:7], 0 offen offset:1024 sc1 lds
    v_fma_f32 v95, v95, s31, s31
    v_mfma_f32_16x16x32_bf16 v[52:55], a[176:179], v[212:215], v[52:55]
    s_waitcnt vmcnt(13) lgkmcnt(0)
    s_barrier
    v_mfma_f32_16x16x32_bf16 v[48:51], a[180:183], v[216:219], v[48:51]
    ds_read_b128 a[160:163], v14 offset:61440
    ds_read_b128 a[164:167], v14 offset:62464
    v_mfma_f32_16x16x32_bf16 v[48:51], a[184:187], v[224:227], v[48:51]
    ds_read_b128 a[168:171], v14 offset:63488
    ds_read_b128 a[172:175], v14 offset:64512
    v_mfma_f32_16x16x32_bf16 v[48:51], a[188:191], v[232:235], v[48:51]
    ds_read_b128 a[176:179], v1 offset:0
    v_mov_b32 v5, 0
    v_mfma_f32_16x16x32_bf16 v[48:51], a[192:195], v[240:243], v[48:51]
    buffer_atomic_add v5, v12, s[4:7], s47 offen sc0 sc1
    v_mfma_f32_16x16x32_bf16 v[48:51], a[196:199], v[248:251], v[48:51]
    v_rcp_f32 v88, v88
    v_mfma_f32_16x16x32_bf16 v[52:55], a[180:183], v[220:223], v[52:55]
    buffer_load_dwordx4 v13, s[4:7], 0 offen offset:2048 sc1 lds
    buffer_load_dwordx4 v13, s[4:7], 0 offen offset:3072 sc1 lds
    v_mfma_f32_16x16x32_bf16 v[52:55], a[184:187], v[228:231], v[52:55]
    v_rcp_f32 v89, v89
    v_mfma_f32_16x16x32_bf16 v[52:55], a[188:191], v[236:239], v[52:55]
    v_mul_f32 v40, v40, v88
    v_mul_f32 v41, v41, v89
    v_mfma_f32_16x16x32_bf16 v[52:55], a[192:195], v[244:247], v[52:55]
    s_add_u32 m0, s43, 4096
    v_rcp_f32 v90, v90
    v_mfma_f32_16x16x32_bf16 v[52:55], a[196:199], v[252:255], v[52:55]
    s_waitcnt lgkmcnt(0)
    v_mul_f32 v42, v42, v90
    v_add_u32 v13, m0, v9
    v_mfma_f32_16x16x32_bf16 v[56:59], a[160:163], v[96:99], 0
    buffer_load_dwordx4 v13, s[4:7], 0 offen offset:0 sc1 lds
    ds_read_b128 a[180:183], v1 offset:6144
    v_mfma_f32_16x16x32_bf16 v[56:59], a[164:167], v[104:107], v[56:59]
    ds_read_b128 a[184:187], v1 offset:7168
    ds_read_b128 a[188:191], v1 offset:8192
    v_mfma_f32_16x16x32_bf16 v[56:59], a[168:171], v[112:115], v[56:59]
    ds_read_b128 a[192:195], v1 offset:9216
    buffer_load_dwordx4 v13, s[4:7], 0 offen offset:1024 sc1 lds
    v_mfma_f32_16x16x32_bf16 v[56:59], a[172:175], v[120:123], v[56:59]
    ds_read_b128 a[196:199], v1 offset:10240
    v_mfma_f32_16x16x32_bf16 v[56:59], a[176:179], v[128:131], v[56:59]
    v_rcp_f32 v91, v91
    v_mfma_f32_16x16x32_bf16 v[60:63], a[160:163], v[100:103], 0
    buffer_load_dwordx4 v13, s[4:7], 0 offen offset:2048 sc1 lds
    v_mul_f32 v43, v43, v91
    v_mfma_f32_16x16x32_bf16 v[60:63], a[164:167], v[108:111], v[60:63]
    v_rcp_f32 v92, v92
    v_mfma_f32_16x16x32_bf16 v[60:63], a[168:171], v[116:119], v[60:63]
    v_mul_f32 v44, v44, v92
    v_mul_f32 v48, v48, v40
    v_mfma_f32_16x16x32_bf16 v[60:63], a[172:175], v[124:127], v[60:63]
    buffer_load_dwordx4 v13, s[4:7], 0 offen offset:3072 sc1 lds
    v_mul_f32 v49, v49, v41
    v_mfma_f32_16x16x32_bf16 v[60:63], a[176:179], v[132:135], v[60:63]
    s_waitcnt lgkmcnt(0)
    v_rcp_f32 v93, v93
    v_mfma_f32_16x16x32_bf16 v[56:59], a[180:183], v[136:139], v[56:59]
    ds_read_b128 a[160:163], v1 offset:36864
    ds_read_b128 a[164:167], v1 offset:37888
    v_mfma_f32_16x16x32_bf16 v[56:59], a[184:187], v[144:147], v[56:59]
    ds_read_b128 a[168:171], v1 offset:38912
    ds_read_b128 a[172:175], v1 offset:39936
    v_mfma_f32_16x16x32_bf16 v[56:59], a[188:191], v[152:155], v[56:59]
    ds_read_b128 a[176:179], v1 offset:40960
    v_mul_f32 v45, v45, v93
    v_mfma_f32_16x16x32_bf16 v[56:59], a[192:195], v[160:163], v[56:59]
    v_rcp_f32 v94, v94
    v_mfma_f32_16x16x32_bf16 v[56:59], a[196:199], v[168:171], v[56:59]
    v_mul_f32 v46, v46, v94
    v_cvt_pk_bf16_f32 v18, v48, v49
    v_mfma_f32_16x16x32_bf16 v[60:63], a[180:183], v[140:143], v[60:63]
    v_rcp_f32 v95, v95
    v_mfma_f32_16x16x32_bf16 v[60:63], a[184:187], v[148:151], v[60:63]
    v_mul_f32 v47, v47, v95
    v_mul_f32 v50, v50, v42
    v_mfma_f32_16x16x32_bf16 v[60:63], a[188:191], v[156:159], v[60:63]
    v_mul_f32 v51, v51, v43
    v_cvt_pk_bf16_f32 v19, v50, v51
    v_mfma_f32_16x16x32_bf16 v[60:63], a[192:195], v[164:167], v[60:63]
    buffer_store_dwordx4 v[16:19], v14, s[4:7], s27 offen offset:0 sc1
    v_mfma_f32_16x16x32_bf16 v[60:63], a[196:199], v[172:175], v[60:63]
    s_waitcnt lgkmcnt(0)
    v_mul_f32 v52, v52, v44
    v_mul_f32 v53, v53, v45
    v_mfma_f32_16x16x32_bf16 v[56:59], a[160:163], v[176:179], v[56:59]
    ds_read_b128 a[180:183], v1 offset:47104
    ds_read_b128 a[184:187], v1 offset:48128
    v_mfma_f32_16x16x32_bf16 v[56:59], a[164:167], v[184:187], v[56:59]
    ds_read_b128 a[188:191], v1 offset:49152
    ds_read_b128 a[192:195], v1 offset:50176
    v_cvt_pk_bf16_f32 v22, v52, v53
    v_mul_f32 v54, v54, v46
    v_mul_f32 v55, v55, v47
    v_cvt_pk_bf16_f32 v23, v54, v55
    v_mfma_f32_16x16x32_bf16 v[56:59], a[168:171], v[192:195], v[56:59]
    buffer_store_dwordx4 v[20:23], v14, s[4:7], s27 offen offset:1024 sc1
    v_mfma_f32_16x16x32_bf16 v[56:59], a[172:175], v[200:203], v[56:59]
    s_add_u32 s27, s27, 8192
    ds_read_b128 a[196:199], v1 offset:51200
    v_add_u32 v15, 4096, v15
    v_mfma_f32_16x16x32_bf16 v[56:59], a[176:179], v[208:211], v[56:59]
    buffer_load_dwordx4 a[216:219], v15, s[4:7], 0 offen offset:0 sc1
    v_add_u32 v8, s30, v4
    v_mfma_f32_16x16x32_bf16 v[60:63], a[160:163], v[180:183], v[60:63]
    buffer_load_dwordx4 a[220:223], v15, s[4:7], 0 offen offset:1024 sc1
    v_mfma_f32_16x16x32_bf16 v[60:63], a[164:167], v[188:191], v[60:63]
    v_mfma_f32_16x16x32_bf16 v[60:63], a[168:171], v[196:199], v[60:63]
    v_mfma_f32_16x16x32_bf16 v[60:63], a[172:175], v[204:207], v[60:63]
    v_mfma_f32_16x16x32_bf16 v[60:63], a[176:179], v[212:215], v[60:63]
    s_waitcnt lgkmcnt(0)
    v_mfma_f32_16x16x32_bf16 v[56:59], a[180:183], v[216:219], v[56:59]
    ds_read_b128 a[160:163], v1 offset:1024
    ds_read_b128 a[164:167], v1 offset:2048
    v_mfma_f32_16x16x32_bf16 v[56:59], a[184:187], v[224:227], v[56:59]
    buffer_load_dwordx4 a[224:227], v15, s[4:7], 0 offen offset:2048 sc1
    ds_read_b128 a[168:171], v1 offset:3072
    v_mfma_f32_16x16x32_bf16 v[56:59], a[188:191], v[232:235], v[56:59]
    ds_read_b128 a[172:175], v1 offset:4096
    ds_read_b128 a[176:179], v1 offset:5120
    v_mfma_f32_16x16x32_bf16 v[56:59], a[192:195], v[240:243], v[56:59]
    v_mfma_f32_16x16x32_bf16 v[56:59], a[196:199], v[248:251], v[56:59]
    v_mfma_f32_16x16x32_bf16 v[60:63], a[180:183], v[220:223], v[60:63]
    buffer_load_dwordx4 a[228:231], v15, s[4:7], 0 offen offset:3072 sc1
    v_mfma_f32_16x16x32_bf16 v[60:63], a[184:187], v[228:231], v[60:63]
    v_mfma_f32_16x16x32_bf16 v[60:63], a[188:191], v[236:239], v[60:63]
    v_mfma_f32_16x16x32_bf16 v[60:63], a[192:195], v[244:247], v[60:63]
    v_mfma_f32_16x16x32_bf16 v[60:63], a[196:199], v[252:255], v[60:63]
    s_waitcnt lgkmcnt(0)
    v_mfma_f32_16x16x32_bf16 v[64:67], a[160:163], v[96:99], 0
    ds_read_b128 a[180:183], v1 offset:11264
    ds_read_b128 a[184:187], v1 offset:12288
    v_mfma_f32_16x16x32_bf16 v[64:67], a[164:167], v[104:107], v[64:67]
    ds_read_b128 a[188:191], v1 offset:13312
    ds_read_b128 a[192:195], v1 offset:14336
    v_mfma_f32_16x16x32_bf16 v[64:67], a[168:171], v[112:115], v[64:67]
    s_waitcnt vmcnt(12)
    v_readfirstlane_b32 s48, v5
    v_add_u32 v15, 4096, v15
    v_mfma_f32_16x16x32_bf16 v[64:67], a[172:175], v[120:123], v[64:67]
    buffer_load_dwordx4 a[232:235], v15, s[4:7], 0 offen offset:0 sc1
    ds_read_b128 a[196:199], v1 offset:15360
    v_mfma_f32_16x16x32_bf16 v[64:67], a[176:179], v[128:131], v[64:67]
    s_bitcmp1_b32 s48, 11
    s_cbranch_scc0 h10_slow
h10_ok:
    v_mfma_f32_16x16x32_bf16 v[68:71], a[160:163], v[100:103], 0
    v_add_u32 v7, s37, v14
    s_add_u32 s37, s37, 4096
    v_mfma_f32_16x16x32_bf16 v[68:71], a[164:167], v[108:111], v[68:71]
    v_exp_f32_e64 v88, -v56
    v_mfma_f32_16x16x32_bf16 v[68:71], a[168:171], v[116:119], v[68:71]
    buffer_load_dwordx4 v[40:43], v7, s[4:7], 0 offen offset:0 sc1
    v_fma_f32 v88, v88, s31, s31
    v_mfma_f32_16x16x32_bf16 v[68:71], a[172:175], v[124:127], v[68:71]
    v_exp_f32_e64 v89, -v57
    v_mfma_f32_16x16x32_bf16 v[68:71], a[176:179], v[132:135], v[68:71]
    s_waitcnt lgkmcnt(0)
    buffer_load_dwordx4 v[44:47], v7, s[4:7], 0 offen offset:2048 sc1
    v_fma_f32 v89, v89, s31, s31
    v_mfma_f32_16x16x32_bf16 v[64:67], a[180:183], v[136:139], v[64:67]
    ds_read_b128 a[160:163], v1 offset:41984
    ds_read_b128 a[164:167], v1 offset:43008
    v_mfma_f32_16x16x32_bf16 v[64:67], a[184:187], v[144:147], v[64:67]
    ds_read_b128 a[168:171], v1 offset:44032
    ds_read_b128 a[172:175], v1 offset:45056
    v_mfma_f32_16x16x32_bf16 v[64:67], a[188:191], v[152:155], v[64:67]
    ds_read_b128 a[176:179], v1 offset:46080
    v_mfma_f32_16x16x32_bf16 v[64:67], a[192:195], v[160:163], v[64:67]
    v_exp_f32_e64 v90, -v58
    v_mfma_f32_16x16x32_bf16 v[64:67], a[196:199], v[168:171], v[64:67]
    v_add_u32 v7, s37, v14
    v_fma_f32 v90, v90, s31, s31
    v_mfma_f32_16x16x32_bf16 v[68:71], a[180:183], v[140:143], v[68:71]
    s_add_u32 s37, s37, 4096
    v_exp_f32_e64 v91, -v59
    v_mfma_f32_16x16x32_bf16 v[68:71], a[184:187], v[148:151], v[68:71]
    buffer_load_dwordx4 v[48:51], v7, s[4:7], 0 offen offset:0 sc1
    v_fma_f32 v91, v91, s31, s31
    v_mfma_f32_16x16x32_bf16 v[68:71], a[188:191], v[156:159], v[68:71]
    v_exp_f32_e64 v92, -v60
    v_mfma_f32_16x16x32_bf16 v[68:71], a[192:195], v[164:167], v[68:71]
    v_exp_f32_e64 v93, -v61
    v_mfma_f32_16x16x32_bf16 v[68:71], a[196:199], v[172:175], v[68:71]
    s_waitcnt lgkmcnt(0)
    buffer_load_dwordx4 v[52:55], v7, s[4:7], 0 offen offset:2048 sc1
    v_fma_f32 v92, v92, s31, s31
    v_mfma_f32_16x16x32_bf16 v[64:67], a[160:163], v[176:179], v[64:67]
    ds_read_b128 a[180:183], v1 offset:52224
    ds_read_b128 a[184:187], v1 offset:53248
    v_mfma_f32_16x16x32_bf16 v[64:67], a[164:167], v[184:187], v[64:67]
    ds_read_b128 a[188:191], v1 offset:54272
    ds_read_b128 a[192:195], v1 offset:55296
    v_mfma_f32_16x16x32_bf16 v[64:67], a[168:171], v[192:195], v[64:67]
    ds_read_b128 a[196:199], v1 offset:56320
    v_fma_f32 v93, v93, s31, s31
    v_mfma_f32_16x16x32_bf16 v[64:67], a[172:175], v[200:203], v[64:67]
    v_exp_f32_e64 v94, -v62
    v_mfma_f32_16x16x32_bf16 v[64:67], a[176:179], v[208:211], v[64:67]
    v_add_u32 v7, s38, v14
    v_fma_f32 v94, v94, s31, s31
    v_mfma_f32_16x16x32_bf16 v[68:71], a[160:163], v[180:183], v[68:71]
    s_add_u32 s38, s38, 4096
    v_exp_f32_e64 v95, -v63
    v_mfma_f32_16x16x32_bf16 v[68:71], a[164:167], v[188:191], v[68:71]
    buffer_load_dwordx4 v[96:99], v7, s[4:7], 0 offen offset:0 sc1
    v_fma_f32 v95, v95, s31, s31
    v_mfma_f32_16x16x32_bf16 v[68:71], a[168:171], v[196:199], v[68:71]
    v_rcp_f32 v88, v88
    v_mfma_f32_16x16x32_bf16 v[68:71], a[172:175], v[204:207], v[68:71]
    buffer_load_dwordx4 v[100:103], v7, s[4:7], 0 offen offset:2048 sc1
    v_mul_f32 v56, v56, v88
    v_mfma_f32_16x16x32_bf16 v[68:71], a[176:179], v[212:215], v[68:71]
    s_waitcnt lgkmcnt(0)
    v_rcp_f32 v89, v89
    v_mfma_f32_16x16x32_bf16 v[64:67], a[180:183], v[216:219], v[64:67]
    v_rcp_f32 v90, v90
    v_mfma_f32_16x16x32_bf16 v[64:67], a[184:187], v[224:227], v[64:67]
    v_rcp_f32 v91, v91
    v_mfma_f32_16x16x32_bf16 v[64:67], a[188:191], v[232:235], v[64:67]
    v_mul_f32 v57, v57, v89
    v_mul_f32 v58, v58, v90
    v_mfma_f32_16x16x32_bf16 v[64:67], a[192:195], v[240:243], v[64:67]
    v_add_u32 v7, s38, v14
    v_mul_f32 v59, v59, v91
    v_mfma_f32_16x16x32_bf16 v[64:67], a[196:199], v[248:251], v[64:67]
    s_add_u32 s38, s38, 4096
    v_rcp_f32 v92, v92
    v_mfma_f32_16x16x32_bf16 v[68:71], a[180:183], v[220:223], v[68:71]
    buffer_load_dwordx4 v[104:107], v7, s[4:7], 0 offen offset:0 sc1
    v_mul_f32 v60, v60, v92
    v_mfma_f32_16x16x32_bf16 v[68:71], a[184:187], v[228:231], v[68:71]
    v_rcp_f32 v93, v93
    v_mfma_f32_16x16x32_bf16 v[68:71], a[188:191], v[236:239], v[68:71]
    v_mov_b32 v6, 0x10000
    v_mul_f32 v61, v61, v93
    v_mfma_f32_16x16x32_bf16 v[68:71], a[192:195], v[244:247], v[68:71]
    s_waitcnt vmcnt(12)
    buffer_atomic_add v6, v12, s[4:7], s46 offen offset:0 sc1
    v_mfma_f32_16x16x32_bf16 v[68:71], a[196:199], v[252:255], v[68:71]
    v_rcp_f32 v94, v94
    v_mfma_f32_16x16x32_bf16 v[176:179], a[0:3], v[72:75], 0
    buffer_load_dwordx4 v[108:111], v7, s[4:7], 0 offen offset:2048 sc1
    v_mul_f32 v62, v62, v94
    v_mfma_f32_16x16x32_bf16 v[176:179], a[20:23], v[76:79], v[176:179]
    v_rcp_f32 v95, v95
    v_mfma_f32_16x16x32_bf16 v[176:179], a[40:43], v[80:83], v[176:179]
    v_add_u32 v7, s39, v14
    v_mul_f32 v63, v63, v95
    v_mfma_f32_16x16x32_bf16 v[176:179], a[60:63], v[84:87], v[176:179]
    s_add_u32 s39, s39, 4096
    v_mfma_f32_16x16x32_bf16 v[180:183], a[4:7], v[72:75], 0
    buffer_load_dwordx4 v[112:115], v7, s[4:7], 0 offen offset:0 sc1
    v_mfma_f32_16x16x32_bf16 v[180:183], a[24:27], v[76:79], v[180:183]
    v_mfma_f32_16x16x32_bf16 v[180:183], a[44:47], v[80:83], v[180:183]
    v_mul_f32 v64, v64, v56
    v_mul_f32 v65, v65, v57
    v_mfma_f32_16x16x32_bf16 v[180:183], a[64:67], v[84:87], v[180:183]
    buffer_load_dwordx4 v[116:119], v7, s[4:7], 0 offen offset:2048 sc1
    v_cvt_pk_bf16_f32 v16, v64, v65
    v_mfma_f32_16x16x32_bf16 v[184:187], a[8:11], v[72:75], 0
    v_mul_f32 v66, v66, v58
    v_mul_f32 v67, v67, v59
    v_mfma_f32_16x16x32_bf16 v[184:187], a[28:31], v[76:79], v[184:187]
    v_cvt_pk_bf16_f32 v17, v66, v67
    v_mul_f32 v68, v68, v60
    v_mfma_f32_16x16x32_bf16 v[184:187], a[48:51], v[80:83], v[184:187]
    v_mul_f32 v69, v69, v61
    v_cvt_pk_bf16_f32 v20, v68, v69
    v_mfma_f32_16x16x32_bf16 v[184:187], a[68:71], v[84:87], v[184:187]
    v_add_u32 v7, s39, v14
    v_mul_f32 v70, v70, v62
    v_mfma_f32_16x16x32_bf16 v[188:191], a[12:15], v[72:75], 0
    s_add_u32 s39, s39, 4096
    v_mul_f32 v71, v71, v63
    v_cvt_pk_bf16_f32 v21, v70, v71
    v_mfma_f32_16x16x32_bf16 v[188:191], a[32:35], v[76:79], v[188:191]
    buffer_load_dwordx4 v[120:123], v7, s[4:7], 0 offen offset:0 sc1
    v_mfma_f32_16x16x32_bf16 v[188:191], a[52:55], v[80:83], v[188:191]
    buffer_store_dwordx2 v[16:17], v8, s[4:7], s28 offen offset:0 sc1
    v_mfma_f32_16x16x32_bf16 v[188:191], a[72:75], v[84:87], v[188:191]
    buffer_store_dwordx2 v[20:21], v8, s[4:7], s28 offen offset:512 sc1
    v_mfma_f32_16x16x32_bf16 v[192:195], a[16:19], v[72:75], 0
    buffer_load_dwordx4 v[124:127], v7, s[4:7], 0 offen offset:2048 sc1
    ds_read_b128 v[144:147], v10 offset:0
    v_mfma_f32_16x16x32_bf16 v[192:195], a[36:39], v[76:79], v[192:195]
    ds_read_b128 v[148:151], v10 offset:2048
    ds_read_b128 v[152:155], v10 offset:4096
    v_mfma_f32_16x16x32_bf16 v[192:195], a[56:59], v[80:83], v[192:195]
    ds_read_b128 v[156:159], v10 offset:6144
    v_xor_b32 v10, 0x400, v10
    v_mfma_f32_16x16x32_bf16 v[192:195], a[76:79], v[84:87], v[192:195]
    ds_read_b128 v[160:163], v10 offset:0
    ds_read_b128 v[164:167], v10 offset:2048
    v_mfma_f32_16x16x32_bf16 v[196:199], a[0:3], v[24:27], 0
    ds_read_b128 v[168:171], v10 offset:4096
    ds_read_b128 v[172:175], v10 offset:6144
    v_mfma_f32_16x16x32_bf16 v[196:199], a[20:23], v[28:31], v[196:199]
    s_lshl_b32 s33, s17, 1
    v_add_u32 v7, s40, v14
    v_and_b32 v88, 15, v0
    v_mfma_f32_16x16x32_bf16 v[196:199], a[40:43], v[32:35], v[196:199]
    s_add_u32 s40, s40, 4096
    v_lshlrev_b32 v16, 3, v88
    v_lshrrev_b32 v89, 5, v0
    v_mfma_f32_16x16x32_bf16 v[196:199], a[60:63], v[36:39], v[196:199]
    buffer_load_dwordx4 v[128:131], v7, s[4:7], 0 offen offset:0 sc1
    v_mul_u32_u24 v89, 2560, v89
    v_mfma_f32_16x16x32_bf16 v[200:203], a[4:7], v[24:27], 0
    s_add_u32 s33, s33, s19
    v_lshl_add_u32 v88, v88, 4, v89
    v_bfe_u32 v89, v0, 4, 1
    v_mfma_f32_16x16x32_bf16 v[200:203], a[24:27], v[28:31], v[200:203]
    buffer_load_dwordx4 v[132:135], v7, s[4:7], 0 offen offset:2048 sc1
    v_lshl_add_u32 v9, v89, 3, v88
    v_mfma_f32_16x16x32_bf16 v[200:203], a[44:47], v[32:35], v[200:203]
    s_lshl_b32 s33, s33, 2
    v_mul_u32_u24 v89, 1536, v89
    v_add_u32 v8, v88, v89
    v_mfma_f32_16x16x32_bf16 v[200:203], a[64:67], v[36:39], v[200:203]
    s_add_u32 s33, s33, s16
    s_lshl_b32 s34, s33, 7
    s_add_u32 s34, s34, 0xf80000
    v_mfma_f32_16x16x32_bf16 v[204:207], a[8:11], v[24:27], 0
    s_lshr_b32 s33, s33, 1
    s_mul_i32 s24, s33, 40960
    s_mul_i32 s32, s33, 110592
    v_mfma_f32_16x16x32_bf16 v[204:207], a[28:31], v[28:31], v[204:207]
    s_lshl_b32 s33, s33, 9
    s_add_u32 s33, s33, 0x1980004
    s_and_b32 s27, s16, 1
    v_mfma_f32_16x16x32_bf16 v[204:207], a[48:51], v[32:35], v[204:207]
    s_lshl_b32 s27, s27, 8
    v_add_u32 v7, s40, v14
    s_add_u32 s40, s40, 4096
    v_mfma_f32_16x16x32_bf16 v[204:207], a[68:71], v[36:39], v[204:207]
    buffer_load_dwordx4 v[136:139], v7, s[4:7], 0 offen offset:0 sc1
    s_add_u32 s24, s24, s27
    v_mfma_f32_16x16x32_bf16 v[208:211], a[12:15], v[24:27], 0
    s_add_u32 s32, s32, s27
    s_add_u32 s32, s32, s27
    s_add_u32 s32, s32, 0x1218000
    v_mfma_f32_16x16x32_bf16 v[208:211], a[32:35], v[28:31], v[208:211]
    s_mul_i32 s27, s20, 5120
    v_add_u32 v17, s32, v4
    s_add_u32 s24, s24, s27
    v_mfma_f32_16x16x32_bf16 v[208:211], a[52:55], v[32:35], v[208:211]
    s_add_u32 s24, s24, 0xd00000
    s_xor_b32 s27, s16, 0
    v_mfma_f32_16x16x32_bf16 v[208:211], a[72:75], v[36:39], v[208:211]
    buffer_load_dwordx4 v[140:143], v7, s[4:7], 0 offen offset:2048 sc1
    v_mfma_f32_16x16x32_bf16 v[212:215], a[16:19], v[24:27], 0
    v_mfma_f32_16x16x32_bf16 v[212:215], a[36:39], v[28:31], v[212:215]
    v_mfma_f32_16x16x32_bf16 v[212:215], a[56:59], v[32:35], v[212:215]
    s_waitcnt lgkmcnt(0)
    v_mfma_f32_16x16x32_bf16 v[212:215], a[76:79], v[36:39], v[212:215]
    v_mfma_f32_16x16x32_bf16 v[216:219], a[0:3], v[144:147], 0
    buffer_load_dwordx4 a[236:239], v15, s[4:7], 0 offen offset:1024 sc1
    v_lshrrev_b32 v88, 4, v0
    v_mfma_f32_16x16x32_bf16 v[216:219], a[20:23], v[148:151], v[216:219]
    s_and_b32 s42, s27, 2
    v_lshl_add_u32 v21, v88, 8, v16
    v_min_u32 v88, 1, v88
    v_mfma_f32_16x16x32_bf16 v[216:219], a[40:43], v[152:155], v[216:219]
    s_add_u32 s27, s27, s42
    v_lshl_add_u32 v20, v88, 31, v4
    v_lshrrev_b32 v90, 4, v0
    v_mfma_f32_16x16x32_bf16 v[216:219], a[60:63], v[156:159], v[216:219]
    buffer_load_dwordx4 a[240:243], v15, s[4:7], 0 offen offset:2048 sc1
    v_and_b32 v91, 7, v0
    v_mfma_f32_16x16x32_bf16 v[220:223], a[4:7], v[144:147], 0
    s_mul_i32 s27, s27, 10240
    v_add_u32 v3, s27, v14
    s_xor_b32 s27, s16, 3
    v_mfma_f32_16x16x32_bf16 v[220:223], a[24:27], v[148:151], v[220:223]
    s_and_b32 s42, s27, 2
    s_add_u32 s27, s27, s42
    s_mul_i32 s27, s27, 10240
    v_mfma_f32_16x16x32_bf16 v[220:223], a[44:47], v[152:155], v[220:223]
    buffer_load_dwordx4 a[244:247], v15, s[4:7], 0 offen offset:3072 sc1
    v_add_u32 v11, s27, v14
    v_mfma_f32_16x16x32_bf16 v[220:223], a[64:67], v[156:159], v[220:223]
    s_xor_b32 s27, s16, 2
    s_and_b32 s42, s27, 2
    s_add_u32 s27, s27, s42
    v_mfma_f32_16x16x32_bf16 v[224:227], a[8:11], v[144:147], 0
    s_mul_i32 s27, s27, 10240
    v_add_u32 v22, s27, v14
    s_xor_b32 s27, s16, 0
    v_mfma_f32_16x16x32_bf16 v[224:227], a[28:31], v[148:151], v[224:227]
    s_mul_i32 s27, s27, 5120
    v_add_u32 v10, s27, v14
    s_xor_b32 s27, s16, 1
    v_mfma_f32_16x16x32_bf16 v[224:227], a[48:51], v[152:155], v[224:227]
    s_mul_i32 s27, s27, 5120
    v_add_u32 v15, 4096, v15
    v_add_u32 v23, s27, v14
    v_mfma_f32_16x16x32_bf16 v[224:227], a[68:71], v[156:159], v[224:227]
    buffer_load_dwordx4 a[248:251], v15, s[4:7], 0 offen offset:0 sc1
    s_lshl_b32 s35, s17, 1
    v_mfma_f32_16x16x32_bf16 v[228:231], a[12:15], v[144:147], 0
    s_add_u32 s35, s35, s19
    s_lshl_b32 s35, s35, 2
    s_add_u32 s35, s35, s16
    v_mfma_f32_16x16x32_bf16 v[228:231], a[32:35], v[148:151], v[228:231]
    buffer_load_dwordx4 a[252:255], v15, s[4:7], 0 offen offset:1024 sc1
    s_mul_i32 s32, s35, 20480
    v_mfma_f32_16x16x32_bf16 v[228:231], a[52:55], v[152:155], v[228:231]
    s_load_dword s48, s[52:53], s47 glc
    s_add_u32 s32, s32, 0x1e80000
    s_lshl_b32 s35, s35, 10
    v_mfma_f32_16x16x32_bf16 v[228:231], a[72:75], v[156:159], v[228:231]
    s_add_u32 s35, s35, 0x2d00000
    s_lshl_b32 s36, s20, 7
    s_add_u32 s36, s36, s35
    v_mfma_f32_16x16x32_bf16 v[232:235], a[16:19], v[144:147], 0
    s_lshl_b32 s27, s20, 2
    v_add_u32 v90, s27, v90
    v_lshrrev_b32 v88, 1, v90
    v_mfma_f32_16x16x32_bf16 v[232:235], a[36:39], v[148:151], v[232:235]
    s_branch .Lps3712
.Lpd3712:
    s_branch hop1_ret
.Lps3712:
    buffer_load_dwordx4 a[160:163], v15, s[4:7], 0 offen offset:2048 sc1
    v_mul_u32_u24 v88, 640, v88
    v_mfma_f32_16x16x32_bf16 v[232:235], a[56:59], v[152:155], v[232:235]
    v_and_b32 v89, 1, v90
    v_and_b32 v18, 7, v90
    v_mfma_f32_16x16x32_bf16 v[232:235], a[76:79], v[156:159], v[232:235]
    v_xor_b32 v18, v18, v91
    v_lshl_add_u32 v18, v18, 4, v88
    v_mfma_f32_16x16x32_bf16 v[236:239], a[0:3], v[160:163], 0
    buffer_load_dwordx4 a[164:167], v15, s[4:7], 0 offen offset:3072 sc1
    v_and_b32 v59, 15, v0
    v_mfma_f32_16x16x32_bf16 v[236:239], a[20:23], v[164:167], v[236:239]
    s_lshl_b32 s3, s16, 3
    v_lshrrev_b32 v60, 1, v59
    v_mul_u32_u24 v86, 336, v60
    v_mfma_f32_16x16x32_bf16 v[236:239], a[40:43], v[168:171], v[236:239]
    s_mul_i32 s29, s20, 5
    v_add_u32 v60, s3, v60
    v_and_b32 v61, 1, v0
    v_mfma_f32_16x16x32_bf16 v[236:239], a[60:63], v[172:175], v[236:239]
    s_lshl_b32 s3, s16, 4
    v_lshl_add_u32 v86, v61, 3, v86
    v_cvt_f32_u32 v62, v61
    v_mfma_f32_16x16x32_bf16 v[240:243], a[4:7], v[160:163], 0
    v_add_u32 v15, 4096, v15
    v_mul_f32 v62, 0x3e800000, v62
    v_mfma_f32_16x16x32_bf16 v[240:243], a[24:27], v[164:167], v[240:243]
    buffer_load_dwordx4 a[168:171], v15, s[4:7], 0 offen offset:0 sc1
    v_cmp_eq_u32 vcc, 0, v60
    v_mfma_f32_16x16x32_bf16 v[240:243], a[44:47], v[168:171], v[240:243]
    v_lshlrev_b32 v61, 5, v61
    v_lshrrev_b32 v63, 5, v0
    v_mfma_f32_16x16x32_bf16 v[240:243], a[64:67], v[172:175], v[240:243]
    buffer_load_dwordx4 a[172:175], v15, s[4:7], 0 offen offset:1024 sc1
    v_cndmask_b32 v60, v60, v61, vcc
    v_mfma_f32_16x16x32_bf16 v[244:247], a[8:11], v[160:163], 0
    v_cndmask_b32_e64 v62, v62, 0, vcc
    v_cvt_f32_u32 v60, v60
    v_mfma_f32_16x16x32_bf16 v[244:247], a[28:31], v[164:167], v[244:247]
    v_mul_f32 v60, 0x3c800000, v60
    v_bfe_u32 v61, v0, 4, 1
    v_mfma_f32_16x16x32_bf16 v[244:247], a[48:51], v[168:171], v[244:247]
    v_lshlrev_b32 v61, 5, v61
    v_lshl_add_u32 v61, v63, 1, v61
    v_mfma_f32_16x16x32_bf16 v[244:247], a[68:71], v[172:175], v[244:247]
    buffer_load_dwordx4 a[176:179], v15, s[4:7], 0 offen offset:2048 sc1
    v_cvt_f32_u32 v61, v61
    v_mfma_f32_16x16x32_bf16 v[248:251], a[12:15], v[160:163], 0
    v_fma_f32 v62, v60, v61, v62
    v_fmamk_f32 v76, v60, 0x00000000, v62
    v_mfma_f32_16x16x32_bf16 v[248:251], a[32:35], v[164:167], v[248:251]
    v_cos_f32 v76, v76
    v_mfma_f32_16x16x32_bf16 v[248:251], a[52:55], v[168:171], v[248:251]
    buffer_load_dwordx4 a[180:183], v15, s[4:7], 0 offen offset:3072 sc1
    v_fmamk_f32 v61, v60, 0x41000000, v62
    v_mfma_f32_16x16x32_bf16 v[248:251], a[72:75], v[172:175], v[248:251]
    v_cos_f32 v61, v61
    v_mfma_f32_16x16x32_bf16 v[252:255], a[16:19], v[160:163], 0
    v_fmamk_f32 v77, v60, 0x41800000, v62
    v_fmamk_f32 v63, v60, 0x41c00000, v62
    v_mfma_f32_16x16x32_bf16 v[252:255], a[36:39], v[164:167], v[252:255]
    v_mov_b32 v6, 0x1
    v_and_b32 v19, 6, v90
    v_mfma_f32_16x16x32_bf16 v[252:255], a[56:59], v[168:171], v[252:255]
    s_waitcnt vmcnt(16)
    buffer_atomic_add v6, v12, s[4:7], s25 offen offset:4 sc1
    v_mfma_f32_16x16x32_bf16 v[252:255], a[76:79], v[172:175], v[252:255]
    buffer_load_dwordx2 v[74:75], v16, s[4:7], s34 offen sc1
    v_mfma_f32_16x16x32_bf16 v[176:179], a[80:83], v[40:43], v[176:179]
    v_cos_f32 v77, v77
    v_mfma_f32_16x16x32_bf16 v[176:179], a[100:103], v[44:47], v[176:179]
    buffer_load_dwordx4 v[64:67], v8, s[4:7], s24 offen sc1
    v_mfma_f32_16x16x32_bf16 v[176:179], a[120:123], v[48:51], v[176:179]
    v_cos_f32 v63, v63
    v_mfma_f32_16x16x32_bf16 v[176:179], a[140:143], v[52:55], v[176:179]
    v_cvt_pk_bf16_f32 v76, v76, v61
    v_xor_b32 v19, v19, v91
    v_mfma_f32_16x16x32_bf16 v[180:183], a[84:87], v[40:43], v[180:183]
    buffer_load_dwordx4 v[68:71], v8, s[4:7], s24 offen offset:512 sc1
    v_mfma_f32_16x16x32_bf16 v[180:183], a[104:107], v[44:47], v[180:183]
    v_lshl_add_u32 v19, v19, 4, v88
    v_lshl_add_u32 v19, v89, 3, v19
    v_mfma_f32_16x16x32_bf16 v[180:183], a[124:127], v[48:51], v[180:183]
    v_add_u32 v19, 256, v19
    v_fmamk_f32 v78, v60, 0x40800000, v62
    v_mfma_f32_16x16x32_bf16 v[180:183], a[144:147], v[52:55], v[180:183]
    buffer_load_dwordx2 v[72:73], v9, s[4:7], s24 offen offset:1024 sc1
    v_mfma_f32_16x16x32_bf16 v[184:187], a[88:91], v[40:43], v[184:187]
    v_cos_f32 v78, v78
    v_mfma_f32_16x16x32_bf16 v[184:187], a[108:111], v[44:47], v[184:187]
    v_mul_u32_u24 v89, 384, v89
    v_fmamk_f32 v61, v60, 0x41400000, v62
    v_mfma_f32_16x16x32_bf16 v[184:187], a[128:131], v[48:51], v[184:187]
    v_cos_f32 v61, v61
    v_mfma_f32_16x16x32_bf16 v[184:187], a[148:151], v[52:55], v[184:187]
    v_add_u32 v18, v18, v89
    v_bfe_u32 v88, v0, 3, 1
    v_mfma_f32_16x16x32_bf16 v[188:191], a[92:95], v[40:43], v[188:191]
    v_cvt_pk_bf16_f32 v77, v77, v63
    v_mul_u32_u24 v88, 10240, v88
    v_mfma_f32_16x16x32_bf16 v[188:191], a[112:115], v[44:47], v[188:191]
    v_add_u32 v18, v18, v88
    v_add_u32 v19, v19, v88
    v_mfma_f32_16x16x32_bf16 v[188:191], a[132:135], v[48:51], v[188:191]
    s_waitcnt lgkmcnt(0)
    s_bitcmp1_b32 s48, 19
    s_cbranch_scc0 h20_slow
h20_ok:
    v_mfma_f32_16x16x32_bf16 v[188:191], a[152:155], v[52:55], v[188:191]
    v_add_u32 v7, s37, v14
    v_fmamk_f32 v79, v60, 0x41a00000, v62
    v_mfma_f32_16x16x32_bf16 v[192:195], a[96:99], v[40:43], v[192:195]
    s_add_u32 s37, s37, 4096
    v_cos_f32 v79, v79
    v_mfma_f32_16x16x32_bf16 v[192:195], a[116:119], v[44:47], v[192:195]
    buffer_load_dwordx4 v[144:147], v7, s[4:7], 0 offen offset:0 sc1
    v_fmamk_f32 v63, v60, 0x41e00000, v62
    v_mfma_f32_16x16x32_bf16 v[192:195], a[136:139], v[48:51], v[192:195]
    buffer_load_dwordx4 v[148:151], v7, s[4:7], 0 offen offset:2048 sc1
    v_cvt_pk_bf16_f32 v78, v78, v61
    v_mfma_f32_16x16x32_bf16 v[192:195], a[156:159], v[52:55], v[192:195]
    v_cos_f32 v63, v63
    v_mfma_f32_16x16x32_bf16 v[196:199], a[80:83], v[96:99], v[196:199]
    v_fmamk_f32 v80, v60, 0x3f800000, v62
    v_fmamk_f32 v61, v60, 0x41100000, v62
    v_mfma_f32_16x16x32_bf16 v[196:199], a[100:103], v[100:103], v[196:199]
    v_cos_f32 v80, v80
    v_mfma_f32_16x16x32_bf16 v[196:199], a[120:123], v[104:107], v[196:199]
    v_add_u32 v7, s37, v14
    v_cvt_pk_bf16_f32 v79, v79, v63
    v_mfma_f32_16x16x32_bf16 v[196:199], a[140:143], v[108:111], v[196:199]
    s_add_u32 s37, s37, 4096
    v_cos_f32 v61, v61
    v_mfma_f32_16x16x32_bf16 v[200:203], a[84:87], v[96:99], v[200:203]
    buffer_load_dwordx4 v[152:155], v7, s[4:7], 0 offen offset:0 sc1
    v_fmamk_f32 v81, v60, 0x41880000, v62
    v_mfma_f32_16x16x32_bf16 v[200:203], a[104:107], v[100:103], v[200:203]
    v_cos_f32 v81, v81
    v_mfma_f32_16x16x32_bf16 v[200:203], a[124:127], v[104:107], v[200:203]
    buffer_load_dwordx4 v[156:159], v7, s[4:7], 0 offen offset:2048 sc1
    v_fmamk_f32 v63, v60, 0x41c80000, v62
    v_mfma_f32_16x16x32_bf16 v[200:203], a[144:147], v[108:111], v[200:203]
    v_cos_f32 v63, v63
    v_mfma_f32_16x16x32_bf16 v[204:207], a[88:91], v[96:99], v[204:207]
    v_cvt_pk_bf16_f32 v80, v80, v61
    v_fmamk_f32 v82, v60, 0x40a00000, v62
    v_mfma_f32_16x16x32_bf16 v[204:207], a[108:111], v[100:103], v[204:207]
    v_add_u32 v7, s38, v14
    v_fmamk_f32 v61, v60, 0x41500000, v62
    v_mfma_f32_16x16x32_bf16 v[204:207], a[128:131], v[104:107], v[204:207]
    s_add_u32 s38, s38, 4096
    v_cos_f32 v82, v82
    v_mfma_f32_16x16x32_bf16 v[204:207], a[148:151], v[108:111], v[204:207]
    buffer_load_dwordx4 v[160:163], v7, s[4:7], 0 offen offset:0 sc1
    v_cvt_pk_bf16_f32 v81, v81, v63
    v_mfma_f32_16x16x32_bf16 v[208:211], a[92:95], v[96:99], v[208:211]
    v_cos_f32 v61, v61
    v_mfma_f32_16x16x32_bf16 v[208:211], a[112:115], v[100:103], v[208:211]
    buffer_load_dwordx4 v[164:167], v7, s[4:7], 0 offen offset:2048 sc1
    v_fmamk_f32 v83, v60, 0x41a80000, v62
    v_mfma_f32_16x16x32_bf16 v[208:211], a[132:135], v[104:107], v[208:211]
    v_cos_f32 v83, v83
    v_mfma_f32_16x16x32_bf16 v[208:211], a[152:155], v[108:111], v[208:211]
    v_fmamk_f32 v63, v60, 0x41e80000, v62
    v_cvt_pk_bf16_f32 v82, v82, v61
    v_mfma_f32_16x16x32_bf16 v[212:215], a[96:99], v[96:99], v[212:215]
    v_cos_f32 v63, v63
    v_mfma_f32_16x16x32_bf16 v[212:215], a[116:119], v[100:103], v[212:215]
    v_add_u32 v7, s38, v14
    v_cvt_pk_bf16_f32 v83, v83, v63
    v_mfma_f32_16x16x32_bf16 v[212:215], a[136:139], v[104:107], v[212:215]
    s_add_u32 s38, s38, 4096
    v_add_u32 v59, s3, v59
    v_mul_u32_u24 v84, 168, v59
    v_mfma_f32_16x16x32_bf16 v[212:215], a[156:159], v[108:111], v[212:215]
    s_waitcnt vmcnt(26)
    buffer_load_dwordx4 v[168:171], v7, s[4:7], 0 offen offset:0 sc1
    v_lshrrev_b32 v59, 4, v0
    v_mfma_f32_16x16x32_bf16 v[216:219], a[80:83], v[112:115], v[216:219]
    buffer_load_dwordx4 v[172:175], v7, s[4:7], 0 offen offset:2048 sc1
    v_mad_u32_u24 v84, v59, 40, v84
    v_mfma_f32_16x16x32_bf16 v[216:219], a[100:103], v[116:119], v[216:219]
    s_and_b32 s3, s17, 3
    v_and_b32 v60, 28, v0
    v_lshrrev_b32 v61, 5, v0
    v_mfma_f32_16x16x32_bf16 v[216:219], a[120:123], v[120:123], v[216:219]
    v_add_u32 v60, v60, v61
    v_mul_u32_u24 v60, 168, v60
    v_mfma_f32_16x16x32_bf16 v[216:219], a[140:143], v[124:127], v[216:219]
    v_and_b32 v61, 3, v0
    v_lshl_add_u32 v85, v61, 3, v60
    v_mfma_f32_16x16x32_bf16 v[220:223], a[84:87], v[112:115], v[220:223]
    v_add_u32 v7, s39, v14
    v_add_u32 v84, 0xf000, v84
    v_mfma_f32_16x16x32_bf16 v[220:223], a[104:107], v[116:119], v[220:223]
    s_add_u32 s39, s39, 4096
    v_add_u32 v85, 0xf000, v85
    v_xor_b32 v59, s3, v59
    v_mfma_f32_16x16x32_bf16 v[220:223], a[124:127], v[120:123], v[220:223]
    buffer_load_dwordx4 a[184:187], v7, s[4:7], 0 offen offset:0 sc1
    v_lshl_add_u32 v86, v59, 4, v86
    v_mfma_f32_16x16x32_bf16 v[220:223], a[144:147], v[124:127], v[220:223]
    s_mul_i32 s3, s16, 2688
    v_add_u32 v59, 0, v0
    v_mul_u32_u24 v60, 205, v59
    v_mfma_f32_16x16x32_bf16 v[224:227], a[88:91], v[112:115], v[224:227]
    buffer_load_dwordx4 a[188:191], v7, s[4:7], 0 offen offset:2048 sc1
    v_lshrrev_b32 v60, 12, v60
    v_mfma_f32_16x16x32_bf16 v[224:227], a[108:111], v[116:119], v[224:227]
    s_add_u32 s3, s3, 0x22000
    v_add_u32 v86, s3, v86
    v_add_u32 v61, v59, v60
    v_mfma_f32_16x16x32_bf16 v[224:227], a[128:131], v[120:123], v[224:227]
    v_lshl_add_u32 v87, v61, 4, s3
    v_mul_u32_u24 v61, 5, v60
    v_mfma_f32_16x16x32_bf16 v[224:227], a[148:151], v[124:127], v[224:227]
    v_add_u32 v7, s39, v14
    v_lshrrev_b32 v62, 2, v59
    v_mfma_f32_16x16x32_bf16 v[228:231], a[92:95], v[112:115], v[228:231]
    s_add_u32 s39, s39, 4096
    v_sub_u32 v61, v62, v61
    v_add_u32 v61, s29, v61
    v_mfma_f32_16x16x32_bf16 v[228:231], a[112:115], v[116:119], v[228:231]
    buffer_load_dwordx4 a[192:195], v7, s[4:7], 0 offen offset:0 sc1
    v_mul_u32_u24 v60, 81920, v60
    v_mfma_f32_16x16x32_bf16 v[228:231], a[132:135], v[120:123], v[228:231]
    v_and_b32 v59, 3, v0
    v_lshl_add_u32 v60, v59, 4, v60
    v_mfma_f32_16x16x32_bf16 v[228:231], a[152:155], v[124:127], v[228:231]
    buffer_load_dwordx4 a[196:199], v7, s[4:7], 0 offen offset:2048 sc1
    v_bfe_u32 v62, v61, 2, 1
    v_mfma_f32_16x16x32_bf16 v[232:235], a[96:99], v[112:115], v[232:235]
    v_mov_b32 v5, 0
    v_xor_b32 v62, v61, v62
    v_mfma_f32_16x16x32_bf16 v[232:235], a[116:119], v[116:119], v[232:235]
    buffer_atomic_add v5, v12, s[4:7], s33 offen sc0 sc1
    v_mfma_f32_16x16x32_bf16 v[232:235], a[136:139], v[120:123], v[232:235]
    v_lshl_add_u32 v56, v62, 6, v60
    v_add_u32 v59, 64, v0
    v_mfma_f32_16x16x32_bf16 v[232:235], a[156:159], v[124:127], v[232:235]
    s_waitcnt vmcnt(29)
    v_add_u32 v7, s40, v14
    v_mul_u32_u24 v60, 205, v59
    v_mfma_f32_16x16x32_bf16 v[236:239], a[80:83], v[128:131], v[236:239]
    s_add_u32 s40, s40, 4096
    v_lshrrev_b32 v60, 12, v60
    v_add_u32 v61, v59, v60
    v_mfma_f32_16x16x32_bf16 v[236:239], a[100:103], v[132:135], v[236:239]
    buffer_load_dwordx4 v[96:99], v7, s[4:7], 0 offen offset:0 sc1
    v_lshl_add_u32 v94, v61, 4, s3
    v_mfma_f32_16x16x32_bf16 v[236:239], a[120:123], v[136:139], v[236:239]
    buffer_load_dwordx4 v[100:103], v7, s[4:7], 0 offen offset:2048 sc1
    ds_read_b128 v[88:91], v1 offset:57344
    v_mfma_f32_16x16x32_bf16 v[236:239], a[140:143], v[140:143], v[236:239]
    v_mul_u32_u24 v61, 5, v60
    v_lshrrev_b32 v62, 2, v59
    v_mfma_f32_16x16x32_bf16 v[240:243], a[84:87], v[128:131], v[240:243]
    v_sub_u32 v61, v62, v61
    v_add_u32 v61, s29, v61
    v_mfma_f32_16x16x32_bf16 v[240:243], a[104:107], v[132:135], v[240:243]
    ds_read_b128 v[112:115], v1 offset:58368
    v_mul_u32_u24 v60, 81920, v60
    v_mfma_f32_16x16x32_bf16 v[240:243], a[124:127], v[136:139], v[240:243]
    v_add_u32 v7, s40, v14
    v_and_b32 v59, 3, v0
    v_mfma_f32_16x16x32_bf16 v[240:243], a[144:147], v[140:143], v[240:243]
    s_add_u32 s40, s40, 4096
    v_lshl_add_u32 v60, v59, 4, v60
    v_bfe_u32 v62, v61, 2, 1
    v_mfma_f32_16x16x32_bf16 v[244:247], a[88:91], v[128:131], v[244:247]
    buffer_load_dwordx4 v[104:107], v7, s[4:7], 0 offen offset:0 sc1
    v_xor_b32 v62, v61, v62
    v_mfma_f32_16x16x32_bf16 v[244:247], a[108:111], v[132:135], v[244:247]
    ds_read_b128 v[116:119], v1 offset:59392
    v_lshl_add_u32 v57, v62, 6, v60
    v_mfma_f32_16x16x32_bf16 v[244:247], a[128:131], v[136:139], v[244:247]
    s_waitcnt vmcnt(16)
    buffer_load_dwordx4 v[108:111], v7, s[4:7], 0 offen offset:2048 sc1
    v_add_u32 v59, 128, v0
    v_mfma_f32_16x16x32_bf16 v[244:247], a[148:151], v[140:143], v[244:247]
    v_lshlrev_b32 v24, 16, v64
    v_fma_f32 v24, v24, v75, v74
    v_mfma_f32_16x16x32_bf16 v[248:251], a[92:95], v[128:131], v[248:251]
    ds_read_b128 v[120:123], v1 offset:60416
    v_and_b32 v25, 0xffff0000, v64
    v_mfma_f32_16x16x32_bf16 v[248:251], a[112:115], v[132:135], v[248:251]
    v_fma_f32 v25, v25, v75, v74
    v_lshlrev_b32 v26, 16, v65
    v_mfma_f32_16x16x32_bf16 v[248:251], a[132:135], v[136:139], v[248:251]
    v_fma_f32 v26, v26, v75, v74
    v_and_b32 v27, 0xffff0000, v65
    v_mfma_f32_16x16x32_bf16 v[248:251], a[152:155], v[140:143], v[248:251]
    v_fma_f32 v27, v27, v75, v74
    v_lshlrev_b32 v28, 16, v66
    v_mfma_f32_16x16x32_bf16 v[252:255], a[96:99], v[128:131], v[252:255]
    ds_read_b128 v[124:127], v1 offset:61440
    v_fma_f32 v28, v28, v75, v74
    v_mfma_f32_16x16x32_bf16 v[252:255], a[116:119], v[132:135], v[252:255]
    v_and_b32 v29, 0xffff0000, v66
    v_fma_f32 v29, v29, v75, v74
    v_mfma_f32_16x16x32_bf16 v[252:255], a[136:139], v[136:139], v[252:255]
    v_lshlrev_b32 v30, 16, v67
    v_fma_f32 v30, v30, v75, v74
    v_mfma_f32_16x16x32_bf16 v[252:255], a[156:159], v[140:143], v[252:255]
    s_waitcnt vmcnt(13)
    v_and_b32 v31, 0xffff0000, v67
    v_fma_f32 v31, v31, v75, v74
    v_mfma_f32_16x16x32_bf16 v[176:179], a[200:203], v[144:147], v[176:179]
    v_lshlrev_b32 v32, 16, v68
    v_fma_f32 v32, v32, v75, v74
    v_mfma_f32_16x16x32_bf16 v[176:179], a[220:223], v[148:151], v[176:179]
    ds_read_b128 v[128:131], v1 offset:62464
    v_and_b32 v33, 0xffff0000, v68
    v_mfma_f32_16x16x32_bf16 v[176:179], a[240:243], v[152:155], v[176:179]
    v_fma_f32 v33, v33, v75, v74
    v_lshlrev_b32 v34, 16, v69
    v_mfma_f32_16x16x32_bf16 v[176:179], a[164:167], v[156:159], v[176:179]
    ds_read_b128 v[132:135], v1 offset:63488
    v_fma_f32 v34, v34, v75, v74
    v_mfma_f32_16x16x32_bf16 v[180:183], a[204:207], v[144:147], v[180:183]
    v_and_b32 v35, 0xffff0000, v69
    v_fma_f32 v35, v35, v75, v74
    v_mfma_f32_16x16x32_bf16 v[180:183], a[224:227], v[148:151], v[180:183]
    ds_read_b128 v[136:139], v1 offset:64512
    v_lshlrev_b32 v36, 16, v70
    v_mfma_f32_16x16x32_bf16 v[180:183], a[244:247], v[152:155], v[180:183]
    v_fma_f32 v36, v36, v75, v74
    v_and_b32 v37, 0xffff0000, v70
    v_mfma_f32_16x16x32_bf16 v[180:183], a[168:171], v[156:159], v[180:183]
    ds_read_b128 v[140:143], v2 offset:0
    v_fma_f32 v37, v37, v75, v74
    v_mfma_f32_16x16x32_bf16 v[184:187], a[208:211], v[144:147], v[184:187]
    v_lshlrev_b32 v38, 16, v71
    v_fma_f32 v38, v38, v75, v74
    v_mfma_f32_16x16x32_bf16 v[184:187], a[228:231], v[148:151], v[184:187]
    v_and_b32 v39, 0xffff0000, v71
    v_fma_f32 v39, v39, v75, v74
    v_mfma_f32_16x16x32_bf16 v[184:187], a[248:251], v[152:155], v[184:187]
    ds_write_b128 v3, v[176:179] offset:0
    v_mfma_f32_16x16x32_bf16 v[184:187], a[172:175], v[156:159], v[184:187]
    v_lshlrev_b32 v40, 16, v72
    v_fma_f32 v40, v40, v75, v74
    v_mfma_f32_16x16x32_bf16 v[188:191], a[212:215], v[144:147], v[188:191]
    v_and_b32 v41, 0xffff0000, v72
    v_fma_f32 v41, v41, v75, v74
    v_mfma_f32_16x16x32_bf16 v[188:191], a[232:235], v[148:151], v[188:191]
    v_lshlrev_b32 v42, 16, v73
    v_fma_f32 v42, v42, v75, v74
    v_mfma_f32_16x16x32_bf16 v[188:191], a[252:255], v[152:155], v[188:191]
    ds_write_b128 v3, v[180:183] offset:1024
    v_mfma_f32_16x16x32_bf16 v[188:191], a[176:179], v[156:159], v[188:191]
    v_and_b32 v43, 0xffff0000, v73
    v_fma_f32 v43, v43, v75, v74
    v_mfma_f32_16x16x32_bf16 v[192:195], a[216:219], v[144:147], v[192:195]
    v_mul_u32_u24 v60, 205, v59
    v_lshrrev_b32 v60, 12, v60
    v_mfma_f32_16x16x32_bf16 v[192:195], a[236:239], v[148:151], v[192:195]
    v_add_u32 v61, v59, v60
    v_add_f32 v236, v236, v24
    v_mfma_f32_16x16x32_bf16 v[192:195], a[160:163], v[152:155], v[192:195]
    ds_write_b128 v3, v[184:187] offset:2048
    v_mfma_f32_16x16x32_bf16 v[192:195], a[180:183], v[156:159], v[192:195]
    s_waitcnt vmcnt(9)
    v_lshl_add_u32 v95, v61, 4, s3
    v_add_f32 v237, v237, v25
    v_mfma_f32_16x16x32_bf16 v[196:199], a[200:203], v[160:163], v[196:199]
    s_mul_i32 s3, s16, 655360
    v_add_f32 v238, v238, v26
    v_mul_u32_u24 v61, 5, v60
    v_mfma_f32_16x16x32_bf16 v[196:199], a[220:223], v[164:167], v[196:199]
    v_lshrrev_b32 v62, 2, v59
    v_add_f32 v239, v239, v27
    v_mfma_f32_16x16x32_bf16 v[196:199], a[240:243], v[168:171], v[196:199]
    ds_write_b128 v3, v[188:191] offset:3072
    v_mfma_f32_16x16x32_bf16 v[196:199], a[164:167], v[172:175], v[196:199]
    v_sub_u32 v61, v62, v61
    v_add_f32 v240, v240, v28
    v_mfma_f32_16x16x32_bf16 v[200:203], a[204:207], v[160:163], v[200:203]
    v_add_u32 v61, s29, v61
    v_mul_u32_u24 v60, 81920, v60
    v_mfma_f32_16x16x32_bf16 v[200:203], a[224:227], v[164:167], v[200:203]
    s_lshl_b32 s29, s19, 4
    v_add_f32 v241, v241, v29
    v_add_f32 v242, v242, v30
    v_mfma_f32_16x16x32_bf16 v[200:203], a[244:247], v[168:171], v[200:203]
    s_add_u32 s29, s29, s17
    ds_write_b128 v3, v[192:195] offset:4096
    v_mfma_f32_16x16x32_bf16 v[200:203], a[168:171], v[172:175], v[200:203]
    s_mul_i32 s29, s29, 2560
    v_and_b32 v59, 3, v0
    v_add_f32 v243, v243, v31
    v_mfma_f32_16x16x32_bf16 v[204:207], a[208:211], v[160:163], v[204:207]
    s_add_u32 s29, s29, s3
    v_lshl_add_u32 v60, v59, 4, v60
    v_lshrrev_b32 v59, 5, v0
    v_mfma_f32_16x16x32_bf16 v[204:207], a[228:231], v[164:167], v[204:207]
    s_add_u32 s29, s29, 0x1c00000
    v_add_f32 v244, v244, v32
    v_add_f32 v245, v245, v33
    v_mfma_f32_16x16x32_bf16 v[204:207], a[248:251], v[168:171], v[204:207]
    s_waitcnt vmcnt(4)
    v_readfirstlane_b32 s48, v5
    v_lshl_add_u32 v60, v59, 31, v60
    v_mfma_f32_16x16x32_bf16 v[204:207], a[172:175], v[172:175], v[204:207]
    ds_write_b128 v3, v[196:199] offset:5120
    v_mfma_f32_16x16x32_bf16 v[208:211], a[212:215], v[160:163], v[208:211]
    s_bitcmp1_b32 s48, 4
    s_cbranch_scc0 h30_slow
h30_ok:
    v_add_f32 v246, v246, v34
    v_mfma_f32_16x16x32_bf16 v[208:211], a[232:235], v[164:167], v[208:211]
    buffer_load_dwordx2 v[144:145], v17, s[4:7], 0 offen offset:0 sc1
    v_bfe_u32 v62, v61, 2, 1
    v_mfma_f32_16x16x32_bf16 v[208:211], a[252:255], v[168:171], v[208:211]
    ds_write_b128 v3, v[200:203] offset:6144
    v_mfma_f32_16x16x32_bf16 v[208:211], a[176:179], v[172:175], v[208:211]
    buffer_load_dwordx2 v[146:147], v17, s[4:7], 0 offen offset:1024 sc1
    v_add_f32 v247, v247, v35
    v_mfma_f32_16x16x32_bf16 v[212:215], a[216:219], v[160:163], v[212:215]
    ds_read_b128 v[64:67], v2 offset:1024
    v_add_f32 v248, v248, v36
    v_mfma_f32_16x16x32_bf16 v[212:215], a[236:239], v[164:167], v[212:215]
    v_xor_b32 v62, v61, v62
    v_lshl_add_u32 v58, v62, 6, v60
    v_mfma_f32_16x16x32_bf16 v[212:215], a[160:163], v[168:171], v[212:215]
    buffer_load_dwordx2 v[148:149], v17, s[4:7], 0 offen offset:2048 sc1
    v_add_f32 v249, v249, v37
    v_mfma_f32_16x16x32_bf16 v[212:215], a[180:183], v[172:175], v[212:215]
    ds_write_b128 v3, v[204:207] offset:7168
    v_mfma_f32_16x16x32_bf16 v[216:219], a[200:203], a[184:187], v[216:219]
    ds_read_b128 v[68:71], v2 offset:2048
    buffer_load_dwordx2 v[150:151], v17, s[4:7], 0 offen offset:3072 sc1
    v_mfma_f32_16x16x32_bf16 v[216:219], a[220:223], a[188:191], v[216:219]
    v_add_f32 v250, v250, v38
    v_add_f32 v251, v251, v39
    v_mfma_f32_16x16x32_bf16 v[216:219], a[240:243], a[192:195], v[216:219]
    ds_read_b128 v[72:75], v2 offset:3072
    v_add_f32 v252, v252, v40
    v_mfma_f32_16x16x32_bf16 v[216:219], a[164:167], a[196:199], v[216:219]
    ds_write_b128 v3, v[208:211] offset:8192
    v_mfma_f32_16x16x32_bf16 v[220:223], a[204:207], a[184:187], v[220:223]
    v_add_u32 v17, 4096, v17
    v_add_f32 v253, v253, v41
    v_mfma_f32_16x16x32_bf16 v[220:223], a[224:227], a[188:191], v[220:223]
    buffer_load_dwordx2 v[152:153], v17, s[4:7], 0 offen offset:0 sc1
    ds_read_b128 v[160:163], v2 offset:4096
    v_mfma_f32_16x16x32_bf16 v[220:223], a[244:247], a[192:195], v[220:223]
    buffer_load_dwordx2 v[154:155], v17, s[4:7], 0 offen offset:1024 sc1
    v_add_f32 v254, v254, v42
    v_mfma_f32_16x16x32_bf16 v[220:223], a[168:171], a[196:199], v[220:223]
    ds_write_b128 v3, v[212:215] offset:9216
    v_mfma_f32_16x16x32_bf16 v[224:227], a[208:211], a[184:187], v[224:227]
    ds_read_b128 v[164:167], v2 offset:5120
    buffer_load_dwordx2 v[156:157], v17, s[4:7], 0 offen offset:2048 sc1
    v_mfma_f32_16x16x32_bf16 v[224:227], a[228:231], a[188:191], v[224:227]
    v_add_f32 v255, v255, v43
    v_mov_b32 v44, -1
    v_mfma_f32_16x16x32_bf16 v[224:227], a[248:251], a[192:195], v[224:227]
    buffer_load_dwordx2 v[158:159], v17, s[4:7], 0 offen offset:3072 sc1
    v_mov_b32 v45, -1
    v_mfma_f32_16x16x32_bf16 v[224:227], a[172:175], a[196:199], v[224:227]
    ds_write_b128 v10, v[216:219] offset:20480
    v_mfma_f32_16x16x32_bf16 v[228:231], a[212:215], a[184:187], v[228:231]
    ds_read_b128 v[168:171], v2 offset:6144
    v_mov_b32 v46, -1
    v_mfma_f32_16x16x32_bf16 v[228:231], a[232:235], a[188:191], v[228:231]
    v_add_u32 v17, 4096, v17
    v_mov_b32 v47, -1
    v_mfma_f32_16x16x32_bf16 v[228:231], a[252:255], a[192:195], v[228:231]
    buffer_load_dwordx2 v[48:49], v17, s[4:7], 0 offen offset:0 sc1
    ds_read_b128 v[172:175], v2 offset:7168
    v_mfma_f32_16x16x32_bf16 v[228:231], a[176:179], a[196:199], v[228:231]
    ds_write_b128 v10, v[220:223] offset:21504
    v_mfma_f32_16x16x32_bf16 v[232:235], a[216:219], a[184:187], v[232:235]
    buffer_load_dwordx2 v[50:51], v17, s[4:7], 0 offen offset:1024 sc1
    v_mfma_f32_16x16x32_bf16 v[232:235], a[236:239], a[188:191], v[232:235]
    v_mfma_f32_16x16x32_bf16 v[232:235], a[160:163], a[192:195], v[232:235]
    buffer_load_dwordx2 v[52:53], v17, s[4:7], 0 offen offset:2048 sc1
    v_mfma_f32_16x16x32_bf16 v[232:235], a[180:183], a[196:199], v[232:235]
    s_waitcnt vmcnt(11)
    ds_write_b128 v10, v[224:227] offset:22528
    v_mfma_f32_16x16x32_bf16 v[236:239], a[200:203], v[96:99], v[236:239]
    buffer_load_dwordx2 v[54:55], v17, s[4:7], 0 offen offset:3072 sc1
    v_mfma_f32_16x16x32_bf16 v[236:239], a[220:223], v[100:103], v[236:239]
    ds_read_b128 a[184:187], v2 offset:8192
    v_mfma_f32_16x16x32_bf16 v[236:239], a[240:243], v[104:107], v[236:239]
    ds_write_b128 v10, v[228:231] offset:23552
    v_mfma_f32_16x16x32_bf16 v[236:239], a[164:167], v[108:111], v[236:239]
    ds_read_b128 a[188:191], v2 offset:9216
    v_mfma_f32_16x16x32_bf16 v[240:243], a[204:207], v[96:99], v[240:243]
    v_mfma_f32_16x16x32_bf16 v[240:243], a[224:227], v[100:103], v[240:243]
    ds_read_b128 a[192:195], v2 offset:10240
    v_mfma_f32_16x16x32_bf16 v[240:243], a[244:247], v[104:107], v[240:243]
    ds_write_b128 v10, v[232:235] offset:24576
    v_mfma_f32_16x16x32_bf16 v[240:243], a[168:171], v[108:111], v[240:243]
    ds_read_b128 a[196:199], v2 offset:11264
    v_mfma_f32_16x16x32_bf16 v[244:247], a[208:211], v[96:99], v[244:247]
    v_mfma_f32_16x16x32_bf16 v[244:247], a[228:231], v[100:103], v[244:247]
    s_waitcnt lgkmcnt(0)
    s_barrier
    v_mfma_f32_16x16x32_bf16 v[244:247], a[248:251], v[104:107], v[244:247]
    ds_read_b128 v[176:179], v11 offset:0
    ds_read_b128 v[180:183], v11 offset:1024
    v_mfma_f32_16x16x32_bf16 v[244:247], a[172:175], v[108:111], v[244:247]
    ds_read_b128 v[184:187], v11 offset:2048
    ds_read_b128 v[188:191], v11 offset:3072
    v_mfma_f32_16x16x32_bf16 v[248:251], a[212:215], v[96:99], v[248:251]
    ds_read_b128 v[192:195], v11 offset:4096
    ds_read_b128 v[196:199], v22 offset:5120
    v_mfma_f32_16x16x32_bf16 v[248:251], a[232:235], v[100:103], v[248:251]
    ds_read_b128 v[200:203], v22 offset:6144
    ds_read_b128 v[204:207], v22 offset:7168
    v_mfma_f32_16x16x32_bf16 v[248:251], a[252:255], v[104:107], v[248:251]
    ds_read_b128 v[208:211], v22 offset:8192
    ds_read_b128 v[212:215], v22 offset:9216
    v_mfma_f32_16x16x32_bf16 v[248:251], a[176:179], v[108:111], v[248:251]
    ds_read_b128 v[216:219], v23 offset:20480
    ds_read_b128 v[220:223], v23 offset:21504
    v_mfma_f32_16x16x32_bf16 v[252:255], a[216:219], v[96:99], v[252:255]
    ds_read_b128 v[224:227], v23 offset:22528
    ds_read_b128 v[228:231], v23 offset:23552
    v_mfma_f32_16x16x32_bf16 v[252:255], a[236:239], v[100:103], v[252:255]
    ds_read_b128 v[232:235], v23 offset:24576
    v_mfma_f32_16x16x32_bf16 v[252:255], a[160:163], v[104:107], v[252:255]
    buffer_store_dwordx4 v[44:47], v56, s[4:7], s29 offen sc1
    v_mfma_f32_16x16x32_bf16 v[252:255], a[180:183], v[108:111], v[252:255]
    s_waitcnt vmcnt(9)
    buffer_store_dwordx4 v[44:47], v57, s[4:7], s29 offen sc1
    v_mfma_f32_16x16x32_bf16 v[236:239], v[88:91], v[144:147], v[236:239]
    buffer_store_dwordx4 v[44:47], v58, s[4:7], s29 offen sc1
    v_mfma_f32_16x16x32_bf16 v[236:239], v[128:131], v[148:151], v[236:239]
    ds_read_b128 v[96:99], v2 offset:12288
    ds_read_b128 v[100:103], v2 offset:13312
    v_mfma_f32_16x16x32_bf16 v[240:243], v[112:115], v[144:147], v[240:243]
    ds_read_b128 v[104:107], v2 offset:14336
    ds_read_b128 v[108:111], v2 offset:15360
    v_mfma_f32_16x16x32_bf16 v[240:243], v[132:135], v[148:151], v[240:243]
    ds_read_b128 a[160:163], v2 offset:16384
    ds_read_b128 a[164:167], v2 offset:17408
    v_mfma_f32_16x16x32_bf16 v[244:247], v[116:119], v[144:147], v[244:247]
    ds_read_b128 a[168:171], v2 offset:18432
    ds_read_b128 a[172:175], v2 offset:19456
    v_mfma_f32_16x16x32_bf16 v[244:247], v[136:139], v[148:151], v[244:247]
    ds_read_b128 a[176:179], v2 offset:20480
    ds_read_b128 a[180:183], v2 offset:21504
    s_waitcnt lgkmcnt(10)
    v_mfma_f32_16x16x32_bf16 v[248:251], v[120:123], v[144:147], v[248:251]
    v_add_f32 v24, v176, v196
    v_add_f32 v25, v177, v197
    v_mfma_f32_16x16x32_bf16 v[248:251], v[140:143], v[148:151], v[248:251]
    v_add_f32 v26, v178, v198
    v_add_f32 v24, v24, v216
    v_mfma_f32_16x16x32_bf16 v[252:255], v[124:127], v[144:147], v[252:255]
    v_add_f32 v27, v179, v199
    v_add_f32 v25, v25, v217
    v_mfma_f32_16x16x32_bf16 v[252:255], v[64:67], v[148:151], v[252:255]
    s_waitcnt vmcnt(7)
    v_add_f32 v26, v26, v218
    v_add_f32 v28, v180, v200
    v_mfma_f32_16x16x32_bf16 v[236:239], v[68:71], v[152:155], v[236:239]
    v_add_f32 v27, v27, v219
    v_add_f32 v29, v181, v201
    v_mfma_f32_16x16x32_bf16 v[236:239], v[172:175], v[156:159], v[236:239]
    v_add_f32 v30, v182, v202
    v_add_f32 v28, v28, v220
    v_mfma_f32_16x16x32_bf16 v[240:243], v[72:75], v[152:155], v[240:243]
    v_add_f32 v31, v183, v203
    v_add_f32 v29, v29, v221
    v_mfma_f32_16x16x32_bf16 v[240:243], a[184:187], v[156:159], v[240:243]
    v_add_f32 v30, v30, v222
    v_add_f32 v32, v184, v204
    v_mfma_f32_16x16x32_bf16 v[244:247], v[160:163], v[152:155], v[244:247]
    v_add_f32 v33, v185, v205
    v_add_f32 v31, v31, v223
    v_mfma_f32_16x16x32_bf16 v[244:247], a[188:191], v[156:159], v[244:247]
    v_add_f32 v34, v186, v206
    v_add_f32 v32, v32, v224
    v_mfma_f32_16x16x32_bf16 v[248:251], v[164:167], v[152:155], v[248:251]
    v_add_f32 v33, v33, v225
    v_add_f32 v35, v187, v207
    v_mfma_f32_16x16x32_bf16 v[248:251], a[192:195], v[156:159], v[248:251]
    v_add_f32 v36, v188, v208
    v_add_f32 v34, v34, v226
    v_mfma_f32_16x16x32_bf16 v[252:255], v[168:171], v[152:155], v[252:255]
    s_waitcnt lgkmcnt(0)
    v_add_f32 v37, v189, v209
    v_add_f32 v35, v35, v227
    v_mfma_f32_16x16x32_bf16 v[252:255], a[196:199], v[156:159], v[252:255]
    s_waitcnt vmcnt(3)
    v_add_f32 v36, v36, v228
    v_add_f32 v38, v190, v210
    v_mfma_f32_16x16x32_bf16 v[236:239], v[96:99], v[48:51], v[236:239]
    v_add_f32 v37, v37, v229
    v_add_f32 v39, v191, v211
    v_mfma_f32_16x16x32_bf16 v[236:239], a[164:167], v[52:55], v[236:239]
    v_add_f32 v40, v192, v212
    v_add_f32 v38, v38, v230
    v_mfma_f32_16x16x32_bf16 v[240:243], v[100:103], v[48:51], v[240:243]
    v_add_f32 v41, v193, v213
    v_add_f32 v39, v39, v231
    v_mfma_f32_16x16x32_bf16 v[240:243], a[168:171], v[52:55], v[240:243]
    v_add_f32 v40, v40, v232
    v_add_f32 v42, v194, v214
    v_mfma_f32_16x16x32_bf16 v[244:247], v[104:107], v[48:51], v[244:247]
    v_add_f32 v43, v195, v215
    v_add_f32 v41, v41, v233
    v_mfma_f32_16x16x32_bf16 v[244:247], a[172:175], v[52:55], v[244:247]
    v_add_f32 v42, v42, v234
    v_add_f32 v43, v43, v235
    v_mfma_f32_16x16x32_bf16 v[248:251], v[108:111], v[48:51], v[248:251]
    s_branch .Lps4322
.Lpd4322:
    s_branch hop1_ret
.Lps4322:
    v_mfma_f32_16x16x32_bf16 v[248:251], a[176:179], v[52:55], v[248:251]
    v_mfma_f32_16x16x32_bf16 v[252:255], a[160:163], v[48:51], v[252:255]
    v_mfma_f32_16x16x32_bf16 v[252:255], a[180:183], v[52:55], v[252:255]
    v_pk_add_f32 v[24:25], v[24:25], v[236:237]
    v_pk_add_f32 v[26:27], v[26:27], v[238:239]
    v_pk_add_f32 v[28:29], v[28:29], v[240:241]
    v_pk_add_f32 v[30:31], v[30:31], v[242:243]
    v_pk_add_f32 v[32:33], v[32:33], v[244:245]
    v_pk_add_f32 v[34:35], v[34:35], v[246:247]
    v_pk_add_f32 v[36:37], v[36:37], v[248:249]
    v_pk_add_f32 v[38:39], v[38:39], v[250:251]
    v_pk_add_f32 v[40:41], v[40:41], v[252:253]
    v_pk_add_f32 v[42:43], v[42:43], v[254:255]
    v_pk_add_f32 v[96:97], v[24:25], v[26:27]
    v_pk_mul_f32 v[98:99], v[24:25], v[24:25]
    v_pk_fma_f32 v[98:99], v[26:27], v[26:27], v[98:99]
    v_pk_add_f32 v[96:97], v[96:97], v[28:29]
    v_pk_fma_f32 v[98:99], v[28:29], v[28:29], v[98:99]
    v_pk_add_f32 v[96:97], v[96:97], v[30:31]
    v_pk_fma_f32 v[98:99], v[30:31], v[30:31], v[98:99]
    v_pk_add_f32 v[96:97], v[96:97], v[32:33]
    v_pk_fma_f32 v[98:99], v[32:33], v[32:33], v[98:99]
    v_pk_add_f32 v[96:97], v[96:97], v[34:35]
    v_pk_fma_f32 v[98:99], v[34:35], v[34:35], v[98:99]
    v_pk_add_f32 v[96:97], v[96:97], v[36:37]
    v_pk_fma_f32 v[98:99], v[36:37], v[36:37], v[98:99]
    v_pk_add_f32 v[96:97], v[96:97], v[38:39]
    v_pk_fma_f32 v[98:99], v[38:39], v[38:39], v[98:99]
    v_pk_add_f32 v[96:97], v[96:97], v[40:41]
    v_pk_fma_f32 v[98:99], v[40:41], v[40:41], v[98:99]
    v_pk_add_f32 v[96:97], v[96:97], v[42:43]
    v_pk_fma_f32 v[98:99], v[42:43], v[42:43], v[98:99]
    v_add_f32 v96, v96, v97
    v_add_f32 v97, v98, v99
    v_mov_b32 v98, v96
    v_mov_b32 v99, v97
    v_cvt_pk_bf16_f32 v64, v24, v25
    v_permlane16_swap_b32 v96, v98
    v_permlane16_swap_b32 v97, v99
    v_add_f32 v96, v96, v98
    v_add_f32 v97, v97, v99
    v_mov_b32 v98, v96
    v_mov_b32 v99, v97
    v_cvt_pk_bf16_f32 v65, v26, v27
    v_permlane32_swap_b32 v96, v98
    v_permlane32_swap_b32 v97, v99
    v_add_f32 v96, v96, v98
    v_add_f32 v97, v97, v99
    v_min_u32 v96, -2, v96
    v_min_u32 v97, -2, v97
    buffer_store_dwordx2 v[96:97], v20, s[4:7], s36 offen sc1
    s_lshr_b32 s3, s18, 2
    s_sub_u32 s3, s18, s3
    s_mul_i32 s48, s18, 6
    s_add_u32 s3, s3, s48
    s_mul_i32 s3, s3, 40960
    v_add_u32 v11, s3, v14
    s_mul_i32 s3, s20, 276480
    s_mul_i32 s48, s16, 61440
    s_add_u32 s3, s3, s48
    s_add_u32 s3, s3, 0x440000
    v_add_u32 v15, s3, v14
    s_mul_i32 s44, s16, 11264
    v_cvt_pk_bf16_f32 v66, v28, v29
    v_cvt_pk_bf16_f32 v67, v30, v31
    v_cvt_pk_bf16_f32 v68, v32, v33
    v_cvt_pk_bf16_f32 v69, v34, v35
    v_cvt_pk_bf16_f32 v70, v36, v37
    v_cvt_pk_bf16_f32 v71, v38, v39
    v_cvt_pk_bf16_f32 v72, v40, v41
    v_cvt_pk_bf16_f32 v73, v42, v43
    buffer_store_dwordx4 v[64:67], v18, s[4:7], s32 offen sc1
    buffer_store_dwordx4 v[68:71], v18, s[4:7], s32 offen offset:128 sc1
    v_mov_b32 v104, v72
    v_mov_b32 v105, v73
    v_mov_b32 v106, v72
    v_mov_b32 v107, v73
    v_bfe_u32 v108, v0, 4, 1
    v_lshl_add_u32 v108, v108, 31, v19
    v_permlane16_swap_b32 v104, v106
    v_permlane16_swap_b32 v105, v107
    buffer_store_dwordx4 v[104:107], v108, s[4:7], s32 offen sc1
    v_and_b32 v44, 15, v0
    v_bfe_u32 v45, v0, 2, 2
    v_sub_u32 v44, v44, v45
    v_cvt_f32_u32 v44, v44
    v_mul_f32 v44, 0x3acccccd, v44
    s_lshl_b32 s3, s16, 3
    v_cos_f32 v46, v44
    v_cvt_f32_u32 v45, s3
    v_lshrrev_b32 v47, 4, v0
    v_cvt_f32_u32 v47, v47
    v_fmamk_f32 v45, v47, 0x42000000, v45
    v_mul_f32 v45, v44, v45
    v_add_f32 v46, v46, v46
    v_fmamk_f32 v237, v44, 0x00000000, v45
    v_cos_f32 v236, v237
    v_sin_f32 v237, v237
    v_fmamk_f32 v239, v44, 0x43000000, v45
    v_cos_f32 v238, v239
    v_sin_f32 v239, v239
    v_fmamk_f32 v241, v44, 0x43800000, v45
    v_cos_f32 v240, v241
    v_sin_f32 v241, v241
    v_fmamk_f32 v243, v44, 0x43c00000, v45
    v_cos_f32 v242, v243
    v_sin_f32 v243, v243
    v_fmamk_f32 v245, v44, 0x44000000, v45
    v_cos_f32 v244, v245
    v_sin_f32 v245, v245
    v_cvt_pk_bf16_f32 v112, v236, v238
    v_cvt_pk_bf16_f32 v113, v240, v242
    v_cvt_pk_bf16_f32 v114, v244, 0
    v_cvt_pk_bf16_f32 v116, v237, v239
    v_cvt_pk_bf16_f32 v117, v241, v243
    v_cvt_pk_bf16_f32 v118, v245, 0
    v_fmamk_f32 v247, v44, 0x3f800000, v45
    v_cos_f32 v246, v247
    v_sin_f32 v247, v247
    v_fmamk_f32 v249, v44, 0x43010000, v45
    v_cos_f32 v248, v249
    v_sin_f32 v249, v249
    v_fmamk_f32 v251, v44, 0x43808000, v45
    v_cos_f32 v250, v251
    v_sin_f32 v251, v251
    v_fmamk_f32 v253, v44, 0x43c08000, v45
    v_cos_f32 v252, v253
    v_sin_f32 v253, v253
    v_fmamk_f32 v255, v44, 0x44004000, v45
    v_cos_f32 v254, v255
    v_sin_f32 v255, v255
    v_cvt_pk_bf16_f32 v120, v246, v248
    v_cvt_pk_bf16_f32 v121, v250, v252
    v_cvt_pk_bf16_f32 v122, v254, 0
    v_cvt_pk_bf16_f32 v124, v247, v249
    v_cvt_pk_bf16_f32 v125, v251, v253
    v_cvt_pk_bf16_f32 v126, v255, 0
    v_pk_fma_f32 v[236:237], v[46:47], v[246:247], v[236:237] op_sel_hi:[0,1,1] neg_lo:[0,0,1] neg_hi:[0,0,1]
    v_pk_fma_f32 v[238:239], v[46:47], v[248:249], v[238:239] op_sel_hi:[0,1,1] neg_lo:[0,0,1] neg_hi:[0,0,1]
    v_pk_fma_f32 v[240:241], v[46:47], v[250:251], v[240:241] op_sel_hi:[0,1,1] neg_lo:[0,0,1] neg_hi:[0,0,1]
    v_pk_fma_f32 v[242:243], v[46:47], v[252:253], v[242:243] op_sel_hi:[0,1,1] neg_lo:[0,0,1] neg_hi:[0,0,1]
    v_pk_fma_f32 v[244:245], v[46:47], v[254:255], v[244:245] op_sel_hi:[0,1,1] neg_lo:[0,0,1] neg_hi:[0,0,1]
    v_cvt_pk_bf16_f32 v128, v236, v238
    v_cvt_pk_bf16_f32 v129, v240, v242
    v_cvt_pk_bf16_f32 v130, v244, 0
    v_cvt_pk_bf16_f32 v132, v237, v239
    v_cvt_pk_bf16_f32 v133, v241, v243
    v_cvt_pk_bf16_f32 v134, v245, 0
    v_pk_fma_f32 v[246:247], v[46:47], v[236:237], v[246:247] op_sel_hi:[0,1,1] neg_lo:[0,0,1] neg_hi:[0,0,1]
    v_pk_fma_f32 v[248:249], v[46:47], v[238:239], v[248:249] op_sel_hi:[0,1,1] neg_lo:[0,0,1] neg_hi:[0,0,1]
    v_pk_fma_f32 v[250:251], v[46:47], v[240:241], v[250:251] op_sel_hi:[0,1,1] neg_lo:[0,0,1] neg_hi:[0,0,1]
    v_pk_fma_f32 v[252:253], v[46:47], v[242:243], v[252:253] op_sel_hi:[0,1,1] neg_lo:[0,0,1] neg_hi:[0,0,1]
    v_pk_fma_f32 v[254:255], v[46:47], v[244:245], v[254:255] op_sel_hi:[0,1,1] neg_lo:[0,0,1] neg_hi:[0,0,1]
    v_cvt_pk_bf16_f32 v136, v246, v248
    v_cvt_pk_bf16_f32 v137, v250, v252
    v_cvt_pk_bf16_f32 v138, v254, 0
    v_cvt_pk_bf16_f32 v140, v247, v249
    v_cvt_pk_bf16_f32 v141, v251, v253
    v_cvt_pk_bf16_f32 v142, v255, 0
    v_pk_fma_f32 v[236:237], v[46:47], v[246:247], v[236:237] op_sel_hi:[0,1,1] neg_lo:[0,0,1] neg_hi:[0,0,1]
    v_pk_fma_f32 v[238:239], v[46:47], v[248:249], v[238:239] op_sel_hi:[0,1,1] neg_lo:[0,0,1] neg_hi:[0,0,1]
    v_pk_fma_f32 v[240:241], v[46:47], v[250:251], v[240:241] op_sel_hi:[0,1,1] neg_lo:[0,0,1] neg_hi:[0,0,1]
    v_pk_fma_f32 v[242:243], v[46:47], v[252:253], v[242:243] op_sel_hi:[0,1,1] neg_lo:[0,0,1] neg_hi:[0,0,1]
    v_pk_fma_f32 v[244:245], v[46:47], v[254:255], v[244:245] op_sel_hi:[0,1,1] neg_lo:[0,0,1] neg_hi:[0,0,1]
    v_cvt_pk_bf16_f32 v144, v236, v238
    v_cvt_pk_bf16_f32 v145, v240, v242
    v_cvt_pk_bf16_f32 v146, v244, 0
    v_cvt_pk_bf16_f32 v148, v237, v239
    v_cvt_pk_bf16_f32 v149, v241, v243
    v_cvt_pk_bf16_f32 v150, v245, 0
    v_pk_fma_f32 v[246:247], v[46:47], v[236:237], v[246:247] op_sel_hi:[0,1,1] neg_lo:[0,0,1] neg_hi:[0,0,1]
    v_pk_fma_f32 v[248:249], v[46:47], v[238:239], v[248:249] op_sel_hi:[0,1,1] neg_lo:[0,0,1] neg_hi:[0,0,1]
    v_pk_fma_f32 v[250:251], v[46:47], v[240:241], v[250:251] op_sel_hi:[0,1,1] neg_lo:[0,0,1] neg_hi:[0,0,1]
    v_pk_fma_f32 v[252:253], v[46:47], v[242:243], v[252:253] op_sel_hi:[0,1,1] neg_lo:[0,0,1] neg_hi:[0,0,1]
    v_pk_fma_f32 v[254:255], v[46:47], v[244:245], v[254:255] op_sel_hi:[0,1,1] neg_lo:[0,0,1] neg_hi:[0,0,1]
    v_cvt_pk_bf16_f32 v152, v246, v248
    v_cvt_pk_bf16_f32 v153, v250, v252
    v_cvt_pk_bf16_f32 v154, v254, 0
    v_cvt_pk_bf16_f32 v156, v247, v249
    v_cvt_pk_bf16_f32 v157, v251, v253
    v_cvt_pk_bf16_f32 v158, v255, 0
    v_pk_fma_f32 v[236:237], v[46:47], v[246:247], v[236:237] op_sel_hi:[0,1,1] neg_lo:[0,0,1] neg_hi:[0,0,1]
    v_pk_fma_f32 v[238:239], v[46:47], v[248:249], v[238:239] op_sel_hi:[0,1,1] neg_lo:[0,0,1] neg_hi:[0,0,1]
    v_pk_fma_f32 v[240:241], v[46:47], v[250:251], v[240:241] op_sel_hi:[0,1,1] neg_lo:[0,0,1] neg_hi:[0,0,1]
    v_pk_fma_f32 v[242:243], v[46:47], v[252:253], v[242:243] op_sel_hi:[0,1,1] neg_lo:[0,0,1] neg_hi:[0,0,1]
    v_pk_fma_f32 v[244:245], v[46:47], v[254:255], v[244:245] op_sel_hi:[0,1,1] neg_lo:[0,0,1] neg_hi:[0,0,1]
    v_cvt_pk_bf16_f32 v160, v236, v238
    v_cvt_pk_bf16_f32 v161, v240, v242
    v_cvt_pk_bf16_f32 v162, v244, 0
    v_cvt_pk_bf16_f32 v164, v237, v239
    v_cvt_pk_bf16_f32 v165, v241, v243
    v_cvt_pk_bf16_f32 v166, v245, 0
    v_pk_fma_f32 v[246:247], v[46:47], v[236:237], v[246:247] op_sel_hi:[0,1,1] neg_lo:[0,0,1] neg_hi:[0,0,1]
    v_pk_fma_f32 v[248:249], v[46:47], v[238:239], v[248:249] op_sel_hi:[0,1,1] neg_lo:[0,0,1] neg_hi:[0,0,1]
    v_pk_fma_f32 v[250:251], v[46:47], v[240:241], v[250:251] op_sel_hi:[0,1,1] neg_lo:[0,0,1] neg_hi:[0,0,1]
    v_pk_fma_f32 v[252:253], v[46:47], v[242:243], v[252:253] op_sel_hi:[0,1,1] neg_lo:[0,0,1] neg_hi:[0,0,1]
    v_pk_fma_f32 v[254:255], v[46:47], v[244:245], v[254:255] op_sel_hi:[0,1,1] neg_lo:[0,0,1] neg_hi:[0,0,1]
    v_cvt_pk_bf16_f32 v168, v246, v248
    v_cvt_pk_bf16_f32 v169, v250, v252
    v_cvt_pk_bf16_f32 v170, v254, 0
    v_cvt_pk_bf16_f32 v172, v247, v249
    v_cvt_pk_bf16_f32 v173, v251, v253
    v_cvt_pk_bf16_f32 v174, v255, 0
    v_mov_b32 v115, 0
    v_mov_b32 v119, 0
    v_mov_b32 v123, 0
    v_mov_b32 v127, 0
    v_mov_b32 v131, 0
    v_mov_b32 v135, 0
    v_mov_b32 v139, 0
    v_mov_b32 v143, 0
    v_mov_b32 v147, 0
    v_mov_b32 v151, 0
    v_mov_b32 v155, 0
    v_mov_b32 v159, 0
    v_mov_b32 v163, 0
    v_mov_b32 v167, 0
    v_mov_b32 v171, 0
    v_mov_b32 v175, 0
    s_waitcnt vmcnt(3)
    buffer_load_dwordx2 v[96:97], v21, s[4:7], s35 offen sc1
    buffer_load_dwordx2 v[98:99], v21, s[4:7], s35 offen offset:128 sc1
    s_add_u32 m0, s44, 81920
    v_add_u32 v13, m0, v11
    buffer_load_dwordx4 v13, s[4:7], 0 offen offset:0 sc1 lds
    buffer_load_dwordx4 v13, s[4:7], 0 offen offset:1024 sc1 lds
    buffer_load_dwordx4 v13, s[4:7], 0 offen offset:2048 sc1 lds
    buffer_load_dwordx4 v13, s[4:7], 0 offen offset:3072 sc1 lds
    s_add_u32 m0, s44, 86016
    v_add_u32 v13, m0, v11
    buffer_load_dwordx4 v13, s[4:7], 0 offen offset:0 sc1 lds
    buffer_load_dwordx4 v13, s[4:7], 0 offen offset:1024 sc1 lds
    buffer_load_dwordx4 v13, s[4:7], 0 offen offset:2048 sc1 lds
    buffer_load_dwordx4 v13, s[4:7], 0 offen offset:3072 sc1 lds
    s_lshl_b32 s38, s17, 7
    s_add_u32 s38, s38, 0x2d8c000
    s_min_u32 s3, s16, 1
    s_lshl_b32 s3, s3, 31
    v_or_b32 v245, s3, v12
    v_mov_b32 v242, 1
    s_and_b32 s37, s2, 63
    s_lshl_b32 s37, s37, 7
    s_add_u32 s37, s37, 0x2d8e000
    s_mov_b32 s36, 0x2d8e000
    v_lshlrev_b32 v241, 7, v0
    v_mov_b32 v240, 1
    s_waitcnt vmcnt(8)
    v_max3_u32 v101, v96, v97, v98
    v_max_u32 v101, v101, v99
    v_cmp_eq_u32 vcc, -1, v101
    s_nop 4
    s_cbranch_vccnz st_slow
st_ok:
    v_pk_add_f32 v[110:111], v[96:97], v[98:99]
st_ok2:
    v_mov_b32 v102, v110
    v_mov_b32 v103, v111
    s_nop 0
    v_permlane16_swap_b32 v110, v102
    v_permlane16_swap_b32 v111, v103
    v_add_f32 v110, v110, v102
    v_add_f32 v111, v111, v103
    v_mov_b32 v102, v110
    v_mov_b32 v103, v111
    s_nop 0
    v_permlane32_swap_b32 v110, v102
    v_permlane32_swap_b32 v111, v103
    v_add_f32 v110, v110, v102
    v_add_f32 v111, v111, v103
    s_barrier
    buffer_atomic_add v242, v245, s[4:7], s38 offen sc0 sc1
    v_mul_f32 v62, 0xbacccccd, v110
    v_mul_f32 v60, 0x3acccccd, v111
    v_fma_f32 v60, -v62, v62, v60
    v_max_f32 v60, 0, v60
    v_add_f32 v60, 0x3727c5ac, v60
    v_rsq_f32 v60, v60
    s_nop 0
    v_mul_f32 v62, v62, v60
    s_add_u32 m0, s44, 90112
    v_add_u32 v13, m0, v11
    buffer_load_dwordx4 v13, s[4:7], 0 offen offset:0 sc1 lds
    v_pk_fma_f32 v[24:25], v[24:25], v[60:61], v[62:63] op_sel_hi:[1,0,0]
    v_pk_fma_f32 v[26:27], v[26:27], v[60:61], v[62:63] op_sel_hi:[1,0,0]
    v_pk_fma_f32 v[28:29], v[28:29], v[60:61], v[62:63] op_sel_hi:[1,0,0]
    v_pk_fma_f32 v[30:31], v[30:31], v[60:61], v[62:63] op_sel_hi:[1,0,0]
    v_pk_fma_f32 v[32:33], v[32:33], v[60:61], v[62:63] op_sel_hi:[1,0,0]
    v_pk_fma_f32 v[34:35], v[34:35], v[60:61], v[62:63] op_sel_hi:[1,0,0]
    v_pk_fma_f32 v[36:37], v[36:37], v[60:61], v[62:63] op_sel_hi:[1,0,0]
    v_pk_fma_f32 v[38:39], v[38:39], v[60:61], v[62:63] op_sel_hi:[1,0,0]
    v_pk_fma_f32 v[40:41], v[40:41], v[60:61], v[62:63] op_sel_hi:[1,0,0]
    v_pk_fma_f32 v[42:43], v[42:43], v[60:61], v[62:63] op_sel_hi:[1,0,0]
    v_cvt_pk_bf16_f32 v176, v24, v25
    v_cvt_pk_bf16_f32 v177, v26, v27
    buffer_load_dwordx4 v13, s[4:7], 0 offen offset:1024 sc1 lds
    v_cvt_pk_bf16_f32 v178, v28, v29
    v_cvt_pk_bf16_f32 v179, v30, v31
    v_cvt_pk_bf16_f32 v180, v32, v33
    v_cvt_pk_bf16_f32 v181, v34, v35
    v_cvt_pk_bf16_f32 v182, v36, v37
    v_cvt_pk_bf16_f32 v183, v38, v39
    v_cvt_pk_bf16_f32 v184, v40, v41
    v_cvt_pk_bf16_f32 v185, v42, v43
    ds_write_b64 v84, v[176:177] offset:0
    ds_write_b64 v84, v[178:179] offset:8
    ds_write_b64 v84, v[180:181] offset:16
    ds_write_b64 v84, v[182:183] offset:24
    ds_write_b64 v84, v[184:185] offset:32
    s_waitcnt lgkmcnt(0)
    buffer_load_dwordx4 v13, s[4:7], 0 offen offset:2048 sc1 lds
    s_barrier
    ds_read_b64_tr_b16 v[176:177], v85 offset:0
    ds_read_b64_tr_b16 v[178:179], v85 offset:336
    ds_read_b64_tr_b16 v[180:181], v85 offset:5376
    ds_read_b64_tr_b16 v[182:183], v85 offset:5712
    ds_read_b64_tr_b16 v[184:185], v85 offset:32
    ds_read_b64_tr_b16 v[186:187], v85 offset:368
    ds_read_b64_tr_b16 v[188:189], v85 offset:5408
    ds_read_b64_tr_b16 v[190:191], v85 offset:5744
    ds_read_b64_tr_b16 v[192:193], v85 offset:64
    ds_read_b64_tr_b16 v[194:195], v85 offset:400
    ds_read_b64_tr_b16 v[196:197], v85 offset:5440
    ds_read_b64_tr_b16 v[198:199], v85 offset:5776
    s_waitcnt lgkmcnt(10)
    v_mfma_f32_16x16x32_bf16 v[216:219], v[176:179], v[76:79], 0
    ds_read_b64_tr_b16 v[200:201], v85 offset:96
    ds_read_b64_tr_b16 v[202:203], v85 offset:432
    s_waitcnt lgkmcnt(10)
    v_mfma_f32_16x16x32_bf16 v[216:219], v[180:183], v[80:83], v[216:219]
    ds_read_b64_tr_b16 v[204:205], v85 offset:5472
    ds_read_b64_tr_b16 v[206:207], v85 offset:5808
    s_waitcnt lgkmcnt(10)
    v_mfma_f32_16x16x32_bf16 v[220:223], v[184:187], v[76:79], 0
    ds_read_b64_tr_b16 v[208:209], v85 offset:128
    ds_read_b64_tr_b16 v[210:211], v85 offset:464
    s_waitcnt lgkmcnt(10)
    v_mfma_f32_16x16x32_bf16 v[220:223], v[188:191], v[80:83], v[220:223]
    ds_read_b64_tr_b16 v[212:213], v85 offset:5504
    ds_read_b64_tr_b16 v[214:215], v85 offset:5840
    s_waitcnt lgkmcnt(10)
    v_mfma_f32_16x16x32_bf16 v[224:227], v[192:195], v[76:79], 0
    s_waitcnt lgkmcnt(8)
    v_mfma_f32_16x16x32_bf16 v[224:227], v[196:199], v[80:83], v[224:227]
    s_waitcnt lgkmcnt(6)
    v_mfma_f32_16x16x32_bf16 v[228:231], v[200:203], v[76:79], 0
    s_waitcnt lgkmcnt(4)
    v_mfma_f32_16x16x32_bf16 v[228:231], v[204:207], v[80:83], v[228:231]
    s_waitcnt lgkmcnt(2)
    v_mfma_f32_16x16x32_bf16 v[232:235], v[208:211], v[76:79], 0
    v_cvt_pk_bf16_f32 v24, v216, v217
    v_cvt_pk_bf16_f32 v25, v218, v219
    s_waitcnt lgkmcnt(0)
    v_mfma_f32_16x16x32_bf16 v[232:235], v[212:215], v[80:83], v[232:235]
    v_cvt_pk_bf16_f32 v26, v220, v221
    v_cvt_pk_bf16_f32 v27, v222, v223
    v_cvt_pk_bf16_f32 v28, v224, v225
    v_cvt_pk_bf16_f32 v29, v226, v227
    v_cvt_pk_bf16_f32 v30, v228, v229
    v_cvt_pk_bf16_f32 v31, v230, v231
    s_nop 1
    v_cvt_pk_bf16_f32 v32, v232, v233
    v_cvt_pk_bf16_f32 v33, v234, v235
    s_waitcnt vmcnt(3)
    v_readfirstlane_b32 s48, v242
    s_nop 1
    s_cmp_lg_u32 s48, 15
    s_cbranch_scc1 a2a_notlast1
    buffer_atomic_add v240, v241, s[4:7], s36 offen sc1
a2a_notlast1:
    ds_write_b64 v86, v[24:25] offset:0
    ds_write_b64 v86, v[26:27] offset:64
    ds_write_b64 v86, v[28:29] offset:128
    ds_write_b64 v86, v[30:31] offset:192
    ds_write_b64 v86, v[32:33] offset:256
    ds_read_b128 v[176:179], v87 offset:0
    ds_read_b128 v[180:183], v94 offset:0
    ds_read_b128 v[184:187], v95 offset:0
    v_mov_b32 v242, 0
    buffer_atomic_add v242, v245, s[4:7], s37 offen sc0 sc1
    s_waitcnt lgkmcnt(2)
    buffer_store_dwordx4 v[176:179], v56, s[4:7], s29 offen sc1
    s_waitcnt lgkmcnt(1)
    buffer_store_dwordx4 v[180:183], v57, s[4:7], s29 offen sc1
    s_waitcnt lgkmcnt(0)
    buffer_store_dwordx4 v[184:187], v58, s[4:7], s29 offen sc1
    s_lshr_b32 s24, s18, 2
    s_sub_u32 s3, 3, s24
    s_cmp_gt_u32 s17, 8
    s_cselect_b32 s24, s3, s24
    s_and_b32 s3, s24, 1
    s_lshl_b32 s25, s17, 1
    s_add_u32 s25, s25, s3
    s_lshl_b32 s25, s25, 1
    s_lshr_b32 s3, s24, 1
    s_add_u32 s25, s25, s3
    s_lshl_b32 s24, s24, 4
    s_add_u32 s24, s24, s17
    s_sub_u32 s3, 64, s24
    s_min_u32 s3, s3, s24
    s_and_b32 s3, s3, 31
    s_mul_i32 s3, s3, 81920
    s_add_u32 s3, s3, 0x1c00000
    v_add_u32 v252, s3, v14
    s_mul_i32 s27, s16, 10240
    s_and_b32 s26, s18, 3
    s_lshl_b32 s28, s25, 2
    s_add_u32 s28, s28, s26
    s_mul_i32 s3, s28, 10240
    s_add_u32 s3, s3, 0x1e5b000
    v_add_u32 v253, s3, v14
    s_mul_i32 s29, s16, 2560
    v_mov_b32 v243, 0
    buffer_atomic_add v243, v245, s[4:7], s37 offen sc0 sc1
    s_cmp_lt_u32 s24, 32
    s_cselect_b32 s30, 0xbe800000, 0
    s_cmp_gt_u32 s24, 32
    s_cselect_b32 s30, 0x3e800000, s30
    s_cmp_eq_u32 s24, 0
    s_cselect_b32 s31, 0xffff, -1
    s_cmp_eq_u32 s24, 32
    s_cselect_b32 s31, 0xffff0000, s31
    v_and_b32 v196, 31, v0
    s_lshr_b32 s3, s16, 1
    v_add_u32 v196, s3, v196
    v_cvt_f32_u32 v196, v196
    v_mul_f32 v196, 0x3d000000, v196
    s_and_b32 s3, s16, 1
    s_lshl_b32 s3, s3, 4
    v_cos_f32 v198, v196
    v_lshrrev_b32 v197, 5, v0
    v_lshl_add_u32 v197, v197, 3, s3
    v_cvt_f32_u32 v197, v197
    v_mul_f32 v177, v196, v197
    v_add_f32 v179, v177, v196
    v_add_f32 v198, v198, v198
    v_cos_f32 v176, v177
    v_sin_f32 v177, v177
    v_cos_f32 v178, v179
    v_sin_f32 v179, v179
    v_mov_b32 v244, 0
    buffer_atomic_add v244, v245, s[4:7], s37 offen sc0 sc1
    s_lshl_b32 s3, s16, 11
    v_add_u32 v251, 0x1f000, v14
    v_add_u32 v197, s3, v251
    v_pk_fma_f32 v[180:181], v[198:199], v[178:179], v[176:177] op_sel_hi:[0,1,1] neg_lo:[0,0,1] neg_hi:[0,0,1]
    v_pk_fma_f32 v[182:183], v[198:199], v[180:181], v[178:179] op_sel_hi:[0,1,1] neg_lo:[0,0,1] neg_hi:[0,0,1]
    v_pk_fma_f32 v[184:185], v[198:199], v[182:183], v[180:181] op_sel_hi:[0,1,1] neg_lo:[0,0,1] neg_hi:[0,0,1]
    v_pk_fma_f32 v[186:187], v[198:199], v[184:185], v[182:183] op_sel_hi:[0,1,1] neg_lo:[0,0,1] neg_hi:[0,0,1]
    v_pk_fma_f32 v[188:189], v[198:199], v[186:187], v[184:185] op_sel_hi:[0,1,1] neg_lo:[0,0,1] neg_hi:[0,0,1]
    v_pk_fma_f32 v[190:191], v[198:199], v[188:189], v[186:187] op_sel_hi:[0,1,1] neg_lo:[0,0,1] neg_hi:[0,0,1]
    v_cvt_pk_bf16_f32 v24, v176, v178
    v_cvt_pk_bf16_f32 v25, v180, v182
    v_cvt_pk_bf16_f32 v26, v184, v186
    v_cvt_pk_bf16_f32 v27, v188, v190
    ds_write_b128 v197, v[24:27] offset:0
    v_cvt_pk_bf16_f32 v28, v177, v179
    v_cvt_pk_bf16_f32 v29, v181, v183
    v_cvt_pk_bf16_f32 v30, v185, v187
    v_cvt_pk_bf16_f32 v31, v189, v191
    ds_write_b128 v197, v[28:31] offset:1024
    s_lshl_b32 s3, s26, 9
    s_add_u32 s3, s3, s24
    v_bfe_u32 v196, v0, 1, 3
    v_lshl_add_u32 v196, v196, 6, s3
    v_cvt_f32_u32 v196, v196
    v_mul_f32 v196, 0x3a000000, v196
    v_lshrrev_b32 v197, 4, v0
    v_cvt_f32_u32 v201, v197
    v_add_f32 v197, v201, v201
    s_waitcnt lgkmcnt(0)
    s_cmp_eq_u32 s16, 1
    s_cbranch_scc1 hop2_1
    s_cmp_eq_u32 s16, 2
    s_cbranch_scc1 hop2_2
    s_cmp_eq_u32 s16, 3
    s_cbranch_scc1 hop2_3
    s_waitcnt vmcnt(5)
    v_readfirstlane_b32 s48, v242
    s_nop 1
    s_bitcmp1_b32 s48, 4
    s_cbranch_scc0 a2a1_slow
a2a1_ok:
hop2_ret:
    s_barrier
    s_add_u32 m0, s27, 0
    v_add_u32 v13, m0, v252
    buffer_load_dwordx4 v13, s[4:7], 0 offen offset:0 sc1 lds
    buffer_load_dwordx4 v13, s[4:7], 0 offen offset:1024 sc1 lds
    buffer_load_dwordx4 v13, s[4:7], 0 offen offset:2048 sc1 lds
    buffer_load_dwordx4 v13, s[4:7], 0 offen offset:3072 sc1 lds
    s_add_u32 m0, s27, 4096
    v_add_u32 v13, m0, v252
    buffer_load_dwordx4 v13, s[4:7], 0 offen offset:0 sc1 lds
    buffer_load_dwordx4 v13, s[4:7], 0 offen offset:1024 sc1 lds
    buffer_load_dwordx4 v13, s[4:7], 0 offen offset:2048 sc1 lds
    buffer_load_dwordx4 v13, s[4:7], 0 offen offset:3072 sc1 lds
    s_add_u32 m0, s27, 8192
    v_add_u32 v13, m0, v252
    buffer_load_dwordx4 v13, s[4:7], 0 offen offset:0 sc1 lds
    buffer_load_dwordx4 v13, s[4:7], 0 offen offset:1024 sc1 lds
    s_add_u32 m0, s27, 40960
    v_add_u32 v13, m0, v252
    buffer_load_dwordx4 v13, s[4:7], 0 offen offset:0 sc1 lds
    v_and_b32 v198, 1, v0
    v_cvt_f32_u32 v198, v198
    v_mul_f32 v198, 0x3e800000, v198
    v_fma_f32 v197, v196, v197, v198
    v_fmamk_f32 v16, v196, 0x00000000, v197
    v_add_f32 v176, s30, v16
    v_cos_f32 v16, v16
    v_cos_f32 v176, v176
    v_fmamk_f32 v17, v196, 0x3f800000, v197
    v_add_f32 v177, s30, v17
    v_cos_f32 v17, v17
    v_cos_f32 v177, v177
    v_fmamk_f32 v18, v196, 0x41000000, v197
    v_add_f32 v178, s30, v18
    v_cos_f32 v18, v18
    v_cos_f32 v178, v178
    v_fmamk_f32 v19, v196, 0x41100000, v197
    v_add_f32 v179, s30, v19
    v_cos_f32 v19, v19
    v_cos_f32 v179, v179
    v_fmamk_f32 v20, v196, 0x41800000, v197
    v_add_f32 v180, s30, v20
    v_cos_f32 v20, v20
    v_cos_f32 v180, v180
    v_fmamk_f32 v21, v196, 0x41880000, v197
    v_add_f32 v181, s30, v21
    v_cos_f32 v21, v21
    v_cos_f32 v181, v181
    v_fmamk_f32 v22, v196, 0x41c00000, v197
    v_add_f32 v182, s30, v22
    v_cos_f32 v22, v22
    v_cos_f32 v182, v182
    v_fmamk_f32 v23, v196, 0x41c80000, v197
    v_add_f32 v183, s30, v23
    v_cos_f32 v23, v23
    v_cos_f32 v183, v183
    v_cvt_pk_bf16_f32 v16, v16, v176
    v_and_b32 v16, s31, v16
    buffer_load_dwordx4 v13, s[4:7], 0 offen offset:1024 sc1 lds
    v_cvt_pk_bf16_f32 v17, v17, v177
    v_and_b32 v17, s31, v17
    v_cvt_pk_bf16_f32 v18, v18, v178
    v_and_b32 v18, s31, v18
    v_cvt_pk_bf16_f32 v19, v19, v179
    v_and_b32 v19, s31, v19
    v_cvt_pk_bf16_f32 v20, v20, v180
    v_and_b32 v20, s31, v20
    v_cvt_pk_bf16_f32 v21, v21, v181
    v_and_b32 v21, s31, v21
    v_cvt_pk_bf16_f32 v22, v22, v182
    v_and_b32 v22, s31, v22
    v_cvt_pk_bf16_f32 v23, v23, v183
    v_and_b32 v23, s31, v23
    v_lshrrev_b32 v196, 3, v0
    buffer_load_dwordx4 v13, s[4:7], 0 offen offset:2048 sc1 lds
    v_mul_u32_u24 v197, 2560, v196
    v_bfe_u32 v198, v0, 2, 1
    v_lshl_add_u32 v197, v198, 3, v197
    v_and_b32 v198, 3, v0
    v_lshl_add_u32 v197, v198, 7, v197
    v_and_b32 v196, 3, v196
    v_and_b32 v198, 2, v0
    v_lshl_or_b32 v196, v198, 1, v196
    s_lshl_b32 s3, s16, 1
    v_xor_b32 v196, s3, v196
    v_lshl_add_u32 v1, v196, 4, v197
    v_xor_b32 v2, 16, v1
    ds_read_b128 v[24:27], v251 offset:0
    ds_read_b128 v[32:35], v251 offset:1024
    ds_read_b128 v[28:31], v251 offset:2048
    buffer_load_dwordx4 v13, s[4:7], 0 offen offset:3072 sc1 lds
    ds_read_b128 v[36:39], v251 offset:3072
    ds_read_b128 v[48:51], v251 offset:4096
    ds_read_b128 v[56:59], v251 offset:5120
    ds_read_b128 v[52:55], v251 offset:6144
    ds_read_b128 v[60:63], v251 offset:7168
    s_lshl_b32 s3, s16, 1
    v_and_b32 v198, 31, v0
    v_lshrrev_b32 v200, 5, v0
    v_add_u32 v199, s3, v200
    v_lshrrev_b32 v196, 1, v198
    v_mul_u32_u24 v196, 640, v196
    v_and_b32 v197, 1, v198
    v_and_b32 v9, 7, v198
    v_xor_b32 v9, v9, v199
    v_lshl_add_u32 v9, v9, 4, v196
    s_add_u32 m0, s27, 45056
    v_add_u32 v13, m0, v252
    buffer_load_dwordx4 v13, s[4:7], 0 offen offset:0 sc1 lds
    v_and_b32 v10, 6, v198
    v_xor_b32 v10, v10, v199
    v_lshl_add_u32 v10, v10, 4, v196
    v_lshl_add_u32 v10, v197, 3, v10
    v_add_u32 v10, 256, v10
    v_mul_u32_u24 v197, 384, v197
    v_add_u32 v9, v9, v197
    v_add_u32 v9, 0x25000, v9
    v_add_u32 v10, 0x25000, v10
    v_bfe_u32 v197, v0, 3, 2
    v_cmp_eq_u32 vcc, 3, v197
    v_bfe_u32 v196, v0, 2, 1
    v_add_u32 v196, s3, v196
    buffer_load_dwordx4 v13, s[4:7], 0 offen offset:1024 sc1 lds
    v_and_b32 v198, 3, v0
    v_cndmask_b32_e64 v197, v197, 0, vcc
    v_lshl_add_u32 v197, v197, 2, v198
    v_mad_u32_u24 v198, v196, 12, v197
    v_lshlrev_b32 v198, 7, v198
    v_lshrrev_b32 v197, 1, v197
    v_and_b32 v196, 3, v196
    v_xor_b32 v196, v196, v197
    v_xor_b32 v196, v196, v200
    v_lshl_add_u32 v196, v196, 4, v198
    v_add_u32 v5, 0x1f000, v196
    v_xor_b32 v6, 32, v5
    v_xor_b32 v7, 64, v5
    v_xor_b32 v8, 96, v5
    v_bfe_u32 v196, v0, 1, 3
    buffer_load_dwordx4 v13, s[4:7], 0 offen offset:2048 sc1 lds
    v_lshrrev_b32 v197, 4, v0
    v_mul_u32_u24 v197, 3, v197
    v_mad_u32_u24 v198, v196, 12, v197
    v_lshlrev_b32 v198, 7, v198
    v_add_u32 v198, 0x1f000, v198
    v_and_b32 v196, 3, v196
    v_and_b32 v199, 1, v0
    v_lshl_or_b32 v199, v199, 2, s16
    v_xor_b32 v196, v196, v199
    v_lshrrev_b32 v199, 1, v197
    v_xor_b32 v199, v199, v196
    v_lshl_add_u32 v3, v199, 4, v198
    v_add_u32 v197, 1, v197
    v_lshrrev_b32 v199, 1, v197
    v_xor_b32 v199, v199, v196
    buffer_load_dwordx4 v13, s[4:7], 0 offen offset:3072 sc1 lds
    v_lshl_add_u32 v4, v199, 4, v198
    v_add_u32 v197, 1, v197
    v_lshrrev_b32 v199, 1, v197
    v_xor_b32 v199, v199, v196
    v_lshl_add_u32 v255, v199, 4, v198
    s_mul_i32 s35, s16, 5120
    s_waitcnt lgkmcnt(6)
    v_xor_b32 v40, 0x80008000, v32
    v_xor_b32 v41, 0x80008000, v33
    v_xor_b32 v42, 0x80008000, v34
    v_xor_b32 v43, 0x80008000, v35
    s_waitcnt lgkmcnt(4)
    s_branch .Lps4972
hop2_1:
.Lpd4972:
    s_branch .Lpd6794
.Lps4972:
    v_xor_b32 v44, 0x80008000, v36
    v_xor_b32 v45, 0x80008000, v37
    v_xor_b32 v46, 0x80008000, v38
    v_xor_b32 v47, 0x80008000, v39
    s_waitcnt lgkmcnt(3)
    v_xor_b32 v64, 0x80008000, v48
    s_add_u32 m0, s27, 49152
    v_add_u32 v13, m0, v252
    buffer_load_dwordx4 v13, s[4:7], 0 offen offset:0 sc1 lds
    v_xor_b32 v65, 0x80008000, v49
    v_xor_b32 v66, 0x80008000, v50
    v_xor_b32 v67, 0x80008000, v51
    s_waitcnt lgkmcnt(1)
    v_xor_b32 v68, 0x80008000, v52
    v_xor_b32 v69, 0x80008000, v53
    v_xor_b32 v70, 0x80008000, v54
    v_xor_b32 v71, 0x80008000, v55
    s_mul_i32 s3, s16, 20
    v_lshrrev_b32 v196, 3, v0
    v_add_u32 v196, s3, v196
    v_mul_u32_u24 v197, 205, v196
    v_lshrrev_b32 v197, 9, v197
    v_xor_b32 v197, v197, v0
    buffer_load_dwordx4 v13, s[4:7], 0 offen offset:1024 sc1 lds
    v_and_b32 v197, 7, v197
    v_lshlrev_b32 v198, 9, v196
    v_lshl_add_u32 v248, v197, 4, v198
    v_add_u32 v196, 8, v196
    v_mul_u32_u24 v197, 205, v196
    v_lshrrev_b32 v197, 9, v197
    v_xor_b32 v197, v197, v0
    v_and_b32 v197, 7, v197
    v_lshlrev_b32 v198, 9, v196
    v_lshl_add_u32 v249, v197, 4, v198
    v_add_u32 v196, 8, v196
    v_mul_u32_u24 v197, 205, v196
    v_lshrrev_b32 v197, 9, v197
    v_xor_b32 v197, v197, v0
    v_and_b32 v197, 7, v197
    v_lshlrev_b32 v198, 9, v196
    v_lshl_add_u32 v250, v197, 4, v198
    v_lshrrev_b32 v196, 5, v0
    v_lshl_add_u32 v250, v196, 31, v250
    s_mul_i32 s32, s25, 40960
    s_lshl_b32 s3, s26, 7
    s_add_u32 s32, s32, s3
    s_add_u32 s32, s32, 0x2100000
    s_add_u32 s3, s29, 0x25000
    v_add_u32 v251, s3, v14
    v_and_b32 v197, 31, v0
    v_min_u32 v197, 1, v197
    v_lshlrev_b32 v197, 31, v197
    v_lshl_add_u32 v254, v196, 3, v197
    s_lshl_b32 s33, s28, 2
    s_add_u32 s33, s33, s16
    s_lshl_b32 s33, s33, 4
    s_add_u32 s33, s33, 0x2380000
    s_lshl_b32 s45, s25, 9
    s_add_u32 s45, s45, 0x2d80000
    s_waitcnt vmcnt(10) lgkmcnt(0)
    s_barrier
    s_add_u32 m0, s29, 151552
    v_add_u32 v13, m0, v253
    buffer_load_dwordx4 v13, s[4:7], 0 offen offset:0 sc1 lds
    ds_read_b64_tr_b16 v[72:73], v1 offset:0
    ds_read_b64_tr_b16 v[74:75], v1 offset:20480
    ds_read_b64_tr_b16 v[76:77], v1 offset:512
    ds_read_b64_tr_b16 v[78:79], v1 offset:20992
    ds_read_b64_tr_b16 v[80:81], v1 offset:1024
    ds_read_b64_tr_b16 v[82:83], v1 offset:21504
    ds_read_b64_tr_b16 v[84:85], v1 offset:1536
    ds_read_b64_tr_b16 v[86:87], v1 offset:22016
    ds_read_b64_tr_b16 v[88:89], v1 offset:2048
    ds_read_b64_tr_b16 v[90:91], v1 offset:22528
    buffer_load_dwordx4 v13, s[4:7], 0 offen offset:1024 sc1 lds
    ds_read_b64_tr_b16 v[92:93], v2 offset:0
    ds_read_b64_tr_b16 v[94:95], v2 offset:20480
    s_waitcnt lgkmcnt(10)
    v_mfma_f32_16x16x32_bf16 v[208:211], v[72:75], v[16:19], 0
    ds_read_b64_tr_b16 v[96:97], v2 offset:512
    ds_read_b64_tr_b16 v[98:99], v2 offset:20992
    s_waitcnt lgkmcnt(10)
    v_mfma_f32_16x16x32_bf16 v[212:215], v[76:79], v[16:19], 0
    ds_read_b64_tr_b16 v[100:101], v2 offset:1024
    ds_read_b64_tr_b16 v[102:103], v2 offset:21504
    s_mov_b32 exec_hi, 0
    buffer_load_dwordx4 v13, s[4:7], 0 offen offset:2048 sc1 lds
    s_mov_b32 exec_hi, -1
    s_waitcnt lgkmcnt(10)
    v_mfma_f32_16x16x32_bf16 v[216:219], v[80:83], v[16:19], 0
    ds_read_b64_tr_b16 v[104:105], v2 offset:1536
    ds_read_b64_tr_b16 v[106:107], v2 offset:22016
    s_waitcnt lgkmcnt(10)
    v_mfma_f32_16x16x32_bf16 v[220:223], v[84:87], v[16:19], 0
    ds_read_b64_tr_b16 v[108:109], v2 offset:2048
    ds_read_b64_tr_b16 v[110:111], v2 offset:22528
    s_waitcnt lgkmcnt(10)
    v_mfma_f32_16x16x32_bf16 v[224:227], v[88:91], v[16:19], 0
    s_waitcnt lgkmcnt(8)
    v_mfma_f32_16x16x32_bf16 v[228:231], v[92:95], v[16:19], 0
    s_waitcnt lgkmcnt(6)
    v_mfma_f32_16x16x32_bf16 v[232:235], v[96:99], v[16:19], 0
    s_waitcnt lgkmcnt(4)
    v_mfma_f32_16x16x32_bf16 v[236:239], v[100:103], v[16:19], 0
    s_waitcnt lgkmcnt(2)
    v_mfma_f32_16x16x32_bf16 v[240:243], v[104:107], v[16:19], 0
    s_waitcnt lgkmcnt(0)
    v_mfma_f32_16x16x32_bf16 v[244:247], v[108:111], v[16:19], 0
    v_mov_b32 v176, -1
    v_mov_b32 v177, -1
    v_mov_b32 v178, -1
    v_mov_b32 v179, -1
    buffer_store_dwordx4 v[176:179], v248, s[4:7], s32 offen sc1
    buffer_store_dwordx4 v[176:179], v249, s[4:7], s32 offen sc1
    buffer_store_dwordx4 v[176:179], v250, s[4:7], s32 offen sc1
    s_waitcnt vmcnt(6) lgkmcnt(0)
    s_barrier
    ds_read_b64_tr_b16 v[72:73], v1 offset:40960
    ds_read_b64_tr_b16 v[74:75], v1 offset:61440
    ds_read_b64_tr_b16 v[76:77], v1 offset:41472
    ds_read_b64_tr_b16 v[78:79], v1 offset:61952
    ds_read_b64_tr_b16 v[80:81], v1 offset:41984
    ds_read_b64_tr_b16 v[82:83], v1 offset:62464
    ds_read_b64_tr_b16 v[84:85], v1 offset:42496
    ds_read_b64_tr_b16 v[86:87], v1 offset:62976
    ds_read_b64_tr_b16 v[88:89], v1 offset:43008
    ds_read_b64_tr_b16 v[90:91], v1 offset:63488
    ds_read_b64_tr_b16 v[92:93], v2 offset:40960
    ds_read_b64_tr_b16 v[94:95], v2 offset:61440
    s_waitcnt lgkmcnt(10)
    v_mfma_f32_16x16x32_bf16 v[208:211], v[72:75], v[20:23], v[208:211]
    ds_read_b64_tr_b16 v[96:97], v2 offset:41472
    ds_read_b64_tr_b16 v[98:99], v2 offset:61952
    s_waitcnt lgkmcnt(10)
    v_mfma_f32_16x16x32_bf16 v[212:215], v[76:79], v[20:23], v[212:215]
    ds_read_b64_tr_b16 v[100:101], v2 offset:41984
    ds_read_b64_tr_b16 v[102:103], v2 offset:62464
    s_waitcnt lgkmcnt(10)
    v_mfma_f32_16x16x32_bf16 v[216:219], v[80:83], v[20:23], v[216:219]
    ds_read_b64_tr_b16 v[104:105], v2 offset:42496
    ds_read_b64_tr_b16 v[106:107], v2 offset:62976
    s_waitcnt lgkmcnt(10)
    v_mfma_f32_16x16x32_bf16 v[220:223], v[84:87], v[20:23], v[220:223]
    ds_read_b64_tr_b16 v[108:109], v2 offset:43008
    ds_read_b64_tr_b16 v[110:111], v2 offset:63488
    s_waitcnt lgkmcnt(10)
    v_mfma_f32_16x16x32_bf16 v[224:227], v[88:91], v[20:23], v[224:227]
    s_waitcnt lgkmcnt(8)
    v_mfma_f32_16x16x32_bf16 v[228:231], v[92:95], v[20:23], v[228:231]
    s_waitcnt lgkmcnt(6)
    v_mfma_f32_16x16x32_bf16 v[232:235], v[96:99], v[20:23], v[232:235]
    s_waitcnt lgkmcnt(4)
    v_mfma_f32_16x16x32_bf16 v[236:239], v[100:103], v[20:23], v[236:239]
    s_waitcnt lgkmcnt(2)
    v_mfma_f32_16x16x32_bf16 v[240:243], v[104:107], v[20:23], v[240:243]
    s_waitcnt lgkmcnt(0)
    v_mfma_f32_16x16x32_bf16 v[244:247], v[108:111], v[20:23], v[244:247]
    v_add_f32 v190, v208, v212
    v_add_f32 v190, v190, v216
    v_add_f32 v190, v190, v220
    v_add_f32 v190, v190, v224
    v_cvt_pk_bf16_f32 v72, v208, v212
    v_cvt_pk_bf16_f32 v73, v216, v220
    v_cvt_pk_bf16_f32 v74, v224, 0
    v_cvt_pk_bf16_f32 v76, v209, v213
    v_cvt_pk_bf16_f32 v77, v217, v221
    v_cvt_pk_bf16_f32 v78, v225, 0
    v_cvt_pk_bf16_f32 v80, v210, v214
    v_cvt_pk_bf16_f32 v81, v218, v222
    v_cvt_pk_bf16_f32 v82, v226, 0
    v_cvt_pk_bf16_f32 v84, v211, v215
    v_add_f32 v190, v190, v228
    v_add_f32 v190, v190, v232
    v_add_f32 v190, v190, v236
    v_add_f32 v190, v190, v240
    v_cmp_u_f32 vcc, v190, v244
    v_cvt_pk_bf16_f32 v85, v219, v223
    v_cvt_pk_bf16_f32 v86, v227, 0
    s_cbranch_vccnz g_slow1
g_ok1:
    v_mfma_f32_16x16x32_bf16 v[208:211], v[112:115], v[72:75], 0
    v_cvt_pk_bf16_f32 v88, v228, v232
    v_cvt_pk_bf16_f32 v89, v236, v240
    v_mfma_f32_16x16x32_bf16 v[212:215], v[120:123], v[76:79], 0
    v_cvt_pk_bf16_f32 v90, v244, 0
    v_cvt_pk_bf16_f32 v92, v229, v233
    v_mfma_f32_16x16x32_bf16 v[216:219], v[128:131], v[80:83], 0
    v_cvt_pk_bf16_f32 v93, v237, v241
    v_cvt_pk_bf16_f32 v94, v245, 0
    v_mfma_f32_16x16x32_bf16 v[220:223], v[136:139], v[84:87], 0
    v_cvt_pk_bf16_f32 v96, v230, v234
    v_cvt_pk_bf16_f32 v97, v238, v242
    v_mfma_f32_16x16x32_bf16 v[112:115], v[116:119], v[72:75], 0
    v_cvt_pk_bf16_f32 v98, v246, 0
    v_cvt_pk_bf16_f32 v100, v231, v235
    v_mfma_f32_16x16x32_bf16 v[120:123], v[124:127], v[76:79], 0
    v_cvt_pk_bf16_f32 v101, v239, v243
    v_cvt_pk_bf16_f32 v102, v247, 0
    v_mfma_f32_16x16x32_bf16 v[224:227], v[144:147], v[88:91], 0
    v_mfma_f32_16x16x32_bf16 v[228:231], v[152:155], v[92:95], 0
    v_cvt_pk_bf16_f32 v104, v208, v212
    v_cvt_pk_bf16_f32 v108, v209, v213
    v_mfma_f32_16x16x32_bf16 v[232:235], v[160:163], v[96:99], 0
    v_cvt_pk_bf16_f32 v240, v210, v214
    v_cvt_pk_bf16_f32 v105, v216, v220
    v_mfma_f32_16x16x32_bf16 v[236:239], v[168:171], v[100:103], 0
    v_cvt_pk_bf16_f32 v109, v217, v221
    v_cvt_pk_bf16_f32 v241, v218, v222
    v_mfma_f32_16x16x32_bf16 v[128:131], v[132:135], v[80:83], 0
    v_mfma_f32_16x16x32_bf16 v[136:139], v[140:143], v[84:87], 0
    v_cvt_pk_bf16_f32 v106, v224, v228
    v_cvt_pk_bf16_f32 v110, v225, v229
    v_mfma_f32_16x16x32_bf16 v[144:147], v[148:151], v[88:91], 0
    v_cvt_pk_bf16_f32 v242, v226, v230
    v_mfma_f32_16x16x32_bf16 v[152:155], v[156:159], v[92:95], 0
    v_cvt_pk_bf16_f32 v107, v232, v236
    v_cvt_pk_bf16_f32 v111, v233, v237
    v_mfma_f32_16x16x32_bf16 v[160:163], v[164:167], v[96:99], 0
    ds_write_b128 v3, v[104:107] offset:0
    v_cvt_pk_bf16_f32 v243, v234, v238
    v_mfma_f32_16x16x32_bf16 v[168:171], v[172:175], v[100:103], 0
    ds_write_b128 v4, v[108:111] offset:128
    ds_write_b128 v255, v[240:243] offset:256
    s_waitcnt vmcnt(3) lgkmcnt(0)
    s_barrier
    ds_read_b128 v[72:75], v5 offset:0
    ds_read_b128 v[76:79], v6 offset:0
    ds_read_b128 v[80:83], v7 offset:0
    ds_read_b128 v[84:87], v8 offset:0
    ds_read_b128 v[220:223], v9 offset:128
    ds_read_b64 v[224:225], v10
    ds_read_b128 v[216:219], v9
    s_add_u32 m0, s35, 0
    v_add_u32 v13, m0, v11
    buffer_load_dwordx4 v13, s[4:7], 0 offen offset:0 sc1 lds
    v_cvt_pk_bf16_f32 v104, v112, v120
    v_cvt_pk_bf16_f32 v105, v128, v136
    v_cvt_pk_bf16_f32 v106, v144, v152
    v_cvt_pk_bf16_f32 v107, v160, v168
    v_cvt_pk_bf16_f32 v108, v113, v121
    v_cvt_pk_bf16_f32 v109, v129, v137
    v_cvt_pk_bf16_f32 v110, v145, v153
    v_cvt_pk_bf16_f32 v111, v161, v169
    v_cvt_pk_bf16_f32 v240, v114, v122
    v_cvt_pk_bf16_f32 v241, v130, v138
    v_cvt_pk_bf16_f32 v242, v146, v154
    v_cvt_pk_bf16_f32 v243, v162, v170
    ds_write_b128 v3, v[104:107] offset:12288
    s_waitcnt lgkmcnt(7)
    v_mfma_f32_32x32x16_bf16 v[176:191], v[72:75], v[24:27], 0
    ds_write_b128 v4, v[108:111] offset:12416
    s_waitcnt lgkmcnt(7)
    v_mfma_f32_32x32x16_bf16 v[176:191], v[76:79], v[28:31], v[176:191]
    ds_write_b128 v255, v[240:243] offset:12544
    s_waitcnt lgkmcnt(7)
    v_mfma_f32_32x32x16_bf16 v[176:191], v[80:83], v[32:35], v[176:191]
    buffer_load_dwordx4 v13, s[4:7], 0 offen offset:1024 sc1 lds
    s_waitcnt lgkmcnt(5)
    v_lshlrev_b32 v202, 16, v221
    v_and_b32 v201, 0xffff0000, v221
    v_lshlrev_b32 v200, 16, v222
    v_and_b32 v199, 0xffff0000, v222
    v_lshlrev_b32 v198, 16, v223
    v_mfma_f32_32x32x16_bf16 v[176:191], v[84:87], v[36:39], v[176:191]
    v_and_b32 v197, 0xffff0000, v223
    s_waitcnt lgkmcnt(4)
    v_lshlrev_b32 v196, 16, v224
    v_and_b32 v195, 0xffff0000, v224
    v_lshlrev_b32 v194, 16, v225
    v_and_b32 v193, 0xffff0000, v225
    s_nop 1
    v_mfma_f32_32x32x16_bf16 v[192:207], v[72:75], v[48:51], v[192:207]
    s_waitcnt lgkmcnt(0)
    s_barrier
    ds_read_b128 v[88:91], v5 offset:12288
    ds_read_b128 v[92:95], v6 offset:12288
    ds_read_b128 v[96:99], v7 offset:12288
    ds_read_b128 v[100:103], v8 offset:12288
    v_mfma_f32_32x32x16_bf16 v[192:207], v[76:79], v[52:55], v[192:207]
    v_lshlrev_b32 v228, 16, v216
    v_and_b32 v229, 0xffff0000, v216
    v_lshlrev_b32 v230, 16, v217
    v_and_b32 v231, 0xffff0000, v217
    v_lshlrev_b32 v232, 16, v218
    v_and_b32 v233, 0xffff0000, v218
    v_mfma_f32_32x32x16_bf16 v[192:207], v[80:83], v[56:59], v[192:207]
    v_lshlrev_b32 v234, 16, v219
    v_and_b32 v235, 0xffff0000, v219
    v_lshlrev_b32 v236, 16, v220
    v_and_b32 v237, 0xffff0000, v220
    v_add_f32 v176, v176, v228
    v_add_f32 v177, v177, v229
    v_add_f32 v178, v178, v230
    v_mfma_f32_32x32x16_bf16 v[192:207], v[84:87], v[60:63], v[192:207]
    v_add_f32 v179, v179, v231
    v_add_f32 v180, v180, v232
    v_add_f32 v181, v181, v233
    v_add_f32 v182, v182, v234
    v_add_f32 v183, v183, v235
    v_add_f32 v184, v184, v236
    v_add_f32 v185, v185, v237
    s_waitcnt lgkmcnt(3)
    s_nop 0
    v_mfma_f32_32x32x16_bf16 v[176:191], v[88:91], v[40:43], v[176:191]
    buffer_load_dwordx4 v13, s[4:7], 0 offen offset:2048 sc1 lds
    s_lshl_b32 s3, s16, 6
    v_add_u32 v1, s3, v0
    v_lshrrev_b32 v1, 2, v1
    v_min_u32 v1, 1, v1
    v_lshlrev_b32 v1, 31, v1
    s_waitcnt lgkmcnt(2)
    v_mfma_f32_32x32x16_bf16 v[176:191], v[92:95], v[44:47], v[176:191]
    buffer_load_dwordx4 v13, s[4:7], 0 offen offset:3072 sc1 lds
    v_lshl_add_u32 v1, v0, 7, v1
    v_mov_b32 v2, 1
    s_waitcnt lgkmcnt(1)
    v_mfma_f32_32x32x16_bf16 v[176:191], v[96:99], v[24:27], v[176:191]
    s_add_u32 m0, s35, 4096
    v_add_u32 v13, m0, v11
    buffer_load_dwordx4 v13, s[4:7], 0 offen offset:0 sc1 lds
    s_waitcnt lgkmcnt(0)
    v_mfma_f32_32x32x16_bf16 v[176:191], v[100:103], v[28:31], v[176:191]
    s_add_u32 m0, s35, 40960
    v_add_u32 v13, m0, v11
    buffer_load_dwordx4 v13, s[4:7], 0 offen offset:0 sc1 lds
    v_mfma_f32_32x32x16_bf16 v[192:207], v[88:91], v[56:59], v[192:207]
    buffer_load_dwordx4 v13, s[4:7], 0 offen offset:1024 sc1 lds
    v_mfma_f32_32x32x16_bf16 v[192:207], v[92:95], v[60:63], v[192:207]
    buffer_load_dwordx4 v13, s[4:7], 0 offen offset:2048 sc1 lds
    v_mfma_f32_32x32x16_bf16 v[192:207], v[96:99], v[64:67], v[192:207]
    buffer_load_dwordx4 v13, s[4:7], 0 offen offset:3072 sc1 lds
    s_nop 2
    v_add_f32 v208, v176, v177
    v_mul_f32 v209, v176, v176
    v_fmac_f32 v209, v177, v177
    v_add_f32 v208, v208, v178
    v_fmac_f32 v209, v178, v178
    v_mfma_f32_32x32x16_bf16 v[192:207], v[100:103], v[68:71], v[192:207]
    v_add_f32 v208, v208, v179
    v_fmac_f32 v209, v179, v179
    v_add_f32 v208, v208, v180
    v_fmac_f32 v209, v180, v180
    v_add_f32 v208, v208, v181
    v_fmac_f32 v209, v181, v181
    v_add_f32 v208, v208, v182
    v_fmac_f32 v209, v182, v182
    v_add_f32 v208, v208, v183
    v_fmac_f32 v209, v183, v183
    v_add_f32 v208, v208, v184
    v_fmac_f32 v209, v184, v184
    v_add_f32 v208, v208, v185
    s_add_u32 m0, s35, 45056
    v_add_u32 v13, m0, v11
    buffer_load_dwordx4 v13, s[4:7], 0 offen offset:0 sc1 lds
    v_fmac_f32 v209, v185, v185
    v_add_f32 v208, v208, v202
    v_fmac_f32 v209, v202, v202
    v_add_f32 v208, v208, v201
    v_fmac_f32 v209, v201, v201
    v_add_f32 v208, v208, v200
    v_fmac_f32 v209, v200, v200
    v_add_f32 v208, v208, v199
    v_fmac_f32 v209, v199, v199
    v_add_f32 v208, v208, v198
    s_add_u32 m0, s35, 20480
    v_add_u32 v13, m0, v11
    buffer_load_dwordx4 v13, s[4:7], 0 offen offset:0 sc1 lds
    v_fmac_f32 v209, v198, v198
    v_add_f32 v208, v208, v197
    v_fmac_f32 v209, v197, v197
    v_add_f32 v208, v208, v196
    v_fmac_f32 v209, v196, v196
    v_add_f32 v208, v208, v195
    v_fmac_f32 v209, v195, v195
    v_add_f32 v208, v208, v194
    v_fmac_f32 v209, v194, v194
    v_add_f32 v208, v208, v193
    buffer_load_dwordx4 v13, s[4:7], 0 offen offset:1024 sc1 lds
    v_fmac_f32 v209, v193, v193
    v_add_f32_dpp v208, v208, v208 quad_perm:[1,0,3,2] row_mask:0xf bank_mask:0xf
    s_nop 0
    v_add_f32_dpp v209, v209, v209 quad_perm:[1,0,3,2] row_mask:0xf bank_mask:0xf
    v_add_f32_dpp v208, v208, v208 quad_perm:[2,3,0,1] row_mask:0xf bank_mask:0xf
    s_nop 0
    v_add_f32_dpp v209, v209, v209 quad_perm:[2,3,0,1] row_mask:0xf bank_mask:0xf
    v_add_f32_dpp v208, v208, v208 row_half_mirror row_mask:0xf bank_mask:0xf
    s_nop 0
    v_add_f32_dpp v209, v209, v209 row_half_mirror row_mask:0xf bank_mask:0xf
    v_add_f32_dpp v208, v208, v208 row_mirror row_mask:0xf bank_mask:0xf
    s_nop 0
    v_add_f32_dpp v209, v209, v209 row_mirror row_mask:0xf bank_mask:0xf
    v_mov_b32 v210, v208
    v_mov_b32 v211, v209
    s_nop 0
    v_permlane16_swap_b32 v208, v210
    buffer_load_dwordx4 v13, s[4:7], 0 offen offset:2048 sc1 lds
    v_permlane16_swap_b32 v209, v211
    v_add_f32 v208, v208, v210
    v_add_f32 v209, v209, v211
    v_mul_f32 v212, 0xbacccccd, v208
    v_mul_f32 v210, 0x3acccccd, v209
    v_fma_f32 v210, -v212, v212, v210
    v_max_f32 v210, 0, v210
    v_add_f32 v210, 0x3727c5ac, v210
    v_rsq_f32 v210, v210
    s_nop 0
    v_mul_f32 v210, 0x3fb8aa3b, v210
    v_mul_f32 v212, v212, v210
    v_pk_fma_f32 v[176:177], v[176:177], v[210:211], v[212:213] op_sel_hi:[1,0,0]
    v_pk_fma_f32 v[178:179], v[178:179], v[210:211], v[212:213] op_sel_hi:[1,0,0]
    v_pk_fma_f32 v[180:181], v[180:181], v[210:211], v[212:213] op_sel_hi:[1,0,0]
    v_pk_fma_f32 v[182:183], v[182:183], v[210:211], v[212:213] op_sel_hi:[1,0,0]
    v_pk_fma_f32 v[184:185], v[184:185], v[210:211], v[212:213] op_sel_hi:[1,0,0]
    v_pk_fma_f32 v[202:203], v[202:203], v[210:211], v[212:213] op_sel_hi:[1,0,0]
    v_pk_fma_f32 v[200:201], v[200:201], v[210:211], v[212:213] op_sel_hi:[1,0,0]
    v_pk_fma_f32 v[198:199], v[198:199], v[210:211], v[212:213] op_sel_hi:[1,0,0]
    v_pk_fma_f32 v[196:197], v[196:197], v[210:211], v[212:213] op_sel_hi:[1,0,0]
    v_cvt_pk_bf16_f32 v72, v176, v177
    v_cvt_pk_bf16_f32 v73, v178, v179
    v_cvt_pk_bf16_f32 v74, v180, v181
    v_cvt_pk_bf16_f32 v75, v182, v183
    v_cvt_pk_bf16_f32 v76, v184, v185
    v_cvt_pk_bf16_f32 v77, v202, v201
    v_cvt_pk_bf16_f32 v78, v200, v199
    v_cvt_pk_bf16_f32 v79, v198, v197
    ds_write_b128 v9, v[72:75]
    ds_write_b128 v9, v[76:79] offset:128
    v_pk_fma_f32 v[194:195], v[194:195], v[210:211], v[212:213] op_sel_hi:[1,0,0]
    v_pk_fma_f32 v[192:193], v[192:193], v[210:211], v[212:213] op_sel_hi:[1,0,0]
    v_cvt_pk_bf16_f32 v80, v196, v195
    v_cvt_pk_bf16_f32 v81, v194, v193
    ds_write_b64 v10, v[80:81]
    v_rcp_f32 v209, v210
    v_mul_f32 v208, 0x3acccccd, v208
    s_waitcnt vmcnt(13) lgkmcnt(0)
    s_barrier
    ds_read_b128 v[216:219], v251 offset:0
    ds_read_b128 v[220:223], v251 offset:1024
    ds_read_b128 v[224:227], v251 offset:2048
    buffer_store_dwordx2 v[208:209], v254, s[4:7], s33 offen sc1
    s_waitcnt lgkmcnt(2)
    buffer_store_dwordx4 v[216:219], v248, s[4:7], s32 offen sc1
    s_waitcnt lgkmcnt(1)
    buffer_store_dwordx4 v[220:223], v249, s[4:7], s32 offen sc1
    s_waitcnt lgkmcnt(0)
    buffer_store_dwordx4 v[224:227], v250, s[4:7], s32 offen sc1
    s_barrier
    buffer_atomic_add v2, v1, s[4:7], s45 offen sc1
    s_mul_i32 s34, s16, 9216
    buffer_load_dwordx4 v13, s[4:7], 0 offen offset:3072 sc1 lds
    s_add_u32 m0, s35, 24576
    v_add_u32 v13, m0, v11
    buffer_load_dwordx4 v13, s[4:7], 0 offen offset:0 sc1 lds
    v_mov_b32 v6, 1
    s_lshl_b32 s24, s17, 2
    s_add_u32 s24, s24, s16
    s_lshl_b32 s25, s24, 9
    s_add_u32 s25, s25, 0x2d80000
    s_lshr_b32 s36, s18, 2
    s_lshl_b32 s36, s36, 7
    s_add_u32 s36, s36, s25
    s_lshl_b32 s3, s16, 6
    v_add_u32 v7, s3, v0
    v_lshrrev_b32 v7, 2, v7
    v_min_u32 v7, 1, v7
    v_lshlrev_b32 v7, 31, v7
    v_lshl_add_u32 v7, v0, 7, v7
    s_mul_i32 s27, s24, 110592
    s_mul_i32 s24, s24, 40960
    s_add_u32 s24, s24, 0x2100000
    v_lshrrev_b32 v3, 4, v0
    v_and_b32 v4, 15, v0
    v_lshlrev_b32 v4, 4, v4
    v_lshl_add_u32 v3, v3, 9, v4
    v_add_u32 v3, s24, v3
    v_lshlrev_b32 v4, 3, v0
    v_add_u32 v1, 0x10000, v14
    v_add_u32 v2, 0x20000, v14
    s_add_u32 s27, s27, 0x2600000
    s_lshr_b32 s3, s18, 2
    s_sub_u32 s28, s18, s3
    s_lshl_b32 s28, s28, 10
    s_add_u32 s28, s28, s27
    s_add_u32 s28, s28, 98304
    s_mul_i32 s3, s3, 24576
    s_add_u32 s27, s27, s3
    s_lshl_b32 s3, s26, 11
    s_add_u32 s27, s27, s3
    s_mul_i32 s29, s16, 5120
    s_add_u32 s30, s26, 1
    s_lshr_b32 s30, s30, 2
    s_lshl_b32 s30, s30, 31
    s_mov_b32 s31, 0x40053526
    s_lshl_b32 s46, s17, 2
    s_lshr_b32 s3, s18, 2
    s_add_u32 s46, s46, s3
    s_lshl_b32 s46, s46, 1
    v_mov_b32 v5, 0
    buffer_atomic_add v5, v12, s[4:7], s36 offen sc0 sc1
    s_add_u32 m0, s35, 61440
    v_add_u32 v13, m0, v11
    buffer_load_dwordx4 v13, s[4:7], 0 offen offset:0 sc1 lds
    s_lshr_b32 s3, s16, 1
    s_add_u32 s46, s46, s3
    s_lshl_b32 s46, s46, 7
    s_add_u32 s46, s46, 0x2d88000
    s_lshl_b32 s47, s17, 2
    s_add_u32 s47, s47, s16
    s_lshl_b32 s47, s47, 1
    s_add_u32 s47, s47, s19
    s_lshl_b32 s47, s47, 7
    s_add_u32 s47, s47, 0x2d88000
    s_lshl_b32 s41, s17, 1
    s_add_u32 s41, s41, s19
    s_mul_i32 s41, s41, 221184
    s_mul_i32 s3, s16, 24576
    s_add_u32 s41, s41, s3
    s_add_u32 s41, s41, 0x2600000
    s_xor_b32 s42, s16, 3
    s_lshr_b32 s3, s42, 1
    s_mul_i32 s3, s3, 110592
    s_add_u32 s37, s41, s3
    s_and_b32 s3, s42, 1
    s_lshl_b32 s3, s3, 10
    s_add_u32 s37, s37, s3
    s_xor_b32 s42, s16, 2
    v_mov_b32 v8, 0
    buffer_atomic_add v8, v12, s[4:7], s36 offen sc0 sc1
    buffer_load_dwordx4 v13, s[4:7], 0 offen offset:1024 sc1 lds
    s_lshr_b32 s3, s42, 1
    s_mul_i32 s3, s3, 110592
    s_add_u32 s38, s41, s3
    s_and_b32 s3, s42, 1
    s_lshl_b32 s3, s3, 10
    s_add_u32 s38, s38, s3
    s_xor_b32 s42, s16, 1
    s_lshr_b32 s3, s42, 1
    s_mul_i32 s3, s3, 110592
    s_add_u32 s39, s41, s3
    s_and_b32 s3, s42, 1
    s_lshl_b32 s3, s3, 10
    s_add_u32 s39, s39, s3
    s_xor_b32 s42, s16, 0
    s_lshr_b32 s3, s42, 1
    s_mul_i32 s3, s3, 110592
    s_add_u32 s40, s41, s3
    s_and_b32 s3, s42, 1
    s_lshl_b32 s3, s3, 10
    s_add_u32 s40, s40, s3
    v_mov_b32 v9, 0
    buffer_atomic_add v9, v12, s[4:7], s36 offen sc0 sc1
    buffer_load_dwordx4 v13, s[4:7], 0 offen offset:2048 sc1 lds
    buffer_load_dwordx4 v13, s[4:7], 0 offen offset:3072 sc1 lds
    s_add_u32 m0, s35, 65536
    v_add_u32 v13, m0, v11
    buffer_load_dwordx4 v13, s[4:7], 0 offen offset:0 sc1 lds
    s_waitcnt vmcnt(18)
    s_barrier
    ds_read_b128 a[160:163], v14 offset:0
    ds_read_b128 a[164:167], v14 offset:5120
    ds_read_b128 a[168:171], v14 offset:40960
    ds_read_b128 a[172:175], v14 offset:46080
    ds_read_b128 a[176:179], v1 offset:16384
    ds_read_b128 v[72:75], v1 offset:21504
    s_waitcnt vmcnt(7)
    v_readfirstlane_b32 s48, v5
    s_nop 1
    s_bitcmp1_b32 s48, 2
    s_cbranch_scc0 zf1_slow
zf1_ok:
    buffer_load_dwordx4 v[96:99], v3, s[4:7], 0 offen offset:0 sc1
    buffer_load_dwordx4 v[100:103], v3, s[4:7], 0 offen offset:256 sc1
    buffer_load_dwordx4 v[104:107], v3, s[4:7], 0 offen offset:2048 sc1
    buffer_load_dwordx4 v[108:111], v3, s[4:7], 0 offen offset:2304 sc1
    v_add_u32 v3, 4096, v3
    buffer_load_dwordx4 v[112:115], v3, s[4:7], 0 offen offset:0 sc1
    buffer_load_dwordx4 v[116:119], v3, s[4:7], 0 offen offset:256 sc1
    buffer_load_dwordx4 v[120:123], v3, s[4:7], 0 offen offset:2048 sc1
    buffer_load_dwordx4 v[124:127], v3, s[4:7], 0 offen offset:2304 sc1
    v_add_u32 v3, 4096, v3
    buffer_load_dwordx4 v[128:131], v3, s[4:7], 0 offen offset:0 sc1
    buffer_load_dwordx4 v[132:135], v3, s[4:7], 0 offen offset:256 sc1
    buffer_load_dwordx4 v[136:139], v3, s[4:7], 0 offen offset:2048 sc1
    buffer_atomic_add v6, v12, s[4:7], s45 offen offset:8 sc1
    s_waitcnt vmcnt(10)
    v_max_u32 v88, v96, v100
    v_cmp_eq_u32 vcc, -1, v88
    s_waitcnt lgkmcnt(0)
    s_cbranch_vccnz zv1_1_slow
zv1_1_ok:
    s_waitcnt lgkmcnt(0)
    v_mfma_f32_16x16x32_bf16 v[24:27], a[160:163], v[96:99], 0
    ds_read_b128 a[180:183], v14 offset:1024
    ds_read_b128 a[184:187], v14 offset:6144
    v_mfma_f32_16x16x32_bf16 v[32:35], a[164:167], v[96:99], 0
    buffer_load_dwordx4 v[140:143], v3, s[4:7], 0 offen offset:2304 sc1
    ds_read_b128 a[188:191], v14 offset:41984
    v_mfma_f32_16x16x32_bf16 v[40:43], a[168:171], v[96:99], 0
    ds_read_b128 a[192:195], v14 offset:47104
    ds_read_b128 a[196:199], v1 offset:17408
    v_mfma_f32_16x16x32_bf16 v[48:51], a[172:175], v[96:99], 0
    ds_read_b128 v[76:79], v1 offset:22528
    v_mfma_f32_16x16x32_bf16 v[56:59], a[176:179], v[96:99], 0
    v_add_u32 v3, 4096, v3
    v_mfma_f32_16x16x32_bf16 v[64:67], v[72:75], v[96:99], 0
    buffer_load_dwordx4 v[144:147], v3, s[4:7], 0 offen offset:0 sc1
    v_mfma_f32_16x16x32_bf16 v[28:31], a[160:163], v[100:103], 0
    v_mfma_f32_16x16x32_bf16 v[36:39], a[164:167], v[100:103], 0
    s_waitcnt vmcnt(10)
    v_max_u32 v88, v104, v108
    v_cmp_eq_u32 vcc, -1, v88
    v_mfma_f32_16x16x32_bf16 v[44:47], a[168:171], v[100:103], 0
    buffer_load_dwordx4 v[148:151], v3, s[4:7], 0 offen offset:256 sc1
    v_mfma_f32_16x16x32_bf16 v[52:55], a[172:175], v[100:103], 0
    v_mfma_f32_16x16x32_bf16 v[60:63], a[176:179], v[100:103], 0
    s_cbranch_vccnz zv1_2_slow
zv1_2_ok:
    v_mfma_f32_16x16x32_bf16 v[68:71], v[72:75], v[100:103], 0
    s_waitcnt lgkmcnt(0)
    v_mfma_f32_16x16x32_bf16 v[24:27], a[180:183], v[104:107], v[24:27]
    ds_read_b128 a[160:163], v14 offset:2048
    ds_read_b128 a[164:167], v14 offset:7168
    v_mfma_f32_16x16x32_bf16 v[32:35], a[184:187], v[104:107], v[32:35]
    buffer_load_dwordx4 v[152:155], v3, s[4:7], 0 offen offset:2048 sc1
    ds_read_b128 a[168:171], v14 offset:43008
    v_mfma_f32_16x16x32_bf16 v[40:43], a[188:191], v[104:107], v[40:43]
    ds_read_b128 a[172:175], v14 offset:48128
    ds_read_b128 a[176:179], v1 offset:18432
    v_mfma_f32_16x16x32_bf16 v[48:51], a[192:195], v[104:107], v[48:51]
    ds_read_b128 v[72:75], v1 offset:23552
    v_mfma_f32_16x16x32_bf16 v[56:59], a[196:199], v[104:107], v[56:59]
    buffer_load_dwordx4 v[156:159], v3, s[4:7], 0 offen offset:2304 sc1
    v_mfma_f32_16x16x32_bf16 v[64:67], v[76:79], v[104:107], v[64:67]
    v_mfma_f32_16x16x32_bf16 v[28:31], a[180:183], v[108:111], v[28:31]
    v_mfma_f32_16x16x32_bf16 v[36:39], a[184:187], v[108:111], v[36:39]
    s_waitcnt vmcnt(11)
    v_max_u32 v88, v112, v116
    v_cmp_eq_u32 vcc, -1, v88
    v_mfma_f32_16x16x32_bf16 v[44:47], a[188:191], v[108:111], v[44:47]
    v_add_u32 v3, 4096, v3
    v_mfma_f32_16x16x32_bf16 v[52:55], a[192:195], v[108:111], v[52:55]
    buffer_load_dwordx4 v[160:163], v3, s[4:7], 0 offen offset:0 sc1
    v_mfma_f32_16x16x32_bf16 v[60:63], a[196:199], v[108:111], v[60:63]
    s_cbranch_vccnz zv1_3_slow
zv1_3_ok:
    v_mfma_f32_16x16x32_bf16 v[68:71], v[76:79], v[108:111], v[68:71]
    s_waitcnt lgkmcnt(0)
    v_mfma_f32_16x16x32_bf16 v[24:27], a[160:163], v[112:115], v[24:27]
    ds_read_b128 a[180:183], v14 offset:3072
    ds_read_b128 a[184:187], v14 offset:8192
    v_mfma_f32_16x16x32_bf16 v[32:35], a[164:167], v[112:115], v[32:35]
    buffer_load_dwordx4 v[164:167], v3, s[4:7], 0 offen offset:256 sc1
    ds_read_b128 a[188:191], v14 offset:44032
    v_mfma_f32_16x16x32_bf16 v[40:43], a[168:171], v[112:115], v[40:43]
    s_branch .Lps5626
hop2_2:
.Lpd5626:
    s_branch .Lpd7380
.Lps5626:
    ds_read_b128 a[192:195], v14 offset:49152
    ds_read_b128 a[196:199], v1 offset:19456
    v_mfma_f32_16x16x32_bf16 v[48:51], a[172:175], v[112:115], v[48:51]
    ds_read_b128 v[76:79], v1 offset:24576
    v_mfma_f32_16x16x32_bf16 v[56:59], a[176:179], v[112:115], v[56:59]
    buffer_load_dwordx4 v[168:171], v3, s[4:7], 0 offen offset:2048 sc1
    v_mfma_f32_16x16x32_bf16 v[64:67], v[72:75], v[112:115], v[64:67]
    v_mfma_f32_16x16x32_bf16 v[28:31], a[160:163], v[116:119], v[28:31]
    v_mfma_f32_16x16x32_bf16 v[36:39], a[164:167], v[116:119], v[36:39]
    s_waitcnt vmcnt(12)
    v_max_u32 v88, v120, v124
    v_cmp_eq_u32 vcc, -1, v88
    v_mfma_f32_16x16x32_bf16 v[44:47], a[168:171], v[116:119], v[44:47]
    buffer_load_dwordx4 v[172:175], v3, s[4:7], 0 offen offset:2304 sc1
    v_mfma_f32_16x16x32_bf16 v[52:55], a[172:175], v[116:119], v[52:55]
    v_mfma_f32_16x16x32_bf16 v[60:63], a[176:179], v[116:119], v[60:63]
    s_cbranch_vccnz zv1_4_slow
zv1_4_ok:
    v_mfma_f32_16x16x32_bf16 v[68:71], v[72:75], v[116:119], v[68:71]
    s_waitcnt lgkmcnt(0)
    v_mfma_f32_16x16x32_bf16 v[24:27], a[180:183], v[120:123], v[24:27]
    ds_read_b128 a[160:163], v14 offset:4096
    ds_read_b128 a[164:167], v14 offset:9216
    v_mfma_f32_16x16x32_bf16 v[32:35], a[184:187], v[120:123], v[32:35]
    ds_read_b128 a[168:171], v14 offset:45056
    ds_read_b128 a[172:175], v14 offset:50176
    v_mfma_f32_16x16x32_bf16 v[40:43], a[188:191], v[120:123], v[40:43]
    ds_read_b128 a[176:179], v1 offset:20480
    ds_read_b128 v[72:75], v1 offset:25600
    v_mfma_f32_16x16x32_bf16 v[48:51], a[192:195], v[120:123], v[48:51]
    v_add_u32 v3, 4096, v3
    v_mfma_f32_16x16x32_bf16 v[56:59], a[196:199], v[120:123], v[56:59]
    buffer_load_dwordx4 v[176:179], v3, s[4:7], 0 offen offset:0 sc1
    buffer_load_dwordx4 v[180:183], v3, s[4:7], 0 offen offset:256 sc1
    v_mfma_f32_16x16x32_bf16 v[64:67], v[76:79], v[120:123], v[64:67]
    v_mfma_f32_16x16x32_bf16 v[28:31], a[180:183], v[124:127], v[28:31]
    v_mfma_f32_16x16x32_bf16 v[36:39], a[184:187], v[124:127], v[36:39]
    s_waitcnt vmcnt(13)
    v_max_u32 v88, v128, v132
    v_cmp_eq_u32 vcc, -1, v88
    v_mfma_f32_16x16x32_bf16 v[44:47], a[188:191], v[124:127], v[44:47]
    buffer_load_dwordx4 v[184:187], v3, s[4:7], 0 offen offset:2048 sc1
    v_mfma_f32_16x16x32_bf16 v[52:55], a[192:195], v[124:127], v[52:55]
    v_mfma_f32_16x16x32_bf16 v[60:63], a[196:199], v[124:127], v[60:63]
    s_cbranch_vccnz zv1_5_slow
zv1_5_ok:
    v_mfma_f32_16x16x32_bf16 v[68:71], v[76:79], v[124:127], v[68:71]
    s_waitcnt lgkmcnt(0)
    v_mfma_f32_16x16x32_bf16 v[24:27], a[160:163], v[128:131], v[24:27]
    ds_read_b128 a[180:183], v14 offset:10240
    ds_read_b128 a[184:187], v14 offset:15360
    v_mfma_f32_16x16x32_bf16 v[32:35], a[164:167], v[128:131], v[32:35]
    buffer_load_dwordx4 v[188:191], v3, s[4:7], 0 offen offset:2304 sc1
    ds_read_b128 a[188:191], v14 offset:51200
    v_mfma_f32_16x16x32_bf16 v[40:43], a[168:171], v[128:131], v[40:43]
    ds_read_b128 a[192:195], v14 offset:56320
    ds_read_b128 a[196:199], v1 offset:26624
    v_mfma_f32_16x16x32_bf16 v[48:51], a[172:175], v[128:131], v[48:51]
    ds_read_b128 v[76:79], v1 offset:31744
    v_mfma_f32_16x16x32_bf16 v[56:59], a[176:179], v[128:131], v[56:59]
    v_add_u32 v3, 4096, v3
    v_mfma_f32_16x16x32_bf16 v[64:67], v[72:75], v[128:131], v[64:67]
    buffer_load_dwordx4 v[192:195], v3, s[4:7], 0 offen offset:0 sc1
    v_mfma_f32_16x16x32_bf16 v[28:31], a[160:163], v[132:135], v[28:31]
    v_mfma_f32_16x16x32_bf16 v[36:39], a[164:167], v[132:135], v[36:39]
    s_waitcnt vmcnt(13)
    v_max_u32 v88, v136, v140
    v_cmp_eq_u32 vcc, -1, v88
    v_mfma_f32_16x16x32_bf16 v[44:47], a[168:171], v[132:135], v[44:47]
    buffer_load_dwordx4 v[196:199], v3, s[4:7], 0 offen offset:256 sc1
    v_mfma_f32_16x16x32_bf16 v[52:55], a[172:175], v[132:135], v[52:55]
    v_mfma_f32_16x16x32_bf16 v[60:63], a[176:179], v[132:135], v[60:63]
    s_cbranch_vccnz zv1_6_slow
zv1_6_ok:
    v_mfma_f32_16x16x32_bf16 v[68:71], v[72:75], v[132:135], v[68:71]
    s_waitcnt lgkmcnt(0)
    v_mfma_f32_16x16x32_bf16 v[24:27], a[180:183], v[136:139], v[24:27]
    ds_read_b128 a[160:163], v14 offset:11264
    ds_read_b128 a[164:167], v14 offset:16384
    v_mfma_f32_16x16x32_bf16 v[32:35], a[184:187], v[136:139], v[32:35]
    buffer_load_dwordx4 v[200:203], v3, s[4:7], 0 offen offset:2048 sc1
    ds_read_b128 a[168:171], v14 offset:52224
    v_mfma_f32_16x16x32_bf16 v[40:43], a[188:191], v[136:139], v[40:43]
    ds_read_b128 a[172:175], v14 offset:57344
    ds_read_b128 a[176:179], v1 offset:27648
    v_mfma_f32_16x16x32_bf16 v[48:51], a[192:195], v[136:139], v[48:51]
    ds_read_b128 v[72:75], v1 offset:32768
    v_mfma_f32_16x16x32_bf16 v[56:59], a[196:199], v[136:139], v[56:59]
    buffer_load_dwordx4 v[204:207], v3, s[4:7], 0 offen offset:2304 sc1
    v_mfma_f32_16x16x32_bf16 v[64:67], v[76:79], v[136:139], v[64:67]
    v_mfma_f32_16x16x32_bf16 v[28:31], a[180:183], v[140:143], v[28:31]
    v_mfma_f32_16x16x32_bf16 v[36:39], a[184:187], v[140:143], v[36:39]
    s_waitcnt vmcnt(14)
    v_max_u32 v88, v144, v148
    v_cmp_eq_u32 vcc, -1, v88
    v_mfma_f32_16x16x32_bf16 v[44:47], a[188:191], v[140:143], v[44:47]
    v_add_u32 v3, 4096, v3
    v_mfma_f32_16x16x32_bf16 v[52:55], a[192:195], v[140:143], v[52:55]
    buffer_load_dwordx4 v[208:211], v3, s[4:7], 0 offen offset:0 sc1
    v_mfma_f32_16x16x32_bf16 v[60:63], a[196:199], v[140:143], v[60:63]
    s_cbranch_vccnz zv1_7_slow
zv1_7_ok:
    v_mfma_f32_16x16x32_bf16 v[68:71], v[76:79], v[140:143], v[68:71]
    s_waitcnt lgkmcnt(0)
    v_mfma_f32_16x16x32_bf16 v[24:27], a[160:163], v[144:147], v[24:27]
    ds_read_b128 a[180:183], v14 offset:12288
    ds_read_b128 a[184:187], v14 offset:17408
    v_mfma_f32_16x16x32_bf16 v[32:35], a[164:167], v[144:147], v[32:35]
    buffer_load_dwordx4 v[212:215], v3, s[4:7], 0 offen offset:256 sc1
    ds_read_b128 a[188:191], v14 offset:53248
    v_mfma_f32_16x16x32_bf16 v[40:43], a[168:171], v[144:147], v[40:43]
    ds_read_b128 a[192:195], v14 offset:58368
    ds_read_b128 a[196:199], v1 offset:28672
    v_mfma_f32_16x16x32_bf16 v[48:51], a[172:175], v[144:147], v[48:51]
    ds_read_b128 v[76:79], v1 offset:33792
    v_mfma_f32_16x16x32_bf16 v[56:59], a[176:179], v[144:147], v[56:59]
    buffer_load_dwordx4 v[216:219], v3, s[4:7], 0 offen offset:2048 sc1
    v_mfma_f32_16x16x32_bf16 v[64:67], v[72:75], v[144:147], v[64:67]
    v_mfma_f32_16x16x32_bf16 v[28:31], a[160:163], v[148:151], v[28:31]
    v_mfma_f32_16x16x32_bf16 v[36:39], a[164:167], v[148:151], v[36:39]
    s_waitcnt vmcnt(15)
    v_max_u32 v88, v152, v156
    v_cmp_eq_u32 vcc, -1, v88
    v_mfma_f32_16x16x32_bf16 v[44:47], a[168:171], v[148:151], v[44:47]
    buffer_load_dwordx4 v[220:223], v3, s[4:7], 0 offen offset:2304 sc1
    v_mfma_f32_16x16x32_bf16 v[52:55], a[172:175], v[148:151], v[52:55]
    v_mfma_f32_16x16x32_bf16 v[60:63], a[176:179], v[148:151], v[60:63]
    s_cbranch_vccnz zv1_8_slow
zv1_8_ok:
    v_mfma_f32_16x16x32_bf16 v[68:71], v[72:75], v[148:151], v[68:71]
    s_waitcnt lgkmcnt(0)
    v_mfma_f32_16x16x32_bf16 v[24:27], a[180:183], v[152:155], v[24:27]
    ds_read_b128 a[160:163], v14 offset:13312
    ds_read_b128 a[164:167], v14 offset:18432
    v_mfma_f32_16x16x32_bf16 v[32:35], a[184:187], v[152:155], v[32:35]
    ds_read_b128 a[168:171], v14 offset:54272
    ds_read_b128 a[172:175], v14 offset:59392
    v_mfma_f32_16x16x32_bf16 v[40:43], a[188:191], v[152:155], v[40:43]
    ds_read_b128 a[176:179], v1 offset:29696
    ds_read_b128 v[72:75], v1 offset:34816
    v_mfma_f32_16x16x32_bf16 v[48:51], a[192:195], v[152:155], v[48:51]
    v_add_u32 v3, 4096, v3
    v_mfma_f32_16x16x32_bf16 v[56:59], a[196:199], v[152:155], v[56:59]
    buffer_load_dwordx4 v[224:227], v3, s[4:7], 0 offen offset:0 sc1
    buffer_load_dwordx4 v[228:231], v3, s[4:7], 0 offen offset:256 sc1
    v_mfma_f32_16x16x32_bf16 v[64:67], v[76:79], v[152:155], v[64:67]
    v_mfma_f32_16x16x32_bf16 v[28:31], a[180:183], v[156:159], v[28:31]
    v_mfma_f32_16x16x32_bf16 v[36:39], a[184:187], v[156:159], v[36:39]
    s_waitcnt vmcnt(16)
    v_max_u32 v88, v160, v164
    v_cmp_eq_u32 vcc, -1, v88
    v_mfma_f32_16x16x32_bf16 v[44:47], a[188:191], v[156:159], v[44:47]
    buffer_load_dwordx4 v[232:235], v3, s[4:7], 0 offen offset:2048 sc1
    v_mfma_f32_16x16x32_bf16 v[52:55], a[192:195], v[156:159], v[52:55]
    v_mfma_f32_16x16x32_bf16 v[60:63], a[196:199], v[156:159], v[60:63]
    s_cbranch_vccnz zv1_9_slow
zv1_9_ok:
    v_mfma_f32_16x16x32_bf16 v[68:71], v[76:79], v[156:159], v[68:71]
    s_waitcnt lgkmcnt(0)
    v_mfma_f32_16x16x32_bf16 v[24:27], a[160:163], v[160:163], v[24:27]
    ds_read_b128 a[180:183], v14 offset:14336
    ds_read_b128 a[184:187], v14 offset:19456
    v_mfma_f32_16x16x32_bf16 v[32:35], a[164:167], v[160:163], v[32:35]
    buffer_load_dwordx4 v[236:239], v3, s[4:7], 0 offen offset:2304 sc1
    ds_read_b128 a[188:191], v14 offset:55296
    v_mfma_f32_16x16x32_bf16 v[40:43], a[168:171], v[160:163], v[40:43]
    ds_read_b128 a[192:195], v14 offset:60416
    ds_read_b128 a[196:199], v1 offset:30720
    v_mfma_f32_16x16x32_bf16 v[48:51], a[172:175], v[160:163], v[48:51]
    ds_read_b128 v[76:79], v1 offset:35840
    v_mfma_f32_16x16x32_bf16 v[56:59], a[176:179], v[160:163], v[56:59]
    v_add_u32 v3, 4096, v3
    v_mfma_f32_16x16x32_bf16 v[64:67], v[72:75], v[160:163], v[64:67]
    buffer_load_dwordx4 v[240:243], v3, s[4:7], 0 offen offset:0 sc1
    v_mfma_f32_16x16x32_bf16 v[28:31], a[160:163], v[164:167], v[28:31]
    v_mfma_f32_16x16x32_bf16 v[36:39], a[164:167], v[164:167], v[36:39]
    s_waitcnt vmcnt(17)
    v_max_u32 v88, v168, v172
    v_cmp_eq_u32 vcc, -1, v88
    v_mfma_f32_16x16x32_bf16 v[44:47], a[168:171], v[164:167], v[44:47]
    buffer_load_dwordx4 v[244:247], v3, s[4:7], 0 offen offset:256 sc1
    v_mfma_f32_16x16x32_bf16 v[52:55], a[172:175], v[164:167], v[52:55]
    v_mfma_f32_16x16x32_bf16 v[60:63], a[176:179], v[164:167], v[60:63]
    s_cbranch_vccnz zv1_10_slow
zv1_10_ok:
    v_mfma_f32_16x16x32_bf16 v[68:71], v[72:75], v[164:167], v[68:71]
    s_waitcnt lgkmcnt(0)
    s_barrier
    v_mfma_f32_16x16x32_bf16 v[24:27], a[180:183], v[168:171], v[24:27]
    ds_read_b128 a[160:163], v14 offset:20480
    ds_read_b128 a[164:167], v14 offset:25600
    v_mfma_f32_16x16x32_bf16 v[32:35], a[184:187], v[168:171], v[32:35]
    buffer_load_dwordx4 v[248:251], v3, s[4:7], 0 offen offset:2048 sc1
    ds_read_b128 a[168:171], v14 offset:61440
    v_mfma_f32_16x16x32_bf16 v[40:43], a[188:191], v[168:171], v[40:43]
    ds_read_b128 a[172:175], v1 offset:1024
    ds_read_b128 a[176:179], v1 offset:36864
    v_mfma_f32_16x16x32_bf16 v[48:51], a[192:195], v[168:171], v[48:51]
    ds_read_b128 v[72:75], v1 offset:41984
    v_mfma_f32_16x16x32_bf16 v[56:59], a[196:199], v[168:171], v[56:59]
    buffer_load_dwordx4 v[252:255], v3, s[4:7], 0 offen offset:2304 sc1
    v_mfma_f32_16x16x32_bf16 v[64:67], v[76:79], v[168:171], v[64:67]
    v_mfma_f32_16x16x32_bf16 v[28:31], a[180:183], v[172:175], v[28:31]
    v_mfma_f32_16x16x32_bf16 v[36:39], a[184:187], v[172:175], v[36:39]
    s_waitcnt vmcnt(18)
    v_max_u32 v88, v176, v180
    v_cmp_eq_u32 vcc, -1, v88
    v_mfma_f32_16x16x32_bf16 v[44:47], a[188:191], v[172:175], v[44:47]
    s_add_u32 m0, s34, 126976
    v_add_u32 v13, m0, v11
    v_mfma_f32_16x16x32_bf16 v[52:55], a[192:195], v[172:175], v[52:55]
    buffer_load_dwordx4 v13, s[4:7], 0 offen offset:0 sc1 lds
    v_mfma_f32_16x16x32_bf16 v[60:63], a[196:199], v[172:175], v[60:63]
    s_cbranch_vccnz zv1_11_slow
zv1_11_ok:
    v_mfma_f32_16x16x32_bf16 v[68:71], v[76:79], v[172:175], v[68:71]
    s_waitcnt lgkmcnt(0)
    v_mfma_f32_16x16x32_bf16 v[24:27], a[160:163], v[176:179], v[24:27]
    ds_read_b128 a[180:183], v14 offset:21504
    ds_read_b128 a[184:187], v14 offset:26624
    v_mfma_f32_16x16x32_bf16 v[32:35], a[164:167], v[176:179], v[32:35]
    buffer_load_dwordx4 v13, s[4:7], 0 offen offset:1024 sc1 lds
    ds_read_b128 a[188:191], v14 offset:62464
    v_mfma_f32_16x16x32_bf16 v[40:43], a[168:171], v[176:179], v[40:43]
    ds_read_b128 a[192:195], v1 offset:2048
    ds_read_b128 a[196:199], v1 offset:37888
    v_mfma_f32_16x16x32_bf16 v[48:51], a[172:175], v[176:179], v[48:51]
    ds_read_b128 v[76:79], v1 offset:43008
    v_mfma_f32_16x16x32_bf16 v[56:59], a[176:179], v[176:179], v[56:59]
    buffer_load_dwordx4 v13, s[4:7], 0 offen offset:2048 sc1 lds
    v_mfma_f32_16x16x32_bf16 v[64:67], v[72:75], v[176:179], v[64:67]
    v_mfma_f32_16x16x32_bf16 v[28:31], a[160:163], v[180:183], v[28:31]
    v_mfma_f32_16x16x32_bf16 v[36:39], a[164:167], v[180:183], v[36:39]
    s_waitcnt vmcnt(19)
    v_max_u32 v88, v184, v188
    v_cmp_eq_u32 vcc, -1, v88
    v_mfma_f32_16x16x32_bf16 v[44:47], a[168:171], v[180:183], v[44:47]
    buffer_load_dwordx4 v13, s[4:7], 0 offen offset:3072 sc1 lds
    v_mfma_f32_16x16x32_bf16 v[52:55], a[172:175], v[180:183], v[52:55]
    v_mfma_f32_16x16x32_bf16 v[60:63], a[176:179], v[180:183], v[60:63]
    s_cbranch_vccnz zv1_12_slow
zv1_12_ok:
    v_lshrrev_b32 v7, 5, v0
    v_mul_u32_u24 v7, 81408, v7
    v_mfma_f32_16x16x32_bf16 v[68:71], v[72:75], v[180:183], v[68:71]
    s_waitcnt lgkmcnt(0)
    v_bfe_u32 v10, v0, 4, 1
    s_mov_b32 s8, s62
    v_mfma_f32_16x16x32_bf16 v[24:27], a[180:183], v[184:187], v[24:27]
    s_add_u32 m0, s34, 131072
    ds_read_b128 a[160:163], v14 offset:22528
    ds_read_b128 a[164:167], v14 offset:27648
    v_mfma_f32_16x16x32_bf16 v[32:35], a[184:187], v[184:187], v[32:35]
    s_and_b32 s9, s63, 0xffff
    ds_read_b128 a[168:171], v14 offset:63488
    ds_read_b128 a[172:175], v1 offset:3072
    v_mfma_f32_16x16x32_bf16 v[40:43], a[188:191], v[184:187], v[40:43]
    s_mov_b32 s10, 0x280000
    ds_read_b128 a[176:179], v1 offset:38912
    ds_read_b128 v[72:75], v1 offset:44032
    v_mfma_f32_16x16x32_bf16 v[48:51], a[192:195], v[184:187], v[48:51]
    s_mov_b32 s11, 0x20000
    v_add_u32 v13, m0, v11
    s_and_b32 s42, s16, 1
    v_mfma_f32_16x16x32_bf16 v[56:59], a[196:199], v[184:187], v[56:59]
    buffer_load_dwordx4 v13, s[4:7], 0 offen offset:0 sc1 lds
    buffer_load_dwordx4 v13, s[4:7], 0 offen offset:1024 sc1 lds
    v_mfma_f32_16x16x32_bf16 v[64:67], v[76:79], v[184:187], v[64:67]
    s_lshl_b32 s42, s42, 1
    s_lshr_b32 s41, s16, 1
    s_add_u32 s42, s42, s41
    v_mfma_f32_16x16x32_bf16 v[28:31], a[180:183], v[188:191], v[28:31]
    s_lshl_b32 s41, s18, 3
    s_add_u32 s42, s42, s41
    s_lshl_b32 s42, s42, 4
    v_mfma_f32_16x16x32_bf16 v[36:39], a[184:187], v[188:191], v[36:39]
    s_waitcnt vmcnt(20)
    v_max_u32 v88, v192, v196
    v_cmp_eq_u32 vcc, -1, v88
    v_mfma_f32_16x16x32_bf16 v[44:47], a[188:191], v[188:191], v[44:47]
    s_add_u32 s42, s42, s17
    s_mul_i32 s42, s42, 1280
    v_add3_u32 v7, v7, v14, s42
    v_mfma_f32_16x16x32_bf16 v[52:55], a[192:195], v[188:191], v[52:55]
    buffer_load_dwordx4 v13, s[4:7], 0 offen offset:2048 sc1 lds
    v_lshl_add_u32 v10, v10, 31, v7
    v_mfma_f32_16x16x32_bf16 v[60:63], a[196:199], v[188:191], v[60:63]
    s_cbranch_vccnz zv1_13_slow
zv1_13_ok:
    v_mfma_f32_16x16x32_bf16 v[68:71], v[76:79], v[188:191], v[68:71]
    s_waitcnt lgkmcnt(0)
    v_mfma_f32_16x16x32_bf16 v[24:27], a[160:163], v[192:195], v[24:27]
    ds_read_b128 a[180:183], v14 offset:23552
    ds_read_b128 a[184:187], v14 offset:28672
    v_mfma_f32_16x16x32_bf16 v[32:35], a[164:167], v[192:195], v[32:35]
    ds_read_b128 a[188:191], v14 offset:64512
    buffer_load_dwordx4 v13, s[4:7], 0 offen offset:3072 sc1 lds
    v_mfma_f32_16x16x32_bf16 v[40:43], a[168:171], v[192:195], v[40:43]
    ds_read_b128 a[192:195], v1 offset:4096
    ds_read_b128 a[196:199], v1 offset:39936
    v_mfma_f32_16x16x32_bf16 v[48:51], a[172:175], v[192:195], v[48:51]
    ds_read_b128 v[76:79], v1 offset:45056
    v_mfma_f32_16x16x32_bf16 v[56:59], a[176:179], v[192:195], v[56:59]
    v_mfma_f32_16x16x32_bf16 v[64:67], v[72:75], v[192:195], v[64:67]
    s_add_u32 m0, s34, 135168
    v_add_u32 v13, m0, v11
    v_mfma_f32_16x16x32_bf16 v[28:31], a[160:163], v[196:199], v[28:31]
    buffer_load_dwordx4 v13, s[4:7], 0 offen offset:0 sc1 lds
    v_mfma_f32_16x16x32_bf16 v[36:39], a[164:167], v[196:199], v[36:39]
    s_waitcnt vmcnt(21)
    v_max_u32 v88, v200, v204
    v_cmp_eq_u32 vcc, -1, v88
    v_mfma_f32_16x16x32_bf16 v[44:47], a[168:171], v[196:199], v[44:47]
    v_mfma_f32_16x16x32_bf16 v[52:55], a[172:175], v[196:199], v[52:55]
    s_add_u32 m0, s29, 0
    v_add_u32 v11, 0x28000, v11
    v_add_u32 v13, m0, v11
    v_mfma_f32_16x16x32_bf16 v[60:63], a[176:179], v[196:199], v[60:63]
    buffer_load_dwordx4 v13, s[4:7], 0 offen offset:0 sc1 lds
    s_cbranch_vccnz zv1_14_slow
zv1_14_ok:
    v_mfma_f32_16x16x32_bf16 v[68:71], v[72:75], v[196:199], v[68:71]
    s_waitcnt lgkmcnt(0)
    v_mfma_f32_16x16x32_bf16 v[24:27], a[180:183], v[200:203], v[24:27]
    ds_read_b128 a[160:163], v14 offset:24576
    ds_read_b128 a[164:167], v14 offset:29696
    v_mfma_f32_16x16x32_bf16 v[32:35], a[184:187], v[200:203], v[32:35]
    ds_read_b128 a[168:171], v1 offset:0
    buffer_load_dwordx4 v13, s[4:7], 0 offen offset:1024 sc1 lds
    v_mfma_f32_16x16x32_bf16 v[40:43], a[188:191], v[200:203], v[40:43]
    ds_read_b128 a[172:175], v1 offset:5120
    ds_read_b128 a[176:179], v1 offset:40960
    v_mfma_f32_16x16x32_bf16 v[48:51], a[192:195], v[200:203], v[48:51]
    ds_read_b128 v[72:75], v1 offset:46080
    v_mfma_f32_16x16x32_bf16 v[56:59], a[196:199], v[200:203], v[56:59]
    v_mfma_f32_16x16x32_bf16 v[64:67], v[76:79], v[200:203], v[64:67]
    buffer_load_dwordx4 v13, s[4:7], 0 offen offset:2048 sc1 lds
    v_mfma_f32_16x16x32_bf16 v[28:31], a[180:183], v[204:207], v[28:31]
    v_mfma_f32_16x16x32_bf16 v[36:39], a[184:187], v[204:207], v[36:39]
    s_waitcnt vmcnt(22)
    v_max_u32 v88, v208, v212
    v_cmp_eq_u32 vcc, -1, v88
    v_mfma_f32_16x16x32_bf16 v[44:47], a[188:191], v[204:207], v[44:47]
    v_mfma_f32_16x16x32_bf16 v[52:55], a[192:195], v[204:207], v[52:55]
    v_mfma_f32_16x16x32_bf16 v[60:63], a[196:199], v[204:207], v[60:63]
    s_cbranch_vccnz zv1_15_slow
zv1_15_ok:
    v_mfma_f32_16x16x32_bf16 v[68:71], v[76:79], v[204:207], v[68:71]
    s_waitcnt lgkmcnt(0)
    buffer_load_dwordx4 v13, s[4:7], 0 offen offset:3072 sc1 lds
    v_mfma_f32_16x16x32_bf16 v[24:27], a[160:163], v[208:211], v[24:27]
    ds_read_b128 a[180:183], v14 offset:30720
    ds_read_b128 a[184:187], v14 offset:31744
    v_mfma_f32_16x16x32_bf16 v[32:35], a[164:167], v[208:211], v[32:35]
    ds_read_b128 a[188:191], v14 offset:32768
    ds_read_b128 a[192:195], v14 offset:33792
    v_mfma_f32_16x16x32_bf16 v[40:43], a[168:171], v[208:211], v[40:43]
    s_add_u32 m0, s29, 4096
    ds_read_b128 a[196:199], v14 offset:34816
    v_add_u32 v13, m0, v11
    v_mfma_f32_16x16x32_bf16 v[48:51], a[172:175], v[208:211], v[48:51]
    buffer_load_dwordx4 v13, s[4:7], 0 offen offset:0 sc1 lds
    v_mfma_f32_16x16x32_bf16 v[56:59], a[176:179], v[208:211], v[56:59]
    v_mfma_f32_16x16x32_bf16 v[64:67], v[72:75], v[208:211], v[64:67]
    s_waitcnt vmcnt(14)
    v_max_u32 v88, v216, v220
    v_max3_u32 v88, v88, v224, v228
    v_mfma_f32_16x16x32_bf16 v[28:31], a[160:163], v[212:215], v[28:31]
    s_add_u32 m0, s29, 40960
    v_max3_u32 v88, v88, v232, v236
    v_add_u32 v11, 0xffffb000, v11
    v_mfma_f32_16x16x32_bf16 v[36:39], a[164:167], v[212:215], v[36:39]
    v_add_u32 v13, m0, v11
    v_max3_u32 v88, v88, v240, v244
    v_mfma_f32_16x16x32_bf16 v[44:47], a[168:171], v[212:215], v[44:47]
    buffer_load_dwordx4 v13, s[4:7], 0 offen offset:0 sc1 lds
    v_max3_u32 v88, v88, v248, v252
    v_mfma_f32_16x16x32_bf16 v[52:55], a[172:175], v[212:215], v[52:55]
    v_cmp_eq_u32 vcc, -1, v88
    v_mfma_f32_16x16x32_bf16 v[60:63], a[176:179], v[212:215], v[60:63]
    s_cbranch_vccnz zv1_16_slow
zv1_16_ok:
    v_mfma_f32_16x16x32_bf16 v[68:71], v[72:75], v[212:215], v[68:71]
    s_waitcnt lgkmcnt(0)
    buffer_load_dwordx4 v13, s[4:7], 0 offen offset:1024 sc1 lds
    v_mfma_f32_16x16x32_bf16 v[24:27], a[180:183], v[216:219], v[24:27]
    ds_read_b128 a[160:163], v1 offset:6144
    ds_read_b128 a[164:167], v1 offset:7168
    v_mfma_f32_16x16x32_bf16 v[24:27], a[184:187], v[224:227], v[24:27]
    ds_read_b128 a[168:171], v1 offset:8192
    ds_read_b128 a[172:175], v1 offset:9216
    v_mfma_f32_16x16x32_bf16 v[24:27], a[188:191], v[232:235], v[24:27]
    buffer_load_dwordx4 v13, s[4:7], 0 offen offset:2048 sc1 lds
    ds_read_b128 a[176:179], v1 offset:10240
    v_mfma_f32_16x16x32_bf16 v[24:27], a[192:195], v[240:243], v[24:27]
    v_mfma_f32_16x16x32_bf16 v[24:27], a[196:199], v[248:251], v[24:27]
    v_mfma_f32_16x16x32_bf16 v[28:31], a[180:183], v[220:223], v[28:31]
    v_mfma_f32_16x16x32_bf16 v[28:31], a[184:187], v[228:231], v[28:31]
    buffer_load_dwordx4 v13, s[4:7], 0 offen offset:3072 sc1 lds
    v_mfma_f32_16x16x32_bf16 v[28:31], a[188:191], v[236:239], v[28:31]
    v_mfma_f32_16x16x32_bf16 v[28:31], a[192:195], v[244:247], v[28:31]
    v_mfma_f32_16x16x32_bf16 v[28:31], a[196:199], v[252:255], v[28:31]
    s_waitcnt lgkmcnt(0)
    v_mfma_f32_16x16x32_bf16 v[40:43], a[160:163], v[216:219], v[40:43]
    ds_read_b128 a[180:183], v1 offset:47104
    ds_read_b128 a[184:187], v1 offset:48128
    v_mfma_f32_16x16x32_bf16 v[40:43], a[164:167], v[224:227], v[40:43]
    s_add_u32 m0, s29, 45056
    ds_read_b128 a[188:191], v1 offset:49152
    ds_read_b128 a[192:195], v1 offset:50176
    v_mfma_f32_16x16x32_bf16 v[40:43], a[168:171], v[232:235], v[40:43]
    ds_read_b128 a[196:199], v1 offset:51200
    v_add_u32 v13, m0, v11
    v_mfma_f32_16x16x32_bf16 v[40:43], a[172:175], v[240:243], v[40:43]
    buffer_load_dwordx4 v13, s[4:7], 0 offen offset:0 sc1 lds
    v_mfma_f32_16x16x32_bf16 v[40:43], a[176:179], v[248:251], v[40:43]
    v_mfma_f32_16x16x32_bf16 v[44:47], a[160:163], v[220:223], v[44:47]
    s_add_u32 m0, s29, 81920
    v_add_u32 v11, 0xffffb000, v11
    v_add_u32 v13, m0, v11
    v_mfma_f32_16x16x32_bf16 v[44:47], a[164:167], v[228:231], v[44:47]
    v_exp_f32_e64 v88, -v24
    v_mfma_f32_16x16x32_bf16 v[44:47], a[168:171], v[236:239], v[44:47]
    buffer_load_dwordx4 v13, s[4:7], 0 offen offset:0 sc1 lds
    v_fma_f32 v88, v88, s31, s31
    v_mfma_f32_16x16x32_bf16 v[44:47], a[172:175], v[244:247], v[44:47]
    v_exp_f32_e64 v89, -v25
    v_mfma_f32_16x16x32_bf16 v[44:47], a[176:179], v[252:255], v[44:47]
    s_waitcnt lgkmcnt(0)
    buffer_load_dwordx4 v13, s[4:7], 0 offen offset:1024 sc1 lds
    v_fma_f32 v89, v89, s31, s31
    v_mfma_f32_16x16x32_bf16 v[56:59], a[180:183], v[216:219], v[56:59]
    ds_read_b128 a[160:163], v14 offset:35840
    ds_read_b128 a[164:167], v14 offset:36864
    v_mfma_f32_16x16x32_bf16 v[56:59], a[184:187], v[224:227], v[56:59]
    ds_read_b128 a[168:171], v14 offset:37888
    ds_read_b128 a[172:175], v14 offset:38912
    v_mfma_f32_16x16x32_bf16 v[56:59], a[188:191], v[232:235], v[56:59]
    ds_read_b128 a[176:179], v14 offset:39936
    v_mfma_f32_16x16x32_bf16 v[56:59], a[192:195], v[240:243], v[56:59]
    v_exp_f32_e64 v90, -v26
    v_mfma_f32_16x16x32_bf16 v[56:59], a[196:199], v[248:251], v[56:59]
    buffer_load_dwordx4 v13, s[4:7], 0 offen offset:2048 sc1 lds
    v_fma_f32 v90, v90, s31, s31
    v_mfma_f32_16x16x32_bf16 v[60:63], a[180:183], v[220:223], v[60:63]
    v_exp_f32_e64 v91, -v27
    v_mfma_f32_16x16x32_bf16 v[60:63], a[184:187], v[228:231], v[60:63]
    v_exp_f32_e64 v92, -v28
    v_mfma_f32_16x16x32_bf16 v[60:63], a[188:191], v[236:239], v[60:63]
    buffer_load_dwordx4 v13, s[4:7], 0 offen offset:3072 sc1 lds
    v_fma_f32 v91, v91, s31, s31
    v_mfma_f32_16x16x32_bf16 v[60:63], a[192:195], v[244:247], v[60:63]
    v_exp_f32_e64 v93, -v29
    v_mfma_f32_16x16x32_bf16 v[60:63], a[196:199], v[252:255], v[60:63]
    s_waitcnt lgkmcnt(0)
    v_exp_f32_e64 v94, -v30
    v_mfma_f32_16x16x32_bf16 v[32:35], a[160:163], v[216:219], v[32:35]
    ds_read_b128 a[180:183], v1 offset:11264
    ds_read_b128 a[184:187], v1 offset:12288
    v_mfma_f32_16x16x32_bf16 v[32:35], a[164:167], v[224:227], v[32:35]
    s_add_u32 m0, s29, 86016
    ds_read_b128 a[188:191], v1 offset:13312
    ds_read_b128 a[192:195], v1 offset:14336
    v_mfma_f32_16x16x32_bf16 v[32:35], a[168:171], v[232:235], v[32:35]
    ds_read_b128 a[196:199], v1 offset:15360
    v_add_u32 v13, m0, v11
    v_mfma_f32_16x16x32_bf16 v[32:35], a[172:175], v[240:243], v[32:35]
    buffer_load_dwordx4 v13, s[4:7], 0 offen offset:0 sc1 lds
    v_fma_f32 v92, v92, s31, s31
    v_mfma_f32_16x16x32_bf16 v[32:35], a[176:179], v[248:251], v[32:35]
    v_exp_f32_e64 v95, -v31
    v_mfma_f32_16x16x32_bf16 v[36:39], a[160:163], v[220:223], v[36:39]
    v_rcp_f32 v88, v88
    v_mfma_f32_16x16x32_bf16 v[36:39], a[164:167], v[228:231], v[36:39]
    v_rcp_f32 v89, v89
    v_mfma_f32_16x16x32_bf16 v[36:39], a[168:171], v[236:239], v[36:39]
    v_rcp_f32 v90, v90
    v_mfma_f32_16x16x32_bf16 v[36:39], a[172:175], v[244:247], v[36:39]
    v_rcp_f32 v91, v91
    v_mfma_f32_16x16x32_bf16 v[36:39], a[176:179], v[252:255], v[36:39]
    s_waitcnt lgkmcnt(0)
    v_rcp_f32 v92, v92
    v_mfma_f32_16x16x32_bf16 v[48:51], a[180:183], v[216:219], v[48:51]
    ds_read_b128 a[160:163], v1 offset:52224
    ds_read_b128 a[164:167], v1 offset:53248
    v_mfma_f32_16x16x32_bf16 v[48:51], a[184:187], v[224:227], v[48:51]
    ds_read_b128 a[168:171], v1 offset:54272
    ds_read_b128 a[172:175], v1 offset:55296
    v_mfma_f32_16x16x32_bf16 v[48:51], a[188:191], v[232:235], v[48:51]
    ds_read_b128 a[176:179], v1 offset:56320
    v_fma_f32 v93, v93, s31, s31
    v_mfma_f32_16x16x32_bf16 v[48:51], a[192:195], v[240:243], v[48:51]
    v_rcp_f32 v93, v93
    v_mfma_f32_16x16x32_bf16 v[48:51], a[196:199], v[248:251], v[48:51]
    v_fma_f32 v94, v94, s31, s31
    v_fma_f32 v95, v95, s31, s31
    v_mfma_f32_16x16x32_bf16 v[52:55], a[180:183], v[220:223], v[52:55]
    v_rcp_f32 v94, v94
    v_mfma_f32_16x16x32_bf16 v[52:55], a[184:187], v[228:231], v[52:55]
    v_rcp_f32 v95, v95
    v_mfma_f32_16x16x32_bf16 v[52:55], a[188:191], v[236:239], v[52:55]
    v_mul_f32 v24, v24, v88
    v_mul_f32 v25, v25, v89
    v_mfma_f32_16x16x32_bf16 v[52:55], a[192:195], v[244:247], v[52:55]
    v_exp_f32_e64 v88, -v40
    v_mfma_f32_16x16x32_bf16 v[52:55], a[196:199], v[252:255], v[52:55]
    s_waitcnt vmcnt(15) lgkmcnt(0)
    s_barrier
    v_mul_f32 v26, v26, v90
    v_mfma_f32_16x16x32_bf16 v[64:67], a[160:163], v[216:219], v[64:67]
    ds_read_b128 a[180:183], v1 offset:57344
    ds_read_b128 a[184:187], v1 offset:58368
    v_mfma_f32_16x16x32_bf16 v[64:67], a[164:167], v[224:227], v[64:67]
    ds_read_b128 a[188:191], v1 offset:59392
    ds_read_b128 a[192:195], v1 offset:60416
    v_mfma_f32_16x16x32_bf16 v[64:67], a[168:171], v[232:235], v[64:67]
    s_add_u32 m0, s29, 20480
    ds_read_b128 a[196:199], v1 offset:61440
    v_add_u32 v11, 0x14000, v11
    v_mfma_f32_16x16x32_bf16 v[64:67], a[172:175], v[240:243], v[64:67]
    v_add_u32 v13, m0, v11
    v_mul_f32 v27, v27, v91
    v_mfma_f32_16x16x32_bf16 v[64:67], a[176:179], v[248:251], v[64:67]
    buffer_load_dwordx4 v13, s[4:7], 0 offen offset:0 sc1 lds
    v_mul_f32 v28, v28, v92
    v_mfma_f32_16x16x32_bf16 v[68:71], a[160:163], v[220:223], v[68:71]
    v_exp_f32_e64 v89, -v41
    v_mfma_f32_16x16x32_bf16 v[68:71], a[164:167], v[228:231], v[68:71]
    buffer_load_dwordx4 v13, s[4:7], 0 offen offset:1024 sc1 lds
    v_mul_f32 v29, v29, v93
    v_mfma_f32_16x16x32_bf16 v[68:71], a[168:171], v[236:239], v[68:71]
    v_exp_f32_e64 v90, -v42
    v_mfma_f32_16x16x32_bf16 v[68:71], a[172:175], v[244:247], v[68:71]
    v_exp_f32_e64 v91, -v43
    v_mfma_f32_16x16x32_bf16 v[68:71], a[176:179], v[252:255], v[68:71]
    s_waitcnt lgkmcnt(0)
    v_exp_f32_e64 v92, -v44
    v_mfma_f32_16x16x32_bf16 v[72:75], a[180:183], v[96:99], 0
    ds_read_b128 a[160:163], v2 offset:2048
    ds_read_b128 a[164:167], v2 offset:3072
    v_mfma_f32_16x16x32_bf16 v[72:75], a[184:187], v[104:107], v[72:75]
    ds_read_b128 a[168:171], v2 offset:4096
    buffer_load_dwordx4 v13, s[4:7], 0 offen offset:2048 sc1 lds
    v_mfma_f32_16x16x32_bf16 v[72:75], a[188:191], v[112:115], v[72:75]
    ds_read_b128 a[172:175], v2 offset:5120
    ds_read_b128 a[176:179], v2 offset:6144
    v_mfma_f32_16x16x32_bf16 v[72:75], a[192:195], v[120:123], v[72:75]
    v_exp_f32_e64 v93, -v45
    v_mfma_f32_16x16x32_bf16 v[72:75], a[196:199], v[128:131], v[72:75]
    v_fma_f32 v88, v88, s31, s31
    v_mul_f32 v30, v30, v94
    v_mfma_f32_16x16x32_bf16 v[76:79], a[180:183], v[100:103], 0
    buffer_load_dwordx4 v13, s[4:7], 0 offen offset:3072 sc1 lds
    v_mul_f32 v31, v31, v95
    v_mfma_f32_16x16x32_bf16 v[76:79], a[184:187], v[108:111], v[76:79]
    v_exp_f32_e64 v94, -v46
    v_mfma_f32_16x16x32_bf16 v[76:79], a[188:191], v[116:119], v[76:79]
    v_exp_f32_e64 v95, -v47
    v_mfma_f32_16x16x32_bf16 v[76:79], a[192:195], v[124:127], v[76:79]
    v_rcp_f32 v88, v88
    v_mfma_f32_16x16x32_bf16 v[76:79], a[196:199], v[132:135], v[76:79]
    s_waitcnt lgkmcnt(0)
    v_fma_f32 v89, v89, s31, s31
    v_fma_f32 v90, v90, s31, s31
    v_mfma_f32_16x16x32_bf16 v[72:75], a[160:163], v[136:139], v[72:75]
    s_add_u32 m0, s29, 24576
    ds_read_b128 a[180:183], v2 offset:12288
    ds_read_b128 a[184:187], v2 offset:13312
    v_mfma_f32_16x16x32_bf16 v[72:75], a[164:167], v[144:147], v[72:75]
    ds_read_b128 a[188:191], v2 offset:14336
    ds_read_b128 a[192:195], v2 offset:15360
    v_mfma_f32_16x16x32_bf16 v[72:75], a[168:171], v[152:155], v[72:75]
    ds_read_b128 a[196:199], v2 offset:16384
    v_add_u32 v13, m0, v11
    v_mfma_f32_16x16x32_bf16 v[72:75], a[172:175], v[160:163], v[72:75]
    buffer_load_dwordx4 v13, s[4:7], 0 offen offset:0 sc1 lds
    v_fma_f32 v91, v91, s31, s31
    v_mfma_f32_16x16x32_bf16 v[72:75], a[176:179], v[168:171], v[72:75]
    s_add_u32 m0, s29, 61440
    v_add_u32 v11, 0xffffb000, v11
    v_add_u32 v11, s30, v11
    v_mfma_f32_16x16x32_bf16 v[76:79], a[160:163], v[140:143], v[76:79]
    s_branch .Lps6208
hop2_3:
.Lpd6208:
    s_branch .Lpd8061
.Lps6208:
    v_add_u32 v13, m0, v11
    v_fma_f32 v92, v92, s31, s31
    v_mfma_f32_16x16x32_bf16 v[76:79], a[164:167], v[148:151], v[76:79]
    buffer_load_dwordx4 v13, s[4:7], 0 offen offset:0 sc1 lds
    v_fma_f32 v93, v93, s31, s31
    v_mfma_f32_16x16x32_bf16 v[76:79], a[168:171], v[156:159], v[76:79]
    v_rcp_f32 v89, v89
    v_mfma_f32_16x16x32_bf16 v[76:79], a[172:175], v[164:167], v[76:79]
    v_rcp_f32 v90, v90
    v_mfma_f32_16x16x32_bf16 v[76:79], a[176:179], v[172:175], v[76:79]
    s_waitcnt lgkmcnt(0)
    buffer_load_dwordx4 v13, s[4:7], 0 offen offset:1024 sc1 lds
    v_fma_f32 v94, v94, s31, s31
    v_mfma_f32_16x16x32_bf16 v[72:75], a[180:183], v[176:179], v[72:75]
    ds_read_b128 a[160:163], v2 offset:22528
    ds_read_b128 a[164:167], v2 offset:23552
    v_mfma_f32_16x16x32_bf16 v[72:75], a[184:187], v[184:187], v[72:75]
    ds_read_b128 a[168:171], v2 offset:24576
    ds_read_b128 a[172:175], v2 offset:25600
    v_mfma_f32_16x16x32_bf16 v[72:75], a[188:191], v[192:195], v[72:75]
    ds_read_b128 a[176:179], v2 offset:26624
    v_fma_f32 v95, v95, s31, s31
    v_mfma_f32_16x16x32_bf16 v[72:75], a[192:195], v[200:203], v[72:75]
    buffer_load_dwordx4 v13, s[4:7], 0 offen offset:2048 sc1 lds
    v_mul_f32 v40, v40, v88
    v_mfma_f32_16x16x32_bf16 v[72:75], a[196:199], v[208:211], v[72:75]
    v_rcp_f32 v91, v91
    v_mfma_f32_16x16x32_bf16 v[76:79], a[180:183], v[180:183], v[76:79]
    v_rcp_f32 v92, v92
    v_mfma_f32_16x16x32_bf16 v[76:79], a[184:187], v[188:191], v[76:79]
    v_mul_f32 v41, v41, v89
    v_mul_f32 v42, v42, v90
    v_mfma_f32_16x16x32_bf16 v[76:79], a[188:191], v[196:199], v[76:79]
    v_rcp_f32 v93, v93
    v_mfma_f32_16x16x32_bf16 v[76:79], a[192:195], v[204:207], v[76:79]
    buffer_load_dwordx4 v13, s[4:7], 0 offen offset:3072 sc1 lds
    v_mul_f32 v32, v32, v24
    v_mfma_f32_16x16x32_bf16 v[76:79], a[196:199], v[212:215], v[76:79]
    s_waitcnt lgkmcnt(0)
    v_mul_f32 v33, v33, v25
    v_mul_f32 v43, v43, v91
    v_mfma_f32_16x16x32_bf16 v[72:75], a[160:163], v[216:219], v[72:75]
    ds_read_b128 a[180:183], v1 offset:62464
    ds_read_b128 a[184:187], v1 offset:63488
    v_mfma_f32_16x16x32_bf16 v[72:75], a[164:167], v[224:227], v[72:75]
    ds_read_b128 a[188:191], v1 offset:64512
    ds_read_b128 a[192:195], v2 offset:0
    v_mfma_f32_16x16x32_bf16 v[72:75], a[168:171], v[232:235], v[72:75]
    s_add_u32 m0, s29, 65536
    ds_read_b128 a[196:199], v2 offset:1024
    v_cvt_pk_bf16_f32 v16, v32, v33
    v_mfma_f32_16x16x32_bf16 v[72:75], a[172:175], v[240:243], v[72:75]
    v_mul_f32 v34, v34, v26
    v_mul_f32 v35, v35, v27
    v_mfma_f32_16x16x32_bf16 v[72:75], a[176:179], v[248:251], v[72:75]
    v_add_u32 v13, m0, v11
    v_mul_f32 v44, v44, v92
    v_mfma_f32_16x16x32_bf16 v[76:79], a[160:163], v[220:223], v[76:79]
    buffer_load_dwordx4 v13, s[4:7], 0 offen offset:0 sc1 lds
    v_cvt_pk_bf16_f32 v17, v34, v35
    v_mfma_f32_16x16x32_bf16 v[76:79], a[164:167], v[228:231], v[76:79]
    v_mul_f32 v36, v36, v28
    v_mul_f32 v45, v45, v93
    v_mfma_f32_16x16x32_bf16 v[76:79], a[168:171], v[236:239], v[76:79]
    s_add_u32 m0, s29, 102400
    v_mul_f32 v37, v37, v29
    v_cvt_pk_bf16_f32 v20, v36, v37
    v_mfma_f32_16x16x32_bf16 v[76:79], a[172:175], v[244:247], v[76:79]
    v_mul_f32 v38, v38, v30
    v_mul_f32 v39, v39, v31
    v_mfma_f32_16x16x32_bf16 v[76:79], a[176:179], v[252:255], v[76:79]
    s_waitcnt lgkmcnt(0)
    v_rcp_f32 v94, v94
    v_mfma_f32_16x16x32_bf16 v[80:83], a[180:183], v[96:99], 0
    ds_read_b128 a[160:163], v2 offset:7168
    ds_read_b128 a[164:167], v2 offset:8192
    v_mfma_f32_16x16x32_bf16 v[80:83], a[184:187], v[104:107], v[80:83]
    ds_read_b128 a[168:171], v2 offset:9216
    ds_read_b128 a[172:175], v2 offset:10240
    v_mfma_f32_16x16x32_bf16 v[80:83], a[188:191], v[112:115], v[80:83]
    ds_read_b128 a[176:179], v2 offset:11264
    v_mul_f32 v46, v46, v94
    v_mfma_f32_16x16x32_bf16 v[80:83], a[192:195], v[120:123], v[80:83]
    v_cvt_pk_bf16_f32 v21, v38, v39
    v_add_u32 v11, 0xffffb000, v11
    v_mfma_f32_16x16x32_bf16 v[80:83], a[196:199], v[128:131], v[80:83]
    v_add_u32 v13, m0, v11
    v_mul_f32 v48, v48, v40
    v_mfma_f32_16x16x32_bf16 v[84:87], a[180:183], v[100:103], 0
    buffer_load_dwordx4 v13, s[4:7], 0 offen offset:0 sc1 lds
    buffer_load_dwordx4 v13, s[4:7], 0 offen offset:1024 sc1 lds
    v_mfma_f32_16x16x32_bf16 v[84:87], a[184:187], v[108:111], v[84:87]
    v_rcp_f32 v95, v95
    s_nop 0
    v_mul_f32 v47, v47, v95
    v_mfma_f32_16x16x32_bf16 v[84:87], a[188:191], v[116:119], v[84:87]
    v_mul_f32 v49, v49, v41
    v_cvt_pk_bf16_f32 v18, v48, v49
    v_mfma_f32_16x16x32_bf16 v[84:87], a[192:195], v[124:127], v[84:87]
    v_mul_f32 v50, v50, v42
    v_mul_f32 v51, v51, v43
    v_mfma_f32_16x16x32_bf16 v[84:87], a[196:199], v[132:135], v[84:87]
    s_waitcnt lgkmcnt(0)
    v_cvt_pk_bf16_f32 v19, v50, v51
    v_mul_f32 v52, v52, v44
    v_mfma_f32_16x16x32_bf16 v[80:83], a[160:163], v[136:139], v[80:83]
    buffer_store_dwordx4 v[16:19], v14, s[4:7], s27 offen offset:0 sc1
    v_mfma_f32_16x16x32_bf16 v[80:83], a[164:167], v[144:147], v[80:83]
    ds_read_b128 a[180:183], v2 offset:17408
    ds_read_b128 a[184:187], v2 offset:18432
    v_mfma_f32_16x16x32_bf16 v[80:83], a[168:171], v[152:155], v[80:83]
    ds_read_b128 a[188:191], v2 offset:19456
    ds_read_b128 a[192:195], v2 offset:20480
    v_mfma_f32_16x16x32_bf16 v[80:83], a[172:175], v[160:163], v[80:83]
    ds_read_b128 a[196:199], v2 offset:21504
    v_mul_f32 v53, v53, v45
    v_mfma_f32_16x16x32_bf16 v[80:83], a[176:179], v[168:171], v[80:83]
    v_cvt_pk_bf16_f32 v22, v52, v53
    v_mul_f32 v54, v54, v46
    v_mul_f32 v55, v55, v47
    v_cvt_pk_bf16_f32 v23, v54, v55
    v_mfma_f32_16x16x32_bf16 v[84:87], a[160:163], v[140:143], v[84:87]
    buffer_store_dwordx4 v[20:23], v14, s[4:7], s27 offen offset:1024 sc1
    v_mfma_f32_16x16x32_bf16 v[84:87], a[164:167], v[148:151], v[84:87]
    s_add_u32 s27, s27, 8192
    v_exp_f32_e64 v88, -v56
    v_mfma_f32_16x16x32_bf16 v[84:87], a[168:171], v[156:159], v[84:87]
    buffer_load_dwordx4 v13, s[4:7], 0 offen offset:2048 sc1 lds
    v_fma_f32 v88, v88, s31, s31
    v_mfma_f32_16x16x32_bf16 v[84:87], a[172:175], v[164:167], v[84:87]
    v_exp_f32_e64 v89, -v57
    v_mfma_f32_16x16x32_bf16 v[84:87], a[176:179], v[172:175], v[84:87]
    s_waitcnt lgkmcnt(0)
    v_exp_f32_e64 v90, -v58
    v_mfma_f32_16x16x32_bf16 v[80:83], a[180:183], v[176:179], v[80:83]
    ds_read_b128 a[160:163], v2 offset:27648
    ds_read_b128 a[164:167], v2 offset:28672
    v_mfma_f32_16x16x32_bf16 v[80:83], a[184:187], v[184:187], v[80:83]
    ds_read_b128 a[168:171], v2 offset:29696
    ds_read_b128 a[172:175], v2 offset:30720
    v_mfma_f32_16x16x32_bf16 v[80:83], a[188:191], v[192:195], v[80:83]
    ds_read_b128 a[176:179], v2 offset:31744
    v_fma_f32 v89, v89, s31, s31
    v_mfma_f32_16x16x32_bf16 v[80:83], a[192:195], v[200:203], v[80:83]
    v_exp_f32_e64 v91, -v59
    v_mfma_f32_16x16x32_bf16 v[80:83], a[196:199], v[208:211], v[80:83]
    v_exp_f32_e64 v92, -v60
    v_mfma_f32_16x16x32_bf16 v[84:87], a[180:183], v[180:183], v[84:87]
    v_exp_f32_e64 v93, -v61
    v_mfma_f32_16x16x32_bf16 v[84:87], a[184:187], v[188:191], v[84:87]
    v_exp_f32_e64 v94, -v62
    v_mfma_f32_16x16x32_bf16 v[84:87], a[188:191], v[196:199], v[84:87]
    v_fma_f32 v90, v90, s31, s31
    v_fma_f32 v91, v91, s31, s31
    v_mfma_f32_16x16x32_bf16 v[84:87], a[192:195], v[204:207], v[84:87]
    v_exp_f32_e64 v95, -v63
    v_mfma_f32_16x16x32_bf16 v[84:87], a[196:199], v[212:215], v[84:87]
    s_waitcnt vmcnt(20) lgkmcnt(0)
    s_barrier
    v_fma_f32 v92, v92, s31, s31
    v_mfma_f32_16x16x32_bf16 v[80:83], a[160:163], v[216:219], v[80:83]
    ds_read_b128 a[180:183], v14 offset:0
    ds_read_b128 a[184:187], v14 offset:1024
    v_mfma_f32_16x16x32_bf16 v[80:83], a[164:167], v[224:227], v[80:83]
    ds_read_b128 a[188:191], v14 offset:2048
    ds_read_b128 a[192:195], v14 offset:3072
    v_mfma_f32_16x16x32_bf16 v[80:83], a[168:171], v[232:235], v[80:83]
    ds_read_b128 a[196:199], v14 offset:4096
    v_fma_f32 v93, v93, s31, s31
    v_mfma_f32_16x16x32_bf16 v[80:83], a[172:175], v[240:243], v[80:83]
    v_rcp_f32 v88, v88
    v_mfma_f32_16x16x32_bf16 v[80:83], a[176:179], v[248:251], v[80:83]
    v_rcp_f32 v89, v89
    v_mfma_f32_16x16x32_bf16 v[84:87], a[160:163], v[220:223], v[84:87]
    v_fma_f32 v94, v94, s31, s31
    v_fma_f32 v95, v95, s31, s31
    v_mfma_f32_16x16x32_bf16 v[84:87], a[164:167], v[228:231], v[84:87]
    buffer_store_dwordx4 v[96:99], v7, s[8:11], 0 offen offset:0 sc1
    v_mfma_f32_16x16x32_bf16 v[84:87], a[168:171], v[236:239], v[84:87]
    v_rcp_f32 v90, v90
    v_mfma_f32_16x16x32_bf16 v[84:87], a[172:175], v[244:247], v[84:87]
    v_rcp_f32 v91, v91
    v_mfma_f32_16x16x32_bf16 v[84:87], a[176:179], v[252:255], v[84:87]
    s_waitcnt lgkmcnt(0)
    buffer_load_dwordx4 v13, s[4:7], 0 offen offset:3072 sc1 lds
    v_mul_f32 v56, v56, v88
    v_mfma_f32_16x16x32_bf16 v[24:27], a[180:183], v[96:99], 0
    buffer_store_dwordx4 v[96:99], v7, s[8:11], 0 offen offset:512 sc1
    v_mfma_f32_16x16x32_bf16 v[24:27], a[184:187], v[104:107], v[24:27]
    ds_read_b128 a[160:163], v14 offset:10240
    ds_read_b128 a[164:167], v14 offset:11264
    v_mfma_f32_16x16x32_bf16 v[24:27], a[188:191], v[112:115], v[24:27]
    ds_read_b128 a[168:171], v14 offset:12288
    ds_read_b128 a[172:175], v14 offset:13312
    v_mfma_f32_16x16x32_bf16 v[24:27], a[192:195], v[120:123], v[24:27]
    ds_read_b128 a[176:179], v14 offset:14336
    v_mul_f32 v57, v57, v89
    v_mfma_f32_16x16x32_bf16 v[24:27], a[196:199], v[128:131], v[24:27]
    buffer_store_dwordx4 v[96:99], v10, s[8:11], 0 offen offset:1024 sc1
    v_mfma_f32_16x16x32_bf16 v[28:31], a[180:183], v[100:103], 0
    v_mul_f32 v58, v58, v90
    v_mul_f32 v59, v59, v91
    v_mfma_f32_16x16x32_bf16 v[28:31], a[184:187], v[108:111], v[28:31]
    v_rcp_f32 v92, v92
    v_mfma_f32_16x16x32_bf16 v[28:31], a[188:191], v[116:119], v[28:31]
    v_rcp_f32 v93, v93
    v_mfma_f32_16x16x32_bf16 v[28:31], a[192:195], v[124:127], v[28:31]
    v_mul_f32 v60, v60, v92
    v_mul_f32 v61, v61, v93
    v_mfma_f32_16x16x32_bf16 v[28:31], a[196:199], v[132:135], v[28:31]
    s_waitcnt lgkmcnt(0)
    v_rcp_f32 v94, v94
    v_mfma_f32_16x16x32_bf16 v[24:27], a[160:163], v[136:139], v[24:27]
    ds_read_b128 a[180:183], v14 offset:40960
    ds_read_b128 a[184:187], v14 offset:41984
    v_mfma_f32_16x16x32_bf16 v[24:27], a[164:167], v[144:147], v[24:27]
    ds_read_b128 a[188:191], v14 offset:43008
    ds_read_b128 a[192:195], v14 offset:44032
    v_mfma_f32_16x16x32_bf16 v[24:27], a[168:171], v[152:155], v[24:27]
    ds_read_b128 a[196:199], v14 offset:45056
    v_mul_f32 v62, v62, v94
    v_mfma_f32_16x16x32_bf16 v[24:27], a[172:175], v[160:163], v[24:27]
    v_rcp_f32 v95, v95
    v_mfma_f32_16x16x32_bf16 v[24:27], a[176:179], v[168:171], v[24:27]
    v_mul_f32 v63, v63, v95
    v_mul_f32 v64, v64, v56
    v_mfma_f32_16x16x32_bf16 v[28:31], a[160:163], v[140:143], v[28:31]
    v_exp_f32_e64 v88, -v72
    v_mfma_f32_16x16x32_bf16 v[28:31], a[164:167], v[148:151], v[28:31]
    v_fma_f32 v88, v88, s31, s31
    v_mul_f32 v65, v65, v57
    v_mfma_f32_16x16x32_bf16 v[28:31], a[168:171], v[156:159], v[28:31]
    v_exp_f32_e64 v89, -v73
    v_mfma_f32_16x16x32_bf16 v[28:31], a[172:175], v[164:167], v[28:31]
    v_fma_f32 v89, v89, s31, s31
    v_cvt_pk_bf16_f32 v16, v64, v65
    v_mfma_f32_16x16x32_bf16 v[28:31], a[176:179], v[172:175], v[28:31]
    s_waitcnt lgkmcnt(0)
    v_exp_f32_e64 v90, -v74
    v_mfma_f32_16x16x32_bf16 v[24:27], a[180:183], v[176:179], v[24:27]
    ds_read_b128 a[160:163], v14 offset:51200
    ds_read_b128 a[164:167], v14 offset:52224
    v_mfma_f32_16x16x32_bf16 v[24:27], a[184:187], v[184:187], v[24:27]
    ds_read_b128 a[168:171], v14 offset:53248
    ds_read_b128 a[172:175], v14 offset:54272
    v_mfma_f32_16x16x32_bf16 v[24:27], a[188:191], v[192:195], v[24:27]
    ds_read_b128 a[176:179], v14 offset:55296
    v_fma_f32 v90, v90, s31, s31
    v_mfma_f32_16x16x32_bf16 v[24:27], a[192:195], v[200:203], v[24:27]
    v_exp_f32_e64 v91, -v75
    v_mfma_f32_16x16x32_bf16 v[24:27], a[196:199], v[208:211], v[24:27]
    v_fma_f32 v91, v91, s31, s31
    v_mov_b32 v6, 0x1
    v_mfma_f32_16x16x32_bf16 v[28:31], a[180:183], v[180:183], v[28:31]
    s_waitcnt vmcnt(5)
    buffer_atomic_add v6, v12, s[4:7], s46 offen offset:0 sc1
    v_mfma_f32_16x16x32_bf16 v[28:31], a[184:187], v[188:191], v[28:31]
    s_add_u32 m0, s29, 106496
    v_exp_f32_e64 v92, -v76
    v_mfma_f32_16x16x32_bf16 v[28:31], a[188:191], v[196:199], v[28:31]
    v_fma_f32 v92, v92, s31, s31
    v_add_u32 v13, m0, v11
    v_mfma_f32_16x16x32_bf16 v[28:31], a[192:195], v[204:207], v[28:31]
    buffer_load_dwordx4 v13, s[4:7], 0 offen offset:0 sc1 lds
    v_mul_f32 v66, v66, v58
    v_mfma_f32_16x16x32_bf16 v[28:31], a[196:199], v[212:215], v[28:31]
    s_waitcnt lgkmcnt(0)
    v_exp_f32_e64 v93, -v77
    v_mfma_f32_16x16x32_bf16 v[24:27], a[160:163], v[216:219], v[24:27]
    ds_read_b128 a[180:183], v14 offset:5120
    ds_read_b128 a[184:187], v14 offset:6144
    v_mfma_f32_16x16x32_bf16 v[24:27], a[164:167], v[224:227], v[24:27]
    ds_read_b128 a[188:191], v14 offset:7168
    ds_read_b128 a[192:195], v14 offset:8192
    v_mfma_f32_16x16x32_bf16 v[24:27], a[168:171], v[232:235], v[24:27]
    ds_read_b128 a[196:199], v14 offset:9216
    v_fma_f32 v93, v93, s31, s31
    v_mfma_f32_16x16x32_bf16 v[24:27], a[172:175], v[240:243], v[24:27]
    v_exp_f32_e64 v94, -v78
    v_mfma_f32_16x16x32_bf16 v[24:27], a[176:179], v[248:251], v[24:27]
    v_fma_f32 v94, v94, s31, s31
    v_mul_f32 v67, v67, v59
    v_mfma_f32_16x16x32_bf16 v[28:31], a[160:163], v[220:223], v[28:31]
    v_exp_f32_e64 v95, -v79
    v_mfma_f32_16x16x32_bf16 v[28:31], a[164:167], v[228:231], v[28:31]
    v_fma_f32 v95, v95, s31, s31
    v_cvt_pk_bf16_f32 v17, v66, v67
    v_mfma_f32_16x16x32_bf16 v[28:31], a[168:171], v[236:239], v[28:31]
    v_rcp_f32 v88, v88
    v_mfma_f32_16x16x32_bf16 v[28:31], a[172:175], v[244:247], v[28:31]
    v_mul_f32 v72, v72, v88
    v_mul_f32 v68, v68, v60
    v_mfma_f32_16x16x32_bf16 v[28:31], a[176:179], v[252:255], v[28:31]
    s_waitcnt lgkmcnt(0)
    v_rcp_f32 v89, v89
    v_mfma_f32_16x16x32_bf16 v[32:35], a[180:183], v[96:99], 0
    ds_read_b128 a[160:163], v14 offset:15360
    ds_read_b128 a[164:167], v14 offset:16384
    v_mfma_f32_16x16x32_bf16 v[32:35], a[184:187], v[104:107], v[32:35]
    ds_read_b128 a[168:171], v14 offset:17408
    ds_read_b128 a[172:175], v14 offset:18432
    v_mfma_f32_16x16x32_bf16 v[32:35], a[188:191], v[112:115], v[32:35]
    ds_read_b128 a[176:179], v14 offset:19456
    v_mul_f32 v73, v73, v89
    v_mfma_f32_16x16x32_bf16 v[32:35], a[192:195], v[120:123], v[32:35]
    v_rcp_f32 v90, v90
    v_mfma_f32_16x16x32_bf16 v[32:35], a[196:199], v[128:131], v[32:35]
    v_mul_f32 v74, v74, v90
    v_mul_f32 v69, v69, v61
    v_mfma_f32_16x16x32_bf16 v[36:39], a[180:183], v[100:103], 0
    v_rcp_f32 v91, v91
    v_mfma_f32_16x16x32_bf16 v[36:39], a[184:187], v[108:111], v[36:39]
    v_mul_f32 v75, v75, v91
    v_cvt_pk_bf16_f32 v20, v68, v69
    v_mfma_f32_16x16x32_bf16 v[36:39], a[188:191], v[116:119], v[36:39]
    v_rcp_f32 v92, v92
    v_mfma_f32_16x16x32_bf16 v[36:39], a[192:195], v[124:127], v[36:39]
    v_mul_f32 v76, v76, v92
    v_mul_f32 v70, v70, v62
    v_mfma_f32_16x16x32_bf16 v[36:39], a[196:199], v[132:135], v[36:39]
    s_waitcnt lgkmcnt(0)
    v_rcp_f32 v93, v93
    v_mfma_f32_16x16x32_bf16 v[32:35], a[160:163], v[136:139], v[32:35]
    ds_read_b128 a[180:183], v14 offset:46080
    ds_read_b128 a[184:187], v14 offset:47104
    v_mfma_f32_16x16x32_bf16 v[32:35], a[164:167], v[144:147], v[32:35]
    ds_read_b128 a[188:191], v14 offset:48128
    ds_read_b128 a[192:195], v14 offset:49152
    v_mfma_f32_16x16x32_bf16 v[32:35], a[168:171], v[152:155], v[32:35]
    ds_read_b128 a[196:199], v14 offset:50176
    v_mul_f32 v77, v77, v93
    v_mfma_f32_16x16x32_bf16 v[32:35], a[172:175], v[160:163], v[32:35]
    v_rcp_f32 v94, v94
    v_mfma_f32_16x16x32_bf16 v[32:35], a[176:179], v[168:171], v[32:35]
    v_mul_f32 v78, v78, v94
    v_mul_f32 v71, v71, v63
    v_mfma_f32_16x16x32_bf16 v[36:39], a[160:163], v[140:143], v[36:39]
    v_cvt_pk_bf16_f32 v21, v70, v71
    v_mul_f32 v80, v80, v72
    v_mfma_f32_16x16x32_bf16 v[36:39], a[164:167], v[148:151], v[36:39]
    v_rcp_f32 v95, v95
    v_mfma_f32_16x16x32_bf16 v[36:39], a[168:171], v[156:159], v[36:39]
    v_mul_f32 v79, v79, v95
    v_mul_f32 v81, v81, v73
    v_mfma_f32_16x16x32_bf16 v[36:39], a[172:175], v[164:167], v[36:39]
    v_cvt_pk_bf16_f32 v18, v80, v81
    v_mul_f32 v82, v82, v74
    v_mfma_f32_16x16x32_bf16 v[36:39], a[176:179], v[172:175], v[36:39]
    s_waitcnt lgkmcnt(0)
    v_mul_f32 v83, v83, v75
    v_cvt_pk_bf16_f32 v19, v82, v83
    v_mfma_f32_16x16x32_bf16 v[32:35], a[180:183], v[176:179], v[32:35]
    s_mul_i32 s43, s16, 7680
    ds_read_b128 a[160:163], v14 offset:56320
    ds_read_b128 a[164:167], v14 offset:57344
    v_mfma_f32_16x16x32_bf16 v[32:35], a[184:187], v[184:187], v[32:35]
    s_mul_i32 s3, s20, 276480
    ds_read_b128 a[168:171], v14 offset:58368
    ds_read_b128 a[172:175], v14 offset:59392
    v_mfma_f32_16x16x32_bf16 v[32:35], a[188:191], v[192:195], v[32:35]
    s_add_u32 s3, s3, 0x45e000
    ds_read_b128 a[176:179], v14 offset:60416
    v_mul_f32 v84, v84, v76
    v_mfma_f32_16x16x32_bf16 v[32:35], a[192:195], v[200:203], v[32:35]
    buffer_store_dwordx4 v[16:19], v14, s[4:7], s27 offen offset:0 sc1
    v_mfma_f32_16x16x32_bf16 v[32:35], a[196:199], v[208:211], v[32:35]
    s_add_u32 m0, s43, 122880
    v_mul_f32 v85, v85, v77
    v_cvt_pk_bf16_f32 v22, v84, v85
    v_mfma_f32_16x16x32_bf16 v[36:39], a[180:183], v[180:183], v[36:39]
    v_mul_f32 v86, v86, v78
    v_mul_f32 v87, v87, v79
    v_mfma_f32_16x16x32_bf16 v[36:39], a[184:187], v[188:191], v[36:39]
    v_cvt_pk_bf16_f32 v23, v86, v87
    v_add_u32 v9, s3, v14
    v_mfma_f32_16x16x32_bf16 v[36:39], a[188:191], v[196:199], v[36:39]
    buffer_store_dwordx4 v[20:23], v14, s[4:7], s27 offen offset:1024 sc1
    v_mfma_f32_16x16x32_bf16 v[36:39], a[192:195], v[204:207], v[36:39]
    s_add_u32 s27, s27, 8192
    v_add_u32 v13, m0, v9
    v_mov_b32 v5, 0
    v_mfma_f32_16x16x32_bf16 v[36:39], a[196:199], v[212:215], v[36:39]
    s_waitcnt vmcnt(2) lgkmcnt(0)
    s_barrier
    buffer_load_dwordx4 v13, s[4:7], 0 offen offset:0 sc1 lds
    v_mfma_f32_16x16x32_bf16 v[32:35], a[160:163], v[216:219], v[32:35]
    buffer_atomic_add v5, v12, s[4:7], s47 offen sc0 sc1
    v_mfma_f32_16x16x32_bf16 v[32:35], a[164:167], v[224:227], v[32:35]
    buffer_load_dwordx4 v13, s[4:7], 0 offen offset:1024 sc1 lds
    ds_read_b128 a[180:183], v1 offset:16384
    ds_read_b128 a[184:187], v1 offset:17408
    v_mfma_f32_16x16x32_bf16 v[32:35], a[168:171], v[232:235], v[32:35]
    ds_read_b128 a[188:191], v1 offset:18432
    ds_read_b128 a[192:195], v1 offset:19456
    v_mfma_f32_16x16x32_bf16 v[32:35], a[172:175], v[240:243], v[32:35]
    buffer_load_dwordx4 v13, s[4:7], 0 offen offset:2048 sc1 lds
    ds_read_b128 a[196:199], v1 offset:20480
    v_mfma_f32_16x16x32_bf16 v[32:35], a[176:179], v[248:251], v[32:35]
    v_exp_f32_e64 v88, -v24
    v_mfma_f32_16x16x32_bf16 v[36:39], a[160:163], v[220:223], v[36:39]
    v_exp_f32_e64 v89, -v25
    v_mfma_f32_16x16x32_bf16 v[36:39], a[164:167], v[228:231], v[36:39]
    v_fma_f32 v88, v88, s31, s31
    v_fma_f32 v89, v89, s31, s31
    v_mfma_f32_16x16x32_bf16 v[36:39], a[168:171], v[236:239], v[36:39]
    v_exp_f32_e64 v90, -v26
    v_mfma_f32_16x16x32_bf16 v[36:39], a[172:175], v[244:247], v[36:39]
    buffer_load_dwordx4 v13, s[4:7], 0 offen offset:3072 sc1 lds
    v_fma_f32 v90, v90, s31, s31
    v_mfma_f32_16x16x32_bf16 v[36:39], a[176:179], v[252:255], v[36:39]
    s_waitcnt lgkmcnt(0)
    v_exp_f32_e64 v91, -v27
    v_mfma_f32_16x16x32_bf16 v[40:43], a[180:183], v[96:99], 0
    ds_read_b128 a[160:163], v1 offset:26624
    ds_read_b128 a[164:167], v1 offset:27648
    v_mfma_f32_16x16x32_bf16 v[40:43], a[184:187], v[104:107], v[40:43]
    ds_read_b128 a[168:171], v1 offset:28672
    ds_read_b128 a[172:175], v1 offset:29696
    v_mfma_f32_16x16x32_bf16 v[40:43], a[188:191], v[112:115], v[40:43]
    ds_read_b128 a[176:179], v1 offset:30720
    v_fma_f32 v91, v91, s31, s31
    v_mfma_f32_16x16x32_bf16 v[40:43], a[192:195], v[120:123], v[40:43]
    v_exp_f32_e64 v92, -v28
    v_mfma_f32_16x16x32_bf16 v[40:43], a[196:199], v[128:131], v[40:43]
    s_add_u32 m0, s43, 126976
    v_fma_f32 v92, v92, s31, s31
    v_add_u32 v13, m0, v9
    v_mfma_f32_16x16x32_bf16 v[44:47], a[180:183], v[100:103], 0
    v_exp_f32_e64 v93, -v29
    v_mfma_f32_16x16x32_bf16 v[44:47], a[184:187], v[108:111], v[44:47]
    buffer_load_dwordx4 v13, s[4:7], 0 offen offset:0 sc1 lds
    v_fma_f32 v93, v93, s31, s31
    v_mfma_f32_16x16x32_bf16 v[44:47], a[188:191], v[116:119], v[44:47]
    v_exp_f32_e64 v94, -v30
    v_mfma_f32_16x16x32_bf16 v[44:47], a[192:195], v[124:127], v[44:47]
    v_exp_f32_e64 v95, -v31
    v_mfma_f32_16x16x32_bf16 v[44:47], a[196:199], v[132:135], v[44:47]
    s_waitcnt lgkmcnt(0)
    v_fma_f32 v94, v94, s31, s31
    v_fma_f32 v95, v95, s31, s31
    v_mfma_f32_16x16x32_bf16 v[40:43], a[160:163], v[136:139], v[40:43]
    ds_read_b128 a[180:183], v14 offset:20480
    ds_read_b128 a[184:187], v14 offset:21504
    v_mfma_f32_16x16x32_bf16 v[40:43], a[164:167], v[144:147], v[40:43]
    buffer_load_dwordx4 v13, s[4:7], 0 offen offset:1024 sc1 lds
    ds_read_b128 a[188:191], v14 offset:22528
    v_mfma_f32_16x16x32_bf16 v[40:43], a[168:171], v[152:155], v[40:43]
    ds_read_b128 a[192:195], v14 offset:23552
    ds_read_b128 a[196:199], v14 offset:24576
    v_mfma_f32_16x16x32_bf16 v[40:43], a[172:175], v[160:163], v[40:43]
    v_rcp_f32 v88, v88
    v_mfma_f32_16x16x32_bf16 v[40:43], a[176:179], v[168:171], v[40:43]
    v_mul_f32 v24, v24, v88
    v_mul_f32 v32, v32, v24
    v_mfma_f32_16x16x32_bf16 v[44:47], a[160:163], v[140:143], v[44:47]
    v_rcp_f32 v89, v89
    v_mfma_f32_16x16x32_bf16 v[44:47], a[164:167], v[148:151], v[44:47]
    buffer_load_dwordx4 v13, s[4:7], 0 offen offset:2048 sc1 lds
    v_mul_f32 v25, v25, v89
    v_mfma_f32_16x16x32_bf16 v[44:47], a[168:171], v[156:159], v[44:47]
    v_rcp_f32 v90, v90
    v_mfma_f32_16x16x32_bf16 v[44:47], a[172:175], v[164:167], v[44:47]
    v_mul_f32 v26, v26, v90
    v_mul_f32 v33, v33, v25
    v_mfma_f32_16x16x32_bf16 v[44:47], a[176:179], v[172:175], v[44:47]
    s_waitcnt lgkmcnt(0)
    v_rcp_f32 v91, v91
    v_mfma_f32_16x16x32_bf16 v[40:43], a[180:183], v[176:179], v[40:43]
    ds_read_b128 a[160:163], v14 offset:30720
    ds_read_b128 a[164:167], v14 offset:31744
    v_mfma_f32_16x16x32_bf16 v[40:43], a[184:187], v[184:187], v[40:43]
    ds_read_b128 a[168:171], v14 offset:32768
    ds_read_b128 a[172:175], v14 offset:33792
    v_mfma_f32_16x16x32_bf16 v[40:43], a[188:191], v[192:195], v[40:43]
    buffer_load_dwordx4 v13, s[4:7], 0 offen offset:3072 sc1 lds
    ds_read_b128 a[176:179], v14 offset:34816
    v_mfma_f32_16x16x32_bf16 v[40:43], a[192:195], v[200:203], v[40:43]
    v_mul_f32 v27, v27, v91
    v_cvt_pk_bf16_f32 v16, v32, v33
    v_mfma_f32_16x16x32_bf16 v[40:43], a[196:199], v[208:211], v[40:43]
    v_rcp_f32 v92, v92
    v_mfma_f32_16x16x32_bf16 v[44:47], a[180:183], v[180:183], v[44:47]
    v_mul_f32 v28, v28, v92
    v_mul_f32 v34, v34, v26
    v_mfma_f32_16x16x32_bf16 v[44:47], a[184:187], v[188:191], v[44:47]
    v_rcp_f32 v93, v93
    v_mfma_f32_16x16x32_bf16 v[44:47], a[188:191], v[196:199], v[44:47]
    v_mul_f32 v29, v29, v93
    v_mul_f32 v35, v35, v27
    v_mfma_f32_16x16x32_bf16 v[44:47], a[192:195], v[204:207], v[44:47]
    v_rcp_f32 v94, v94
    v_mfma_f32_16x16x32_bf16 v[44:47], a[196:199], v[212:215], v[44:47]
    s_waitcnt lgkmcnt(0)
    v_mul_f32 v30, v30, v94
    v_cvt_pk_bf16_f32 v17, v34, v35
    v_mfma_f32_16x16x32_bf16 v[40:43], a[160:163], v[216:219], v[40:43]
    ds_read_b128 a[180:183], v1 offset:21504
    ds_read_b128 a[184:187], v1 offset:22528
    v_mfma_f32_16x16x32_bf16 v[40:43], a[164:167], v[224:227], v[40:43]
    ds_read_b128 a[188:191], v1 offset:23552
    ds_read_b128 a[192:195], v1 offset:24576
    v_mfma_f32_16x16x32_bf16 v[40:43], a[168:171], v[232:235], v[40:43]
    ds_read_b128 a[196:199], v1 offset:25600
    v_mul_f32 v36, v36, v28
    v_mfma_f32_16x16x32_bf16 v[40:43], a[172:175], v[240:243], v[40:43]
    v_rcp_f32 v95, v95
    v_mfma_f32_16x16x32_bf16 v[40:43], a[176:179], v[248:251], v[40:43]
    v_mul_f32 v31, v31, v95
    v_mul_f32 v37, v37, v29
    v_mfma_f32_16x16x32_bf16 v[44:47], a[160:163], v[220:223], v[44:47]
    v_cvt_pk_bf16_f32 v20, v36, v37
    v_mul_f32 v38, v38, v30
    v_mfma_f32_16x16x32_bf16 v[44:47], a[164:167], v[228:231], v[44:47]
    s_waitcnt vmcnt(7)
    v_readfirstlane_b32 s48, v5
    v_mov_b32 v6, 0x100
    v_mfma_f32_16x16x32_bf16 v[44:47], a[168:171], v[236:239], v[44:47]
    buffer_atomic_add v6, v12, s[4:7], s46 offen offset:0 sc1
    v_mfma_f32_16x16x32_bf16 v[44:47], a[172:175], v[244:247], v[44:47]
    s_bitcmp1_b32 s48, 3
    s_cbranch_scc0 h01_slow
h01_ok:
    v_mul_f32 v39, v39, v31
    v_mfma_f32_16x16x32_bf16 v[44:47], a[176:179], v[252:255], v[44:47]
    s_waitcnt lgkmcnt(0)
    v_cvt_pk_bf16_f32 v21, v38, v39
    v_add_u32 v7, s37, v14
    v_mfma_f32_16x16x32_bf16 v[48:51], a[180:183], v[96:99], 0
    s_add_u32 s37, s37, 4096
    ds_read_b128 a[160:163], v1 offset:31744
    buffer_load_dwordx4 v[72:75], v7, s[4:7], 0 offen offset:0 sc1
    v_mfma_f32_16x16x32_bf16 v[48:51], a[184:187], v[104:107], v[48:51]
    s_lshr_b32 s43, s16, 1
    ds_read_b128 a[164:167], v1 offset:32768
    ds_read_b128 a[168:171], v1 offset:33792
    v_mfma_f32_16x16x32_bf16 v[48:51], a[188:191], v[112:115], v[48:51]
    s_mul_i32 s43, s43, 20480
    ds_read_b128 a[172:175], v1 offset:34816
    buffer_load_dwordx4 v[76:79], v7, s[4:7], 0 offen offset:2048 sc1
    v_mfma_f32_16x16x32_bf16 v[48:51], a[192:195], v[120:123], v[48:51]
    s_mul_i32 s3, s16, 10240
    ds_read_b128 a[176:179], v1 offset:35840
    s_add_u32 s43, s43, s3
    v_mfma_f32_16x16x32_bf16 v[48:51], a[196:199], v[128:131], v[48:51]
    s_min_u32 s3, s39, s40
    s_sub_u32 s3, s3, s43
    v_add_u32 v9, s3, v14
    v_mfma_f32_16x16x32_bf16 v[52:55], a[180:183], v[100:103], 0
    s_sub_u32 s3, s39, s3
    v_add_u32 v7, s37, v14
    v_add_u32 v10, s3, v14
    v_mfma_f32_16x16x32_bf16 v[52:55], a[184:187], v[108:111], v[52:55]
    s_add_u32 s37, s37, 4096
    v_exp_f32_e64 v88, -v40
    v_mfma_f32_16x16x32_bf16 v[52:55], a[188:191], v[116:119], v[52:55]
    buffer_load_dwordx4 v[80:83], v7, s[4:7], 0 offen offset:0 sc1
    v_fma_f32 v88, v88, s31, s31
    v_mfma_f32_16x16x32_bf16 v[52:55], a[192:195], v[124:127], v[52:55]
    v_exp_f32_e64 v89, -v41
    v_mfma_f32_16x16x32_bf16 v[52:55], a[196:199], v[132:135], v[52:55]
    s_waitcnt lgkmcnt(0)
    buffer_load_dwordx4 v[84:87], v7, s[4:7], 0 offen offset:2048 sc1
    v_fma_f32 v89, v89, s31, s31
    v_mfma_f32_16x16x32_bf16 v[48:51], a[160:163], v[136:139], v[48:51]
    s_add_u32 s39, s39, 8192
    ds_read_b128 a[180:183], v14 offset:25600
    ds_read_b128 a[184:187], v14 offset:26624
    v_mfma_f32_16x16x32_bf16 v[48:51], a[164:167], v[144:147], v[48:51]
    s_add_u32 s40, s40, 8192
    ds_read_b128 a[188:191], v14 offset:27648
    ds_read_b128 a[192:195], v14 offset:28672
    v_mfma_f32_16x16x32_bf16 v[48:51], a[168:171], v[152:155], v[48:51]
    ds_read_b128 a[196:199], v14 offset:29696
    v_add_u32 v7, s38, v14
    v_mfma_f32_16x16x32_bf16 v[48:51], a[172:175], v[160:163], v[48:51]
    s_add_u32 s38, s38, 4096
    v_exp_f32_e64 v90, -v42
    v_mfma_f32_16x16x32_bf16 v[48:51], a[176:179], v[168:171], v[48:51]
    buffer_load_dwordx4 v[24:27], v7, s[4:7], 0 offen offset:0 sc1
    v_fma_f32 v90, v90, s31, s31
    v_mfma_f32_16x16x32_bf16 v[52:55], a[160:163], v[140:143], v[52:55]
    v_exp_f32_e64 v91, -v43
    v_mfma_f32_16x16x32_bf16 v[52:55], a[164:167], v[148:151], v[52:55]
    buffer_load_dwordx4 v[28:31], v7, s[4:7], 0 offen offset:2048 sc1
    v_fma_f32 v91, v91, s31, s31
    v_mfma_f32_16x16x32_bf16 v[52:55], a[168:171], v[156:159], v[52:55]
    s_branch .Lps6794
.Lpd6794:
    s_branch hop2_ret
.Lps6794:
    v_exp_f32_e64 v92, -v44
    v_mfma_f32_16x16x32_bf16 v[52:55], a[172:175], v[164:167], v[52:55]
    v_add_u32 v7, s38, v14
    v_fma_f32 v92, v92, s31, s31
    v_mfma_f32_16x16x32_bf16 v[52:55], a[176:179], v[172:175], v[52:55]
    s_waitcnt lgkmcnt(0)
    v_exp_f32_e64 v93, -v45
    v_mfma_f32_16x16x32_bf16 v[48:51], a[180:183], v[176:179], v[48:51]
    s_add_u32 s38, s38, 4096
    ds_read_b128 a[160:163], v14 offset:35840
    buffer_load_dwordx4 v[32:35], v7, s[4:7], 0 offen offset:0 sc1
    v_mfma_f32_16x16x32_bf16 v[48:51], a[184:187], v[184:187], v[48:51]
    ds_read_b128 a[164:167], v14 offset:36864
    ds_read_b128 a[168:171], v14 offset:37888
    v_mfma_f32_16x16x32_bf16 v[48:51], a[188:191], v[192:195], v[48:51]
    ds_read_b128 a[172:175], v14 offset:38912
    buffer_load_dwordx4 v[36:39], v7, s[4:7], 0 offen offset:2048 sc1
    v_mfma_f32_16x16x32_bf16 v[48:51], a[192:195], v[200:203], v[48:51]
    ds_read_b128 a[176:179], v14 offset:39936
    v_fma_f32 v93, v93, s31, s31
    v_mfma_f32_16x16x32_bf16 v[48:51], a[196:199], v[208:211], v[48:51]
    v_exp_f32_e64 v94, -v46
    v_mfma_f32_16x16x32_bf16 v[52:55], a[180:183], v[180:183], v[52:55]
    s_add_u32 m0, s43, 0
    v_add_u32 v13, m0, v9
    v_fma_f32 v94, v94, s31, s31
    v_mfma_f32_16x16x32_bf16 v[52:55], a[184:187], v[188:191], v[52:55]
    v_exp_f32_e64 v95, -v47
    v_mfma_f32_16x16x32_bf16 v[52:55], a[188:191], v[196:199], v[52:55]
    buffer_load_dwordx4 v13, s[4:7], 0 offen offset:0 sc1 lds
    v_fma_f32 v95, v95, s31, s31
    v_mfma_f32_16x16x32_bf16 v[52:55], a[192:195], v[204:207], v[52:55]
    v_rcp_f32 v88, v88
    v_mfma_f32_16x16x32_bf16 v[52:55], a[196:199], v[212:215], v[52:55]
    s_waitcnt vmcnt(10) lgkmcnt(0)
    s_barrier
    buffer_load_dwordx4 v13, s[4:7], 0 offen offset:1024 sc1 lds
    v_mfma_f32_16x16x32_bf16 v[48:51], a[160:163], v[216:219], v[48:51]
    ds_read_b128 a[180:183], v14 offset:61440
    ds_read_b128 a[184:187], v14 offset:62464
    v_mfma_f32_16x16x32_bf16 v[48:51], a[164:167], v[224:227], v[48:51]
    ds_read_b128 a[188:191], v14 offset:63488
    ds_read_b128 a[192:195], v14 offset:64512
    v_mfma_f32_16x16x32_bf16 v[48:51], a[168:171], v[232:235], v[48:51]
    ds_read_b128 a[196:199], v1 offset:0
    v_mov_b32 v5, 0
    v_mfma_f32_16x16x32_bf16 v[48:51], a[172:175], v[240:243], v[48:51]
    buffer_atomic_add v5, v12, s[4:7], s47 offen sc0 sc1
    v_mfma_f32_16x16x32_bf16 v[48:51], a[176:179], v[248:251], v[48:51]
    buffer_load_dwordx4 v13, s[4:7], 0 offen offset:2048 sc1 lds
    v_mul_f32 v40, v40, v88
    v_mfma_f32_16x16x32_bf16 v[52:55], a[160:163], v[220:223], v[52:55]
    v_rcp_f32 v89, v89
    v_mfma_f32_16x16x32_bf16 v[52:55], a[164:167], v[228:231], v[52:55]
    buffer_load_dwordx4 v13, s[4:7], 0 offen offset:3072 sc1 lds
    v_mul_f32 v41, v41, v89
    v_mfma_f32_16x16x32_bf16 v[52:55], a[168:171], v[236:239], v[52:55]
    v_rcp_f32 v90, v90
    v_mfma_f32_16x16x32_bf16 v[52:55], a[172:175], v[244:247], v[52:55]
    s_add_u32 m0, s43, 4096
    v_mul_f32 v42, v42, v90
    v_add_u32 v13, m0, v9
    v_mfma_f32_16x16x32_bf16 v[52:55], a[176:179], v[252:255], v[52:55]
    s_waitcnt lgkmcnt(0)
    v_rcp_f32 v91, v91
    v_mfma_f32_16x16x32_bf16 v[56:59], a[180:183], v[96:99], 0
    buffer_load_dwordx4 v13, s[4:7], 0 offen offset:0 sc1 lds
    ds_read_b128 a[160:163], v1 offset:6144
    v_mfma_f32_16x16x32_bf16 v[56:59], a[184:187], v[104:107], v[56:59]
    ds_read_b128 a[164:167], v1 offset:7168
    ds_read_b128 a[168:171], v1 offset:8192
    v_mfma_f32_16x16x32_bf16 v[56:59], a[188:191], v[112:115], v[56:59]
    ds_read_b128 a[172:175], v1 offset:9216
    buffer_load_dwordx4 v13, s[4:7], 0 offen offset:1024 sc1 lds
    v_mfma_f32_16x16x32_bf16 v[56:59], a[192:195], v[120:123], v[56:59]
    ds_read_b128 a[176:179], v1 offset:10240
    v_mul_f32 v43, v43, v91
    v_mfma_f32_16x16x32_bf16 v[56:59], a[196:199], v[128:131], v[56:59]
    v_rcp_f32 v92, v92
    v_mfma_f32_16x16x32_bf16 v[60:63], a[180:183], v[100:103], 0
    buffer_load_dwordx4 v13, s[4:7], 0 offen offset:2048 sc1 lds
    v_mul_f32 v44, v44, v92
    v_mfma_f32_16x16x32_bf16 v[60:63], a[184:187], v[108:111], v[60:63]
    v_rcp_f32 v93, v93
    v_mfma_f32_16x16x32_bf16 v[60:63], a[188:191], v[116:119], v[60:63]
    v_mul_f32 v45, v45, v93
    v_mul_f32 v48, v48, v40
    v_mfma_f32_16x16x32_bf16 v[60:63], a[192:195], v[124:127], v[60:63]
    buffer_load_dwordx4 v13, s[4:7], 0 offen offset:3072 sc1 lds
    v_mul_f32 v49, v49, v41
    v_mfma_f32_16x16x32_bf16 v[60:63], a[196:199], v[132:135], v[60:63]
    s_waitcnt lgkmcnt(0)
    v_rcp_f32 v94, v94
    v_mfma_f32_16x16x32_bf16 v[56:59], a[160:163], v[136:139], v[56:59]
    ds_read_b128 a[180:183], v1 offset:36864
    ds_read_b128 a[184:187], v1 offset:37888
    v_mfma_f32_16x16x32_bf16 v[56:59], a[164:167], v[144:147], v[56:59]
    ds_read_b128 a[188:191], v1 offset:38912
    ds_read_b128 a[192:195], v1 offset:39936
    v_mfma_f32_16x16x32_bf16 v[56:59], a[168:171], v[152:155], v[56:59]
    ds_read_b128 a[196:199], v1 offset:40960
    v_mul_f32 v46, v46, v94
    v_mfma_f32_16x16x32_bf16 v[56:59], a[172:175], v[160:163], v[56:59]
    v_rcp_f32 v95, v95
    v_mfma_f32_16x16x32_bf16 v[56:59], a[176:179], v[168:171], v[56:59]
    v_mul_f32 v47, v47, v95
    v_cvt_pk_bf16_f32 v18, v48, v49
    v_mfma_f32_16x16x32_bf16 v[60:63], a[160:163], v[140:143], v[60:63]
    v_mul_f32 v50, v50, v42
    v_mul_f32 v51, v51, v43
    v_mfma_f32_16x16x32_bf16 v[60:63], a[164:167], v[148:151], v[60:63]
    v_cvt_pk_bf16_f32 v19, v50, v51
    v_mul_f32 v52, v52, v44
    v_mfma_f32_16x16x32_bf16 v[60:63], a[168:171], v[156:159], v[60:63]
    buffer_store_dwordx4 v[16:19], v14, s[4:7], s27 offen offset:0 sc1
    v_mfma_f32_16x16x32_bf16 v[60:63], a[172:175], v[164:167], v[60:63]
    v_mul_f32 v53, v53, v45
    v_cvt_pk_bf16_f32 v22, v52, v53
    v_mfma_f32_16x16x32_bf16 v[60:63], a[176:179], v[172:175], v[60:63]
    s_waitcnt lgkmcnt(0)
    v_mul_f32 v54, v54, v46
    v_mul_f32 v55, v55, v47
    v_mfma_f32_16x16x32_bf16 v[56:59], a[180:183], v[176:179], v[56:59]
    ds_read_b128 a[160:163], v1 offset:47104
    ds_read_b128 a[164:167], v1 offset:48128
    v_mfma_f32_16x16x32_bf16 v[56:59], a[184:187], v[184:187], v[56:59]
    ds_read_b128 a[168:171], v1 offset:49152
    ds_read_b128 a[172:175], v1 offset:50176
    v_cvt_pk_bf16_f32 v23, v54, v55
    v_mfma_f32_16x16x32_bf16 v[56:59], a[188:191], v[192:195], v[56:59]
    buffer_store_dwordx4 v[20:23], v14, s[4:7], s27 offen offset:1024 sc1
    v_mfma_f32_16x16x32_bf16 v[56:59], a[192:195], v[200:203], v[56:59]
    s_add_u32 s27, s27, 8192
    ds_read_b128 a[176:179], v1 offset:51200
    v_add_u32 v8, s30, v4
    v_mfma_f32_16x16x32_bf16 v[56:59], a[196:199], v[208:211], v[56:59]
    v_mfma_f32_16x16x32_bf16 v[60:63], a[180:183], v[180:183], v[60:63]
    v_mfma_f32_16x16x32_bf16 v[60:63], a[184:187], v[188:191], v[60:63]
    v_mfma_f32_16x16x32_bf16 v[60:63], a[188:191], v[196:199], v[60:63]
    v_mfma_f32_16x16x32_bf16 v[60:63], a[192:195], v[204:207], v[60:63]
    v_mfma_f32_16x16x32_bf16 v[60:63], a[196:199], v[212:215], v[60:63]
    s_waitcnt lgkmcnt(0)
    v_mfma_f32_16x16x32_bf16 v[56:59], a[160:163], v[216:219], v[56:59]
    ds_read_b128 a[180:183], v1 offset:1024
    ds_read_b128 a[184:187], v1 offset:2048
    v_mfma_f32_16x16x32_bf16 v[56:59], a[164:167], v[224:227], v[56:59]
    ds_read_b128 a[188:191], v1 offset:3072
    ds_read_b128 a[192:195], v1 offset:4096
    v_mfma_f32_16x16x32_bf16 v[56:59], a[168:171], v[232:235], v[56:59]
    ds_read_b128 a[196:199], v1 offset:5120
    v_mfma_f32_16x16x32_bf16 v[56:59], a[172:175], v[240:243], v[56:59]
    v_mfma_f32_16x16x32_bf16 v[56:59], a[176:179], v[248:251], v[56:59]
    v_mfma_f32_16x16x32_bf16 v[60:63], a[160:163], v[220:223], v[60:63]
    v_mfma_f32_16x16x32_bf16 v[60:63], a[164:167], v[228:231], v[60:63]
    v_mfma_f32_16x16x32_bf16 v[60:63], a[168:171], v[236:239], v[60:63]
    v_mfma_f32_16x16x32_bf16 v[60:63], a[172:175], v[244:247], v[60:63]
    v_mfma_f32_16x16x32_bf16 v[60:63], a[176:179], v[252:255], v[60:63]
    s_waitcnt lgkmcnt(0)
    v_mfma_f32_16x16x32_bf16 v[64:67], a[180:183], v[96:99], 0
    ds_read_b128 a[160:163], v1 offset:11264
    ds_read_b128 a[164:167], v1 offset:12288
    v_mfma_f32_16x16x32_bf16 v[64:67], a[184:187], v[104:107], v[64:67]
    ds_read_b128 a[168:171], v1 offset:13312
    ds_read_b128 a[172:175], v1 offset:14336
    v_mfma_f32_16x16x32_bf16 v[64:67], a[188:191], v[112:115], v[64:67]
    s_waitcnt vmcnt(8)
    v_readfirstlane_b32 s48, v5
    v_mfma_f32_16x16x32_bf16 v[64:67], a[192:195], v[120:123], v[64:67]
    ds_read_b128 a[176:179], v1 offset:15360
    v_mfma_f32_16x16x32_bf16 v[64:67], a[196:199], v[128:131], v[64:67]
    s_bitcmp1_b32 s48, 11
    s_cbranch_scc0 h11_slow
h11_ok:
    v_mfma_f32_16x16x32_bf16 v[68:71], a[180:183], v[100:103], 0
    v_add_u32 v7, s37, v14
    s_add_u32 s37, s37, 4096
    v_mfma_f32_16x16x32_bf16 v[68:71], a[184:187], v[108:111], v[68:71]
    v_exp_f32_e64 v88, -v56
    v_mfma_f32_16x16x32_bf16 v[68:71], a[188:191], v[116:119], v[68:71]
    buffer_load_dwordx4 v[40:43], v7, s[4:7], 0 offen offset:0 sc1
    v_fma_f32 v88, v88, s31, s31
    v_mfma_f32_16x16x32_bf16 v[68:71], a[192:195], v[124:127], v[68:71]
    v_exp_f32_e64 v89, -v57
    v_mfma_f32_16x16x32_bf16 v[68:71], a[196:199], v[132:135], v[68:71]
    s_waitcnt lgkmcnt(0)
    v_exp_f32_e64 v90, -v58
    v_mfma_f32_16x16x32_bf16 v[64:67], a[160:163], v[136:139], v[64:67]
    ds_read_b128 a[180:183], v1 offset:41984
    ds_read_b128 a[184:187], v1 offset:43008
    v_mfma_f32_16x16x32_bf16 v[64:67], a[164:167], v[144:147], v[64:67]
    buffer_load_dwordx4 v[44:47], v7, s[4:7], 0 offen offset:2048 sc1
    ds_read_b128 a[188:191], v1 offset:44032
    v_mfma_f32_16x16x32_bf16 v[64:67], a[168:171], v[152:155], v[64:67]
    ds_read_b128 a[192:195], v1 offset:45056
    ds_read_b128 a[196:199], v1 offset:46080
    v_mfma_f32_16x16x32_bf16 v[64:67], a[172:175], v[160:163], v[64:67]
    v_exp_f32_e64 v91, -v59
    v_mfma_f32_16x16x32_bf16 v[64:67], a[176:179], v[168:171], v[64:67]
    v_exp_f32_e64 v92, -v60
    v_mfma_f32_16x16x32_bf16 v[68:71], a[160:163], v[140:143], v[68:71]
    v_add_u32 v7, s37, v14
    v_fma_f32 v89, v89, s31, s31
    v_mfma_f32_16x16x32_bf16 v[68:71], a[164:167], v[148:151], v[68:71]
    s_add_u32 s37, s37, 4096
    v_exp_f32_e64 v93, -v61
    v_mfma_f32_16x16x32_bf16 v[68:71], a[168:171], v[156:159], v[68:71]
    buffer_load_dwordx4 v[48:51], v7, s[4:7], 0 offen offset:0 sc1
    v_fma_f32 v90, v90, s31, s31
    v_mfma_f32_16x16x32_bf16 v[68:71], a[172:175], v[164:167], v[68:71]
    v_exp_f32_e64 v94, -v62
    v_mfma_f32_16x16x32_bf16 v[68:71], a[176:179], v[172:175], v[68:71]
    s_waitcnt lgkmcnt(0)
    v_fma_f32 v91, v91, s31, s31
    v_fma_f32 v92, v92, s31, s31
    v_mfma_f32_16x16x32_bf16 v[64:67], a[180:183], v[176:179], v[64:67]
    ds_read_b128 a[160:163], v1 offset:52224
    ds_read_b128 a[164:167], v1 offset:53248
    v_mfma_f32_16x16x32_bf16 v[64:67], a[184:187], v[184:187], v[64:67]
    ds_read_b128 a[168:171], v1 offset:54272
    buffer_load_dwordx4 v[52:55], v7, s[4:7], 0 offen offset:2048 sc1
    v_mfma_f32_16x16x32_bf16 v[64:67], a[188:191], v[192:195], v[64:67]
    ds_read_b128 a[172:175], v1 offset:55296
    ds_read_b128 a[176:179], v1 offset:56320
    v_mfma_f32_16x16x32_bf16 v[64:67], a[192:195], v[200:203], v[64:67]
    v_fma_f32 v93, v93, s31, s31
    v_fma_f32 v94, v94, s31, s31
    v_mfma_f32_16x16x32_bf16 v[64:67], a[196:199], v[208:211], v[64:67]
    v_exp_f32_e64 v95, -v63
    v_mfma_f32_16x16x32_bf16 v[68:71], a[180:183], v[180:183], v[68:71]
    v_rcp_f32 v88, v88
    v_mfma_f32_16x16x32_bf16 v[68:71], a[184:187], v[188:191], v[68:71]
    v_add_u32 v7, s38, v14
    v_fma_f32 v95, v95, s31, s31
    v_mfma_f32_16x16x32_bf16 v[68:71], a[188:191], v[196:199], v[68:71]
    s_add_u32 s38, s38, 4096
    v_rcp_f32 v89, v89
    v_mfma_f32_16x16x32_bf16 v[68:71], a[192:195], v[204:207], v[68:71]
    buffer_load_dwordx4 v[96:99], v7, s[4:7], 0 offen offset:0 sc1
    v_mul_f32 v56, v56, v88
    v_mfma_f32_16x16x32_bf16 v[68:71], a[196:199], v[212:215], v[68:71]
    s_waitcnt lgkmcnt(0)
    v_rcp_f32 v90, v90
    v_mfma_f32_16x16x32_bf16 v[64:67], a[160:163], v[216:219], v[64:67]
    v_rcp_f32 v91, v91
    v_mfma_f32_16x16x32_bf16 v[64:67], a[164:167], v[224:227], v[64:67]
    v_rcp_f32 v92, v92
    v_mfma_f32_16x16x32_bf16 v[64:67], a[168:171], v[232:235], v[64:67]
    buffer_load_dwordx4 v[100:103], v7, s[4:7], 0 offen offset:2048 sc1
    v_mul_f32 v57, v57, v89
    v_mfma_f32_16x16x32_bf16 v[64:67], a[172:175], v[240:243], v[64:67]
    v_rcp_f32 v93, v93
    v_mfma_f32_16x16x32_bf16 v[64:67], a[176:179], v[248:251], v[64:67]
    v_mul_f32 v58, v58, v90
    v_mul_f32 v59, v59, v91
    v_mfma_f32_16x16x32_bf16 v[68:71], a[160:163], v[220:223], v[68:71]
    v_rcp_f32 v94, v94
    v_mfma_f32_16x16x32_bf16 v[68:71], a[164:167], v[228:231], v[68:71]
    v_mov_b32 v6, 0x10000
    v_mul_f32 v60, v60, v92
    v_mfma_f32_16x16x32_bf16 v[68:71], a[168:171], v[236:239], v[68:71]
    s_waitcnt vmcnt(6)
    buffer_atomic_add v6, v12, s[4:7], s46 offen offset:0 sc1
    v_mfma_f32_16x16x32_bf16 v[68:71], a[172:175], v[244:247], v[68:71]
    v_add_u32 v7, s38, v14
    v_mul_f32 v61, v61, v93
    v_mfma_f32_16x16x32_bf16 v[68:71], a[176:179], v[252:255], v[68:71]
    buffer_load_dwordx4 v[104:107], v7, s[4:7], 0 offen offset:0 sc1
    v_mul_f32 v62, v62, v94
    v_mfma_f32_16x16x32_bf16 v[176:179], a[0:3], v[72:75], 0
    s_add_u32 s38, s38, 4096
    v_rcp_f32 v95, v95
    v_mfma_f32_16x16x32_bf16 v[176:179], a[20:23], v[76:79], v[176:179]
    v_mul_f32 v63, v63, v95
    v_mfma_f32_16x16x32_bf16 v[176:179], a[40:43], v[80:83], v[176:179]
    v_mfma_f32_16x16x32_bf16 v[176:179], a[60:63], v[84:87], v[176:179]
    buffer_load_dwordx4 v[108:111], v7, s[4:7], 0 offen offset:2048 sc1
    v_mfma_f32_16x16x32_bf16 v[180:183], a[4:7], v[72:75], 0
    v_mfma_f32_16x16x32_bf16 v[180:183], a[24:27], v[76:79], v[180:183]
    v_mfma_f32_16x16x32_bf16 v[180:183], a[44:47], v[80:83], v[180:183]
    v_mul_f32 v64, v64, v56
    v_mul_f32 v65, v65, v57
    v_mfma_f32_16x16x32_bf16 v[180:183], a[64:67], v[84:87], v[180:183]
    v_cvt_pk_bf16_f32 v16, v64, v65
    v_mul_f32 v66, v66, v58
    v_mfma_f32_16x16x32_bf16 v[184:187], a[8:11], v[72:75], 0
    v_add_u32 v7, s39, v14
    v_mul_f32 v67, v67, v59
    v_mfma_f32_16x16x32_bf16 v[184:187], a[28:31], v[76:79], v[184:187]
    s_add_u32 s39, s39, 4096
    v_cvt_pk_bf16_f32 v17, v66, v67
    v_mul_f32 v68, v68, v60
    v_mfma_f32_16x16x32_bf16 v[184:187], a[48:51], v[80:83], v[184:187]
    buffer_load_dwordx4 v[112:115], v7, s[4:7], 0 offen offset:0 sc1
    v_mul_f32 v69, v69, v61
    v_mfma_f32_16x16x32_bf16 v[184:187], a[68:71], v[84:87], v[184:187]
    v_cvt_pk_bf16_f32 v20, v68, v69
    v_mul_f32 v70, v70, v62
    v_mfma_f32_16x16x32_bf16 v[188:191], a[12:15], v[72:75], 0
    v_mul_f32 v71, v71, v63
    v_cvt_pk_bf16_f32 v21, v70, v71
    v_mfma_f32_16x16x32_bf16 v[188:191], a[32:35], v[76:79], v[188:191]
    buffer_store_dwordx2 v[16:17], v8, s[4:7], s28 offen offset:0 sc1
    v_mfma_f32_16x16x32_bf16 v[188:191], a[52:55], v[80:83], v[188:191]
    buffer_store_dwordx2 v[20:21], v8, s[4:7], s28 offen offset:512 sc1
    v_mfma_f32_16x16x32_bf16 v[188:191], a[72:75], v[84:87], v[188:191]
    buffer_load_dwordx4 v[116:119], v7, s[4:7], 0 offen offset:2048 sc1
    v_mfma_f32_16x16x32_bf16 v[192:195], a[16:19], v[72:75], 0
    ds_read_b128 v[144:147], v10 offset:0
    ds_read_b128 v[148:151], v10 offset:2048
    v_mfma_f32_16x16x32_bf16 v[192:195], a[36:39], v[76:79], v[192:195]
    ds_read_b128 v[152:155], v10 offset:4096
    ds_read_b128 v[156:159], v10 offset:6144
    v_mfma_f32_16x16x32_bf16 v[192:195], a[56:59], v[80:83], v[192:195]
    v_xor_b32 v10, 0x400, v10
    v_mfma_f32_16x16x32_bf16 v[192:195], a[76:79], v[84:87], v[192:195]
    ds_read_b128 v[160:163], v10 offset:0
    ds_read_b128 v[164:167], v10 offset:2048
    v_mfma_f32_16x16x32_bf16 v[196:199], a[0:3], v[24:27], 0
    ds_read_b128 v[168:171], v10 offset:4096
    ds_read_b128 v[172:175], v10 offset:6144
    v_mfma_f32_16x16x32_bf16 v[196:199], a[20:23], v[28:31], v[196:199]
    s_lshl_b32 s33, s17, 1
    v_add_u32 v7, s39, v14
    v_and_b32 v88, 15, v0
    v_mfma_f32_16x16x32_bf16 v[196:199], a[40:43], v[32:35], v[196:199]
    s_add_u32 s39, s39, 4096
    v_lshlrev_b32 v16, 3, v88
    v_lshrrev_b32 v89, 5, v0
    v_mfma_f32_16x16x32_bf16 v[196:199], a[60:63], v[36:39], v[196:199]
    buffer_load_dwordx4 v[120:123], v7, s[4:7], 0 offen offset:0 sc1
    v_mul_u32_u24 v89, 2560, v89
    v_mfma_f32_16x16x32_bf16 v[200:203], a[4:7], v[24:27], 0
    buffer_load_dwordx4 v[124:127], v7, s[4:7], 0 offen offset:2048 sc1
    v_lshl_add_u32 v88, v88, 4, v89
    v_mfma_f32_16x16x32_bf16 v[200:203], a[24:27], v[28:31], v[200:203]
    s_add_u32 s33, s33, s19
    v_bfe_u32 v89, v0, 4, 1
    v_lshl_add_u32 v9, v89, 3, v88
    v_mfma_f32_16x16x32_bf16 v[200:203], a[44:47], v[32:35], v[200:203]
    s_lshl_b32 s33, s33, 2
    v_mul_u32_u24 v89, 1536, v89
    v_add_u32 v8, v88, v89
    v_mfma_f32_16x16x32_bf16 v[200:203], a[64:67], v[36:39], v[200:203]
    s_add_u32 s33, s33, s16
    s_lshl_b32 s34, s33, 7
    s_add_u32 s34, s34, 0x2380000
    v_mfma_f32_16x16x32_bf16 v[204:207], a[8:11], v[24:27], 0
    s_lshr_b32 s33, s33, 1
    s_mul_i32 s24, s33, 40960
    s_mul_i32 s32, s33, 110592
    v_mfma_f32_16x16x32_bf16 v[204:207], a[28:31], v[28:31], v[204:207]
    s_lshl_b32 s33, s33, 9
    s_add_u32 s33, s33, 0x2d80004
    s_and_b32 s27, s16, 1
    v_mfma_f32_16x16x32_bf16 v[204:207], a[48:51], v[32:35], v[204:207]
    s_lshl_b32 s27, s27, 8
    v_add_u32 v7, s40, v14
    s_add_u32 s40, s40, 4096
    v_mfma_f32_16x16x32_bf16 v[204:207], a[68:71], v[36:39], v[204:207]
    buffer_load_dwordx4 v[128:131], v7, s[4:7], 0 offen offset:0 sc1
    s_add_u32 s24, s24, s27
    v_mfma_f32_16x16x32_bf16 v[208:211], a[12:15], v[24:27], 0
    s_add_u32 s32, s32, s27
    s_add_u32 s32, s32, s27
    s_add_u32 s32, s32, 0x2618000
    v_mfma_f32_16x16x32_bf16 v[208:211], a[32:35], v[28:31], v[208:211]
    s_mul_i32 s27, s20, 5120
    v_add_u32 v17, s32, v4
    s_add_u32 s24, s24, s27
    v_mfma_f32_16x16x32_bf16 v[208:211], a[52:55], v[32:35], v[208:211]
    s_add_u32 s24, s24, 0x2100000
    s_xor_b32 s27, s16, 0
    v_mfma_f32_16x16x32_bf16 v[208:211], a[72:75], v[36:39], v[208:211]
    buffer_load_dwordx4 v[132:135], v7, s[4:7], 0 offen offset:2048 sc1
    v_mfma_f32_16x16x32_bf16 v[212:215], a[16:19], v[24:27], 0
    v_mfma_f32_16x16x32_bf16 v[212:215], a[36:39], v[28:31], v[212:215]
    v_mfma_f32_16x16x32_bf16 v[212:215], a[56:59], v[32:35], v[212:215]
    s_waitcnt lgkmcnt(0)
    v_mfma_f32_16x16x32_bf16 v[212:215], a[76:79], v[36:39], v[212:215]
    v_mfma_f32_16x16x32_bf16 v[216:219], a[0:3], v[144:147], 0
    s_and_b32 s42, s27, 2
    v_and_b32 v88, 15, v0
    v_mul_u32_u24 v18, 176, v88
    v_mfma_f32_16x16x32_bf16 v[216:219], a[20:23], v[148:151], v[216:219]
    s_add_u32 s27, s27, s42
    v_add_u32 v7, s40, v14
    v_lshrrev_b32 v88, 4, v0
    v_mfma_f32_16x16x32_bf16 v[216:219], a[40:43], v[152:155], v[216:219]
    s_add_u32 s40, s40, 4096
    v_mad_u32_u24 v18, v88, 40, v18
    v_add_u32 v88, 0, v0
    v_mfma_f32_16x16x32_bf16 v[216:219], a[60:63], v[156:159], v[216:219]
    buffer_load_dwordx4 v[136:139], v7, s[4:7], 0 offen offset:0 sc1
    v_mul_u32_u24 v89, 205, v88
    v_mfma_f32_16x16x32_bf16 v[220:223], a[4:7], v[144:147], 0
    s_mul_i32 s27, s27, 10240
    v_add_u32 v3, s27, v14
    v_lshrrev_b32 v89, 11, v89
    v_mfma_f32_16x16x32_bf16 v[220:223], a[24:27], v[148:151], v[220:223]
    s_xor_b32 s27, s16, 3
    v_add_u32 v90, v88, v89
    v_mul_u32_u24 v89, 81760, v89
    v_mfma_f32_16x16x32_bf16 v[220:223], a[44:47], v[152:155], v[220:223]
    buffer_load_dwordx4 v[140:143], v7, s[4:7], 0 offen offset:2048 sc1
    v_lshl_add_u32 v91, v88, 4, v89
    v_mfma_f32_16x16x32_bf16 v[220:223], a[64:67], v[156:159], v[220:223]
    s_and_b32 s42, s27, 2
    v_add_u32 v88, 64, v0
    v_mul_u32_u24 v89, 205, v88
    v_mfma_f32_16x16x32_bf16 v[224:227], a[8:11], v[144:147], 0
    s_add_u32 s27, s27, s42
    v_lshrrev_b32 v89, 11, v89
    s_mul_i32 s27, s27, 10240
    v_mfma_f32_16x16x32_bf16 v[224:227], a[28:31], v[148:151], v[224:227]
    s_lshl_b32 s32, s19, 4
    v_add_u32 v11, s27, v14
    s_xor_b32 s27, s16, 2
    v_mfma_f32_16x16x32_bf16 v[224:227], a[48:51], v[152:155], v[224:227]
    s_and_b32 s42, s27, 2
    s_add_u32 s27, s27, s42
    s_mul_i32 s27, s27, 10240
    v_mfma_f32_16x16x32_bf16 v[224:227], a[68:71], v[156:159], v[224:227]
    s_add_u32 s32, s32, s17
    v_add_u32 v22, s27, v14
    s_xor_b32 s27, s16, 0
    v_mfma_f32_16x16x32_bf16 v[228:231], a[12:15], v[144:147], 0
    s_mul_i32 s27, s27, 5120
    v_add_u32 v15, 53248, v15
    v_add_u32 v10, s27, v14
    v_mfma_f32_16x16x32_bf16 v[228:231], a[32:35], v[148:151], v[228:231]
    buffer_load_dwordx4 a[160:163], v15, s[4:7], 0 offen offset:2048 sc1
    s_xor_b32 s27, s16, 1
    v_mfma_f32_16x16x32_bf16 v[228:231], a[52:55], v[152:155], v[228:231]
    s_load_dword s48, s[52:53], s47 glc
    s_mul_i32 s27, s27, 5120
    v_add_u32 v23, s27, v14
    v_mfma_f32_16x16x32_bf16 v[228:231], a[72:75], v[156:159], v[228:231]
    s_lshr_b32 s27, s16, 1
    s_lshl_b32 s27, s27, 5
    s_add_u32 s32, s32, s27
    v_mfma_f32_16x16x32_bf16 v[232:235], a[16:19], v[144:147], 0
    buffer_load_dwordx4 a[164:167], v15, s[4:7], 0 offen offset:3072 sc1
    s_and_b32 s27, s16, 1
    v_mfma_f32_16x16x32_bf16 v[232:235], a[36:39], v[148:151], v[232:235]
    s_lshl_b32 s27, s27, 10
    s_add_u32 s32, s32, s27
    s_mul_i32 s32, s32, 1280
    v_mfma_f32_16x16x32_bf16 v[232:235], a[56:59], v[152:155], v[232:235]
    s_mul_i32 s27, s20, 160
    s_add_u32 s32, s32, s27
    s_mul_i32 s27, s16, 2816
    v_mfma_f32_16x16x32_bf16 v[232:235], a[76:79], v[156:159], v[232:235]
    s_add_u32 s27, s27, 61440
    v_add_u32 v18, s27, v18
    v_lshl_add_u32 v19, v90, 4, s27
    v_mfma_f32_16x16x32_bf16 v[236:239], a[0:3], v[160:163], 0
    v_add_u32 v15, 4096, v15
    v_add_u32 v90, v88, v89
    v_mfma_f32_16x16x32_bf16 v[236:239], a[20:23], v[164:167], v[236:239]
    buffer_load_dwordx4 a[168:171], v15, s[4:7], 0 offen offset:0 sc1
    v_lshl_add_u32 v20, v90, 4, s27
    v_mfma_f32_16x16x32_bf16 v[236:239], a[40:43], v[168:171], v[236:239]
    v_mul_u32_u24 v89, 81760, v89
    v_lshl_add_u32 v92, v88, 4, v89
    v_mfma_f32_16x16x32_bf16 v[236:239], a[60:63], v[172:175], v[236:239]
    v_add_u32 v88, 128, v0
    v_mul_u32_u24 v89, 205, v88
    v_mfma_f32_16x16x32_bf16 v[240:243], a[4:7], v[160:163], 0
    v_lshrrev_b32 v89, 11, v89
    v_add_u32 v90, v88, v89
    v_mfma_f32_16x16x32_bf16 v[240:243], a[24:27], v[164:167], v[240:243]
    buffer_load_dwordx4 a[172:175], v15, s[4:7], 0 offen offset:1024 sc1
    v_lshl_add_u32 v21, v90, 4, s27
    v_mfma_f32_16x16x32_bf16 v[240:243], a[44:47], v[168:171], v[240:243]
    v_mul_u32_u24 v89, 81760, v89
    v_lshl_add_u32 v93, v88, 4, v89
    v_mfma_f32_16x16x32_bf16 v[240:243], a[64:67], v[172:175], v[240:243]
    v_lshrrev_b32 v88, 5, v0
    v_lshl_add_u32 v93, v88, 31, v93
    v_mfma_f32_16x16x32_bf16 v[244:247], a[8:11], v[160:163], 0
    v_mfma_f32_16x16x32_bf16 v[244:247], a[28:31], v[164:167], v[244:247]
    buffer_load_dwordx4 a[176:179], v15, s[4:7], 0 offen offset:2048 sc1
    v_mfma_f32_16x16x32_bf16 v[244:247], a[48:51], v[168:171], v[244:247]
    v_mfma_f32_16x16x32_bf16 v[244:247], a[68:71], v[172:175], v[244:247]
    v_mfma_f32_16x16x32_bf16 v[248:251], a[12:15], v[160:163], 0
    v_mfma_f32_16x16x32_bf16 v[248:251], a[32:35], v[164:167], v[248:251]
    buffer_load_dwordx4 a[180:183], v15, s[4:7], 0 offen offset:3072 sc1
    v_mfma_f32_16x16x32_bf16 v[248:251], a[52:55], v[168:171], v[248:251]
    v_mfma_f32_16x16x32_bf16 v[248:251], a[72:75], v[172:175], v[248:251]
    v_mfma_f32_16x16x32_bf16 v[252:255], a[16:19], v[160:163], 0
    v_mfma_f32_16x16x32_bf16 v[252:255], a[36:39], v[164:167], v[252:255]
    v_mov_b32 v6, 0x1
    v_mfma_f32_16x16x32_bf16 v[252:255], a[56:59], v[168:171], v[252:255]
    s_waitcnt vmcnt(13)
    buffer_atomic_add v6, v12, s[4:7], s25 offen offset:4 sc1
    v_mfma_f32_16x16x32_bf16 v[252:255], a[76:79], v[172:175], v[252:255]
    buffer_load_dwordx2 v[74:75], v16, s[4:7], s34 offen sc1
    v_mfma_f32_16x16x32_bf16 v[176:179], a[80:83], v[40:43], v[176:179]
    v_mfma_f32_16x16x32_bf16 v[176:179], a[100:103], v[44:47], v[176:179]
    buffer_load_dwordx4 v[64:67], v8, s[4:7], s24 offen sc1
    v_mfma_f32_16x16x32_bf16 v[176:179], a[120:123], v[48:51], v[176:179]
    v_mfma_f32_16x16x32_bf16 v[176:179], a[140:143], v[52:55], v[176:179]
    v_mfma_f32_16x16x32_bf16 v[180:183], a[84:87], v[40:43], v[180:183]
    buffer_load_dwordx4 v[68:71], v8, s[4:7], s24 offen offset:512 sc1
    v_mfma_f32_16x16x32_bf16 v[180:183], a[104:107], v[44:47], v[180:183]
    v_mfma_f32_16x16x32_bf16 v[180:183], a[124:127], v[48:51], v[180:183]
    v_mfma_f32_16x16x32_bf16 v[180:183], a[144:147], v[52:55], v[180:183]
    buffer_load_dwordx2 v[72:73], v9, s[4:7], s24 offen offset:1024 sc1
    v_mfma_f32_16x16x32_bf16 v[184:187], a[88:91], v[40:43], v[184:187]
    v_mfma_f32_16x16x32_bf16 v[184:187], a[108:111], v[44:47], v[184:187]
    v_mfma_f32_16x16x32_bf16 v[184:187], a[128:131], v[48:51], v[184:187]
    v_mfma_f32_16x16x32_bf16 v[184:187], a[148:151], v[52:55], v[184:187]
    v_mfma_f32_16x16x32_bf16 v[188:191], a[92:95], v[40:43], v[188:191]
    ds_read_b128 a[184:187], v1 offset:57344
    v_mfma_f32_16x16x32_bf16 v[188:191], a[112:115], v[44:47], v[188:191]
    v_mfma_f32_16x16x32_bf16 v[188:191], a[132:135], v[48:51], v[188:191]
    s_waitcnt lgkmcnt(0)
    s_bitcmp1_b32 s48, 19
    s_cbranch_scc0 h21_slow
h21_ok:
    v_mfma_f32_16x16x32_bf16 v[188:191], a[152:155], v[52:55], v[188:191]
    ds_read_b128 a[188:191], v1 offset:58368
    v_add_u32 v7, s37, v14
    v_mfma_f32_16x16x32_bf16 v[192:195], a[96:99], v[40:43], v[192:195]
    s_add_u32 s37, s37, 4096
    v_mfma_f32_16x16x32_bf16 v[192:195], a[116:119], v[44:47], v[192:195]
    buffer_load_dwordx4 a[0:3], v7, s[4:7], 0 offen offset:0 sc1
    v_mfma_f32_16x16x32_bf16 v[192:195], a[136:139], v[48:51], v[192:195]
    buffer_load_dwordx4 a[4:7], v7, s[4:7], 0 offen offset:2048 sc1
    v_mfma_f32_16x16x32_bf16 v[192:195], a[156:159], v[52:55], v[192:195]
    ds_read_b128 a[192:195], v1 offset:59392
    v_mfma_f32_16x16x32_bf16 v[196:199], a[80:83], v[96:99], v[196:199]
    v_mfma_f32_16x16x32_bf16 v[196:199], a[100:103], v[100:103], v[196:199]
    v_mfma_f32_16x16x32_bf16 v[196:199], a[120:123], v[104:107], v[196:199]
    ds_read_b128 a[196:199], v1 offset:60416
    v_add_u32 v7, s37, v14
    v_mfma_f32_16x16x32_bf16 v[196:199], a[140:143], v[108:111], v[196:199]
    s_add_u32 s37, s37, 4096
    v_mfma_f32_16x16x32_bf16 v[200:203], a[84:87], v[96:99], v[200:203]
    buffer_load_dwordx4 a[8:11], v7, s[4:7], 0 offen offset:0 sc1
    v_mfma_f32_16x16x32_bf16 v[200:203], a[104:107], v[100:103], v[200:203]
    v_mfma_f32_16x16x32_bf16 v[200:203], a[124:127], v[104:107], v[200:203]
    buffer_load_dwordx4 a[12:15], v7, s[4:7], 0 offen offset:2048 sc1
    ds_read_b128 a[64:67], v1 offset:61440
    v_mfma_f32_16x16x32_bf16 v[200:203], a[144:147], v[108:111], v[200:203]
    v_mfma_f32_16x16x32_bf16 v[204:207], a[88:91], v[96:99], v[204:207]
    v_mfma_f32_16x16x32_bf16 v[204:207], a[108:111], v[100:103], v[204:207]
    v_add_u32 v7, s38, v14
    s_add_u32 s38, s38, 4096
    v_mfma_f32_16x16x32_bf16 v[204:207], a[128:131], v[104:107], v[204:207]
    buffer_load_dwordx4 a[16:19], v7, s[4:7], 0 offen offset:0 sc1
    ds_read_b128 a[68:71], v1 offset:62464
    v_mfma_f32_16x16x32_bf16 v[204:207], a[148:151], v[108:111], v[204:207]
    v_mfma_f32_16x16x32_bf16 v[208:211], a[92:95], v[96:99], v[208:211]
    v_mfma_f32_16x16x32_bf16 v[208:211], a[112:115], v[100:103], v[208:211]
    buffer_load_dwordx4 a[20:23], v7, s[4:7], 0 offen offset:2048 sc1
    ds_read_b128 a[72:75], v1 offset:63488
    v_mfma_f32_16x16x32_bf16 v[208:211], a[132:135], v[104:107], v[208:211]
    v_mfma_f32_16x16x32_bf16 v[208:211], a[152:155], v[108:111], v[208:211]
    v_mfma_f32_16x16x32_bf16 v[212:215], a[96:99], v[96:99], v[212:215]
    v_mfma_f32_16x16x32_bf16 v[212:215], a[116:119], v[100:103], v[212:215]
    ds_read_b128 a[76:79], v1 offset:64512
    v_add_u32 v7, s38, v14
    v_mfma_f32_16x16x32_bf16 v[212:215], a[136:139], v[104:107], v[212:215]
    s_add_u32 s38, s38, 4096
    v_mfma_f32_16x16x32_bf16 v[212:215], a[156:159], v[108:111], v[212:215]
    s_waitcnt vmcnt(21)
    buffer_load_dwordx4 a[24:27], v7, s[4:7], 0 offen offset:0 sc1
    v_mfma_f32_16x16x32_bf16 v[216:219], a[80:83], v[112:115], v[216:219]
    buffer_load_dwordx4 a[28:31], v7, s[4:7], 0 offen offset:2048 sc1
    ds_read_b128 v[168:171], v2 offset:0
    v_mfma_f32_16x16x32_bf16 v[216:219], a[100:103], v[116:119], v[216:219]
    v_mfma_f32_16x16x32_bf16 v[216:219], a[120:123], v[120:123], v[216:219]
    v_mfma_f32_16x16x32_bf16 v[216:219], a[140:143], v[124:127], v[216:219]
    v_mfma_f32_16x16x32_bf16 v[220:223], a[84:87], v[112:115], v[220:223]
    ds_read_b128 v[172:175], v2 offset:1024
    v_add_u32 v7, s39, v14
    v_mfma_f32_16x16x32_bf16 v[220:223], a[104:107], v[116:119], v[220:223]
    s_add_u32 s39, s39, 4096
    v_mfma_f32_16x16x32_bf16 v[220:223], a[124:127], v[120:123], v[220:223]
    buffer_load_dwordx4 a[32:35], v7, s[4:7], 0 offen offset:0 sc1
    v_mfma_f32_16x16x32_bf16 v[220:223], a[144:147], v[124:127], v[220:223]
    v_mfma_f32_16x16x32_bf16 v[224:227], a[88:91], v[112:115], v[224:227]
    buffer_load_dwordx4 a[36:39], v7, s[4:7], 0 offen offset:2048 sc1
    ds_read_b128 v[96:99], v2 offset:2048
    v_mfma_f32_16x16x32_bf16 v[224:227], a[108:111], v[116:119], v[224:227]
    s_branch .Lps7380
.Lpd7380:
    s_branch hop2_ret
.Lps7380:
    v_mfma_f32_16x16x32_bf16 v[224:227], a[128:131], v[120:123], v[224:227]
    v_mfma_f32_16x16x32_bf16 v[224:227], a[148:151], v[124:127], v[224:227]
    ds_read_b128 v[100:103], v2 offset:3072
    v_add_u32 v7, s39, v14
    v_mfma_f32_16x16x32_bf16 v[228:231], a[92:95], v[112:115], v[228:231]
    s_add_u32 s39, s39, 4096
    v_mfma_f32_16x16x32_bf16 v[228:231], a[112:115], v[116:119], v[228:231]
    buffer_load_dwordx4 a[40:43], v7, s[4:7], 0 offen offset:0 sc1
    v_mfma_f32_16x16x32_bf16 v[228:231], a[132:135], v[120:123], v[228:231]
    v_mfma_f32_16x16x32_bf16 v[228:231], a[152:155], v[124:127], v[228:231]
    buffer_load_dwordx4 a[44:47], v7, s[4:7], 0 offen offset:2048 sc1
    ds_read_b128 v[104:107], v2 offset:4096
    v_mfma_f32_16x16x32_bf16 v[232:235], a[96:99], v[112:115], v[232:235]
    v_mov_b32 v5, 0
    v_mfma_f32_16x16x32_bf16 v[232:235], a[116:119], v[116:119], v[232:235]
    buffer_atomic_add v5, v12, s[4:7], s33 offen sc0 sc1
    v_mfma_f32_16x16x32_bf16 v[232:235], a[136:139], v[120:123], v[232:235]
    ds_read_b128 v[108:111], v2 offset:5120
    v_mfma_f32_16x16x32_bf16 v[232:235], a[156:159], v[124:127], v[232:235]
    s_waitcnt vmcnt(24)
    v_add_u32 v7, s40, v14
    s_add_u32 s40, s40, 4096
    v_mfma_f32_16x16x32_bf16 v[236:239], a[80:83], v[128:131], v[236:239]
    buffer_load_dwordx4 a[48:51], v7, s[4:7], 0 offen offset:0 sc1
    v_mfma_f32_16x16x32_bf16 v[236:239], a[100:103], v[132:135], v[236:239]
    v_mfma_f32_16x16x32_bf16 v[236:239], a[120:123], v[136:139], v[236:239]
    buffer_load_dwordx4 a[52:55], v7, s[4:7], 0 offen offset:2048 sc1
    ds_read_b128 v[112:115], v2 offset:6144
    v_mfma_f32_16x16x32_bf16 v[236:239], a[140:143], v[140:143], v[236:239]
    v_mfma_f32_16x16x32_bf16 v[240:243], a[84:87], v[128:131], v[240:243]
    v_mfma_f32_16x16x32_bf16 v[240:243], a[104:107], v[132:135], v[240:243]
    v_mfma_f32_16x16x32_bf16 v[240:243], a[124:127], v[136:139], v[240:243]
    ds_read_b128 v[116:119], v2 offset:7168
    v_add_u32 v7, s40, v14
    v_mfma_f32_16x16x32_bf16 v[240:243], a[144:147], v[140:143], v[240:243]
    s_add_u32 s40, s40, 4096
    v_mfma_f32_16x16x32_bf16 v[244:247], a[88:91], v[128:131], v[244:247]
    buffer_load_dwordx4 a[56:59], v7, s[4:7], 0 offen offset:0 sc1
    v_mfma_f32_16x16x32_bf16 v[244:247], a[108:111], v[132:135], v[244:247]
    ds_read_b128 v[120:123], v2 offset:8192
    v_mfma_f32_16x16x32_bf16 v[244:247], a[128:131], v[136:139], v[244:247]
    s_waitcnt vmcnt(16)
    buffer_load_dwordx4 a[60:63], v7, s[4:7], 0 offen offset:2048 sc1
    v_mfma_f32_16x16x32_bf16 v[244:247], a[148:151], v[140:143], v[244:247]
    v_lshlrev_b32 v24, 16, v64
    v_fma_f32 v24, v24, v75, v74
    v_mfma_f32_16x16x32_bf16 v[248:251], a[92:95], v[128:131], v[248:251]
    v_and_b32 v25, 0xffff0000, v64
    v_fma_f32 v25, v25, v75, v74
    v_mfma_f32_16x16x32_bf16 v[248:251], a[112:115], v[132:135], v[248:251]
    ds_read_b128 v[124:127], v2 offset:9216
    v_lshlrev_b32 v26, 16, v65
    v_mfma_f32_16x16x32_bf16 v[248:251], a[132:135], v[136:139], v[248:251]
    v_fma_f32 v26, v26, v75, v74
    v_and_b32 v27, 0xffff0000, v65
    v_mfma_f32_16x16x32_bf16 v[248:251], a[152:155], v[140:143], v[248:251]
    v_fma_f32 v27, v27, v75, v74
    v_lshlrev_b32 v28, 16, v66
    v_mfma_f32_16x16x32_bf16 v[252:255], a[96:99], v[128:131], v[252:255]
    v_fma_f32 v28, v28, v75, v74
    v_and_b32 v29, 0xffff0000, v66
    v_mfma_f32_16x16x32_bf16 v[252:255], a[116:119], v[132:135], v[252:255]
    v_fma_f32 v29, v29, v75, v74
    v_lshlrev_b32 v30, 16, v67
    v_mfma_f32_16x16x32_bf16 v[252:255], a[136:139], v[136:139], v[252:255]
    v_fma_f32 v30, v30, v75, v74
    v_and_b32 v31, 0xffff0000, v67
    v_mfma_f32_16x16x32_bf16 v[252:255], a[156:159], v[140:143], v[252:255]
    s_waitcnt vmcnt(13)
    v_fma_f32 v31, v31, v75, v74
    v_lshlrev_b32 v32, 16, v68
    v_mfma_f32_16x16x32_bf16 v[176:179], a[200:203], a[0:3], v[176:179]
    v_fma_f32 v32, v32, v75, v74
    v_and_b32 v33, 0xffff0000, v68
    v_mfma_f32_16x16x32_bf16 v[176:179], a[220:223], a[4:7], v[176:179]
    ds_read_b128 a[80:83], v2 offset:10240
    v_fma_f32 v33, v33, v75, v74
    v_mfma_f32_16x16x32_bf16 v[176:179], a[240:243], a[8:11], v[176:179]
    ds_read_b128 a[84:87], v2 offset:11264
    v_lshlrev_b32 v34, 16, v69
    v_mfma_f32_16x16x32_bf16 v[176:179], a[164:167], a[12:15], v[176:179]
    ds_read_b128 a[88:91], v2 offset:12288
    v_fma_f32 v34, v34, v75, v74
    v_mfma_f32_16x16x32_bf16 v[180:183], a[204:207], a[0:3], v[180:183]
    ds_read_b128 a[92:95], v2 offset:13312
    v_and_b32 v35, 0xffff0000, v69
    v_mfma_f32_16x16x32_bf16 v[180:183], a[224:227], a[4:7], v[180:183]
    v_fma_f32 v35, v35, v75, v74
    v_lshlrev_b32 v36, 16, v70
    v_mfma_f32_16x16x32_bf16 v[180:183], a[244:247], a[8:11], v[180:183]
    ds_read_b128 a[96:99], v2 offset:14336
    v_fma_f32 v36, v36, v75, v74
    v_mfma_f32_16x16x32_bf16 v[180:183], a[168:171], a[12:15], v[180:183]
    ds_read_b128 a[100:103], v2 offset:15360
    v_and_b32 v37, 0xffff0000, v70
    v_mfma_f32_16x16x32_bf16 v[184:187], a[208:211], a[0:3], v[184:187]
    ds_read_b128 a[104:107], v2 offset:16384
    v_fma_f32 v37, v37, v75, v74
    v_mfma_f32_16x16x32_bf16 v[184:187], a[228:231], a[4:7], v[184:187]
    ds_read_b128 a[108:111], v2 offset:17408
    v_lshlrev_b32 v38, 16, v71
    v_mfma_f32_16x16x32_bf16 v[184:187], a[248:251], a[8:11], v[184:187]
    ds_write_b128 v3, v[176:179] offset:0
    v_mfma_f32_16x16x32_bf16 v[184:187], a[172:175], a[12:15], v[184:187]
    ds_read_b128 a[112:115], v2 offset:18432
    v_fma_f32 v38, v38, v75, v74
    v_mfma_f32_16x16x32_bf16 v[188:191], a[212:215], a[0:3], v[188:191]
    ds_read_b128 a[116:119], v2 offset:19456
    v_and_b32 v39, 0xffff0000, v71
    v_mfma_f32_16x16x32_bf16 v[188:191], a[232:235], a[4:7], v[188:191]
    ds_read_b128 a[120:123], v2 offset:20480
    v_fma_f32 v39, v39, v75, v74
    v_mfma_f32_16x16x32_bf16 v[188:191], a[252:255], a[8:11], v[188:191]
    ds_read_b128 a[124:127], v2 offset:21504
    v_lshlrev_b32 v40, 16, v72
    v_mfma_f32_16x16x32_bf16 v[188:191], a[176:179], a[12:15], v[188:191]
    ds_write_b128 v3, v[180:183] offset:1024
    v_mfma_f32_16x16x32_bf16 v[192:195], a[216:219], a[0:3], v[192:195]
    v_fma_f32 v40, v40, v75, v74
    v_and_b32 v41, 0xffff0000, v72
    v_mfma_f32_16x16x32_bf16 v[192:195], a[236:239], a[4:7], v[192:195]
    v_fma_f32 v41, v41, v75, v74
    v_lshlrev_b32 v42, 16, v73
    v_mfma_f32_16x16x32_bf16 v[192:195], a[160:163], a[8:11], v[192:195]
    ds_write_b128 v3, v[184:187] offset:2048
    v_mfma_f32_16x16x32_bf16 v[192:195], a[180:183], a[12:15], v[192:195]
    s_waitcnt vmcnt(9)
    v_fma_f32 v42, v42, v75, v74
    v_and_b32 v43, 0xffff0000, v73
    v_mfma_f32_16x16x32_bf16 v[196:199], a[200:203], a[16:19], v[196:199]
    v_fma_f32 v43, v43, v75, v74
    v_add_f32 v236, v236, v24
    v_mfma_f32_16x16x32_bf16 v[196:199], a[220:223], a[20:23], v[196:199]
    v_add_f32 v237, v237, v25
    v_add_f32 v238, v238, v26
    v_mfma_f32_16x16x32_bf16 v[196:199], a[240:243], a[24:27], v[196:199]
    ds_write_b128 v3, v[188:191] offset:3072
    v_mfma_f32_16x16x32_bf16 v[196:199], a[164:167], a[28:31], v[196:199]
    v_add_f32 v239, v239, v27
    v_add_f32 v240, v240, v28
    v_mfma_f32_16x16x32_bf16 v[200:203], a[204:207], a[16:19], v[200:203]
    v_add_f32 v241, v241, v29
    v_add_f32 v242, v242, v30
    v_mfma_f32_16x16x32_bf16 v[200:203], a[224:227], a[20:23], v[200:203]
    v_add_f32 v243, v243, v31
    v_add_f32 v244, v244, v32
    v_mfma_f32_16x16x32_bf16 v[200:203], a[244:247], a[24:27], v[200:203]
    ds_write_b128 v3, v[192:195] offset:4096
    v_mfma_f32_16x16x32_bf16 v[200:203], a[168:171], a[28:31], v[200:203]
    v_add_f32 v245, v245, v33
    v_add_f32 v246, v246, v34
    v_mfma_f32_16x16x32_bf16 v[204:207], a[208:211], a[16:19], v[204:207]
    v_add_f32 v247, v247, v35
    v_add_f32 v248, v248, v36
    v_mfma_f32_16x16x32_bf16 v[204:207], a[228:231], a[20:23], v[204:207]
    v_add_f32 v249, v249, v37
    v_add_f32 v250, v250, v38
    v_mfma_f32_16x16x32_bf16 v[204:207], a[248:251], a[24:27], v[204:207]
    s_waitcnt vmcnt(4)
    v_readfirstlane_b32 s48, v5
    v_add_f32 v251, v251, v39
    v_mfma_f32_16x16x32_bf16 v[204:207], a[172:175], a[28:31], v[204:207]
    ds_write_b128 v3, v[196:199] offset:5120
    v_mfma_f32_16x16x32_bf16 v[208:211], a[212:215], a[16:19], v[208:211]
    s_bitcmp1_b32 s48, 4
    s_cbranch_scc0 h31_slow
h31_ok:
    v_add_f32 v252, v252, v40
    v_mfma_f32_16x16x32_bf16 v[208:211], a[232:235], a[20:23], v[208:211]
    buffer_load_dwordx2 v[144:145], v17, s[4:7], 0 offen offset:0 sc1
    v_add_f32 v253, v253, v41
    v_mfma_f32_16x16x32_bf16 v[208:211], a[252:255], a[24:27], v[208:211]
    ds_write_b128 v3, v[200:203] offset:6144
    v_mfma_f32_16x16x32_bf16 v[208:211], a[176:179], a[28:31], v[208:211]
    buffer_load_dwordx2 v[146:147], v17, s[4:7], 0 offen offset:1024 sc1
    v_add_f32 v254, v254, v42
    v_mfma_f32_16x16x32_bf16 v[212:215], a[216:219], a[16:19], v[212:215]
    v_add_f32 v255, v255, v43
    v_mfma_f32_16x16x32_bf16 v[212:215], a[236:239], a[20:23], v[212:215]
    v_mfma_f32_16x16x32_bf16 v[212:215], a[160:163], a[24:27], v[212:215]
    buffer_load_dwordx2 v[148:149], v17, s[4:7], 0 offen offset:2048 sc1
    v_mfma_f32_16x16x32_bf16 v[212:215], a[180:183], a[28:31], v[212:215]
    ds_write_b128 v3, v[204:207] offset:7168
    v_mfma_f32_16x16x32_bf16 v[216:219], a[200:203], a[32:35], v[216:219]
    buffer_load_dwordx2 v[150:151], v17, s[4:7], 0 offen offset:3072 sc1
    v_mfma_f32_16x16x32_bf16 v[216:219], a[220:223], a[36:39], v[216:219]
    v_mfma_f32_16x16x32_bf16 v[216:219], a[240:243], a[40:43], v[216:219]
    ds_write_b128 v3, v[208:211] offset:8192
    v_mfma_f32_16x16x32_bf16 v[216:219], a[164:167], a[44:47], v[216:219]
    v_add_u32 v17, 4096, v17
    v_mfma_f32_16x16x32_bf16 v[220:223], a[204:207], a[32:35], v[220:223]
    buffer_load_dwordx2 v[152:153], v17, s[4:7], 0 offen offset:0 sc1
    v_mfma_f32_16x16x32_bf16 v[220:223], a[224:227], a[36:39], v[220:223]
    buffer_load_dwordx2 v[154:155], v17, s[4:7], 0 offen offset:1024 sc1
    v_mfma_f32_16x16x32_bf16 v[220:223], a[244:247], a[40:43], v[220:223]
    ds_write_b128 v3, v[212:215] offset:9216
    v_mfma_f32_16x16x32_bf16 v[220:223], a[168:171], a[44:47], v[220:223]
    v_mfma_f32_16x16x32_bf16 v[224:227], a[208:211], a[32:35], v[224:227]
    buffer_load_dwordx2 v[156:157], v17, s[4:7], 0 offen offset:2048 sc1
    v_mfma_f32_16x16x32_bf16 v[224:227], a[228:231], a[36:39], v[224:227]
    v_mfma_f32_16x16x32_bf16 v[224:227], a[248:251], a[40:43], v[224:227]
    buffer_load_dwordx2 v[158:159], v17, s[4:7], 0 offen offset:3072 sc1
    v_mfma_f32_16x16x32_bf16 v[224:227], a[172:175], a[44:47], v[224:227]
    ds_write_b128 v10, v[216:219] offset:20480
    v_mfma_f32_16x16x32_bf16 v[228:231], a[212:215], a[32:35], v[228:231]
    v_mfma_f32_16x16x32_bf16 v[228:231], a[232:235], a[36:39], v[228:231]
    v_add_u32 v17, 4096, v17
    v_mfma_f32_16x16x32_bf16 v[228:231], a[252:255], a[40:43], v[228:231]
    buffer_load_dwordx2 v[160:161], v17, s[4:7], 0 offen offset:0 sc1
    v_mfma_f32_16x16x32_bf16 v[228:231], a[176:179], a[44:47], v[228:231]
    ds_write_b128 v10, v[220:223] offset:21504
    v_mfma_f32_16x16x32_bf16 v[232:235], a[216:219], a[32:35], v[232:235]
    buffer_load_dwordx2 v[162:163], v17, s[4:7], 0 offen offset:1024 sc1
    v_mfma_f32_16x16x32_bf16 v[232:235], a[236:239], a[36:39], v[232:235]
    v_mfma_f32_16x16x32_bf16 v[232:235], a[160:163], a[40:43], v[232:235]
    buffer_load_dwordx2 v[164:165], v17, s[4:7], 0 offen offset:2048 sc1
    v_mfma_f32_16x16x32_bf16 v[232:235], a[180:183], a[44:47], v[232:235]
    s_waitcnt vmcnt(11)
    ds_write_b128 v10, v[224:227] offset:22528
    v_mfma_f32_16x16x32_bf16 v[236:239], a[200:203], a[48:51], v[236:239]
    buffer_load_dwordx2 v[166:167], v17, s[4:7], 0 offen offset:3072 sc1
    v_mfma_f32_16x16x32_bf16 v[236:239], a[220:223], a[52:55], v[236:239]
    v_mfma_f32_16x16x32_bf16 v[236:239], a[240:243], a[56:59], v[236:239]
    ds_write_b128 v10, v[228:231] offset:23552
    v_mfma_f32_16x16x32_bf16 v[236:239], a[164:167], a[60:63], v[236:239]
    v_mfma_f32_16x16x32_bf16 v[240:243], a[204:207], a[48:51], v[240:243]
    v_mfma_f32_16x16x32_bf16 v[240:243], a[224:227], a[52:55], v[240:243]
    v_mfma_f32_16x16x32_bf16 v[240:243], a[244:247], a[56:59], v[240:243]
    ds_write_b128 v10, v[232:235] offset:24576
    v_mfma_f32_16x16x32_bf16 v[240:243], a[168:171], a[60:63], v[240:243]
    v_mfma_f32_16x16x32_bf16 v[244:247], a[208:211], a[48:51], v[244:247]
    v_mfma_f32_16x16x32_bf16 v[244:247], a[228:231], a[52:55], v[244:247]
    v_mfma_f32_16x16x32_bf16 v[244:247], a[248:251], a[56:59], v[244:247]
    v_mfma_f32_16x16x32_bf16 v[244:247], a[172:175], a[60:63], v[244:247]
    v_mfma_f32_16x16x32_bf16 v[248:251], a[212:215], a[48:51], v[248:251]
    s_waitcnt lgkmcnt(0)
    s_barrier
    v_mfma_f32_16x16x32_bf16 v[248:251], a[232:235], a[52:55], v[248:251]
    ds_read_b128 v[176:179], v11 offset:0
    ds_read_b128 v[180:183], v11 offset:1024
    v_mfma_f32_16x16x32_bf16 v[248:251], a[252:255], a[56:59], v[248:251]
    ds_read_b128 v[184:187], v11 offset:2048
    ds_read_b128 v[188:191], v11 offset:3072
    v_mfma_f32_16x16x32_bf16 v[248:251], a[176:179], a[60:63], v[248:251]
    ds_read_b128 v[192:195], v11 offset:4096
    ds_read_b128 v[196:199], v22 offset:5120
    v_mfma_f32_16x16x32_bf16 v[252:255], a[216:219], a[48:51], v[252:255]
    ds_read_b128 v[200:203], v22 offset:6144
    ds_read_b128 v[204:207], v22 offset:7168
    v_mfma_f32_16x16x32_bf16 v[252:255], a[236:239], a[52:55], v[252:255]
    ds_read_b128 v[208:211], v22 offset:8192
    ds_read_b128 v[212:215], v22 offset:9216
    v_mfma_f32_16x16x32_bf16 v[252:255], a[160:163], a[56:59], v[252:255]
    ds_read_b128 v[216:219], v23 offset:20480
    ds_read_b128 v[220:223], v23 offset:21504
    v_mfma_f32_16x16x32_bf16 v[252:255], a[180:183], a[60:63], v[252:255]
    s_waitcnt vmcnt(8)
    ds_read_b128 v[224:227], v23 offset:22528
    ds_read_b128 v[228:231], v23 offset:23552
    v_mfma_f32_16x16x32_bf16 v[236:239], a[184:187], v[144:147], v[236:239]
    ds_read_b128 v[232:235], v23 offset:24576
    v_mfma_f32_16x16x32_bf16 v[236:239], a[68:71], v[148:151], v[236:239]
    v_mfma_f32_16x16x32_bf16 v[240:243], a[188:191], v[144:147], v[240:243]
    v_mfma_f32_16x16x32_bf16 v[240:243], a[72:75], v[148:151], v[240:243]
    v_mfma_f32_16x16x32_bf16 v[244:247], a[192:195], v[144:147], v[244:247]
    v_mfma_f32_16x16x32_bf16 v[244:247], a[76:79], v[148:151], v[244:247]
    v_mfma_f32_16x16x32_bf16 v[248:251], a[196:199], v[144:147], v[248:251]
    v_mfma_f32_16x16x32_bf16 v[248:251], v[168:171], v[148:151], v[248:251]
    v_mfma_f32_16x16x32_bf16 v[252:255], a[64:67], v[144:147], v[252:255]
    s_waitcnt lgkmcnt(0)
    v_mfma_f32_16x16x32_bf16 v[252:255], v[172:175], v[148:151], v[252:255]
    s_waitcnt vmcnt(4)
    v_add_f32 v24, v176, v196
    v_add_f32 v25, v177, v197
    v_mfma_f32_16x16x32_bf16 v[236:239], v[96:99], v[152:155], v[236:239]
    v_add_f32 v26, v178, v198
    v_add_f32 v24, v24, v216
    v_mfma_f32_16x16x32_bf16 v[236:239], v[116:119], v[156:159], v[236:239]
    v_add_f32 v27, v179, v199
    v_add_f32 v25, v25, v217
    v_mfma_f32_16x16x32_bf16 v[240:243], v[100:103], v[152:155], v[240:243]
    v_add_f32 v26, v26, v218
    v_add_f32 v28, v180, v200
    v_mfma_f32_16x16x32_bf16 v[240:243], v[120:123], v[156:159], v[240:243]
    v_add_f32 v27, v27, v219
    v_add_f32 v29, v181, v201
    v_mfma_f32_16x16x32_bf16 v[244:247], v[104:107], v[152:155], v[244:247]
    v_add_f32 v30, v182, v202
    v_add_f32 v28, v28, v220
    v_mfma_f32_16x16x32_bf16 v[244:247], v[124:127], v[156:159], v[244:247]
    v_add_f32 v31, v183, v203
    v_add_f32 v29, v29, v221
    v_mfma_f32_16x16x32_bf16 v[248:251], v[108:111], v[152:155], v[248:251]
    v_add_f32 v30, v30, v222
    v_add_f32 v32, v184, v204
    v_mfma_f32_16x16x32_bf16 v[248:251], a[80:83], v[156:159], v[248:251]
    v_add_f32 v33, v185, v205
    v_add_f32 v31, v31, v223
    v_mfma_f32_16x16x32_bf16 v[252:255], v[112:115], v[152:155], v[252:255]
    v_add_f32 v34, v186, v206
    v_add_f32 v32, v32, v224
    v_mfma_f32_16x16x32_bf16 v[252:255], a[84:87], v[156:159], v[252:255]
    s_waitcnt vmcnt(0)
    v_add_f32 v33, v33, v225
    v_add_f32 v35, v187, v207
    v_mfma_f32_16x16x32_bf16 v[236:239], a[88:91], v[160:163], v[236:239]
    v_add_f32 v36, v188, v208
    v_add_f32 v34, v34, v226
    v_mfma_f32_16x16x32_bf16 v[236:239], a[108:111], v[164:167], v[236:239]
    v_add_f32 v37, v189, v209
    v_add_f32 v35, v35, v227
    v_mfma_f32_16x16x32_bf16 v[240:243], a[92:95], v[160:163], v[240:243]
    v_add_f32 v36, v36, v228
    v_add_f32 v38, v190, v210
    v_mfma_f32_16x16x32_bf16 v[240:243], a[112:115], v[164:167], v[240:243]
    v_add_f32 v37, v37, v229
    v_add_f32 v39, v191, v211
    v_mfma_f32_16x16x32_bf16 v[244:247], a[96:99], v[160:163], v[244:247]
    v_add_f32 v40, v192, v212
    v_add_f32 v38, v38, v230
    v_mfma_f32_16x16x32_bf16 v[244:247], a[116:119], v[164:167], v[244:247]
    v_add_f32 v41, v193, v213
    v_add_f32 v39, v39, v231
    v_mfma_f32_16x16x32_bf16 v[248:251], a[100:103], v[160:163], v[248:251]
    v_add_f32 v40, v40, v232
    v_add_f32 v42, v194, v214
    v_mfma_f32_16x16x32_bf16 v[248:251], a[120:123], v[164:167], v[248:251]
    v_add_f32 v43, v195, v215
    v_add_f32 v41, v41, v233
    v_mfma_f32_16x16x32_bf16 v[252:255], a[104:107], v[160:163], v[252:255]
    v_add_f32 v42, v42, v234
    v_add_f32 v43, v43, v235
    v_mfma_f32_16x16x32_bf16 v[252:255], a[124:127], v[164:167], v[252:255]
    v_pk_add_f32 v[24:25], v[24:25], v[236:237]
    v_pk_add_f32 v[26:27], v[26:27], v[238:239]
    v_pk_add_f32 v[28:29], v[28:29], v[240:241]
    v_pk_add_f32 v[30:31], v[30:31], v[242:243]
    v_pk_add_f32 v[32:33], v[32:33], v[244:245]
    v_pk_add_f32 v[34:35], v[34:35], v[246:247]
    v_pk_add_f32 v[36:37], v[36:37], v[248:249]
    v_pk_add_f32 v[38:39], v[38:39], v[250:251]
    v_pk_add_f32 v[40:41], v[40:41], v[252:253]
    v_pk_add_f32 v[42:43], v[42:43], v[254:255]
    v_cvt_pk_bf16_f32 v64, v24, v25
    v_cvt_pk_bf16_f32 v65, v26, v27
    ds_write_b64 v18, v[64:65] offset:0
    v_cvt_pk_bf16_f32 v66, v28, v29
    v_cvt_pk_bf16_f32 v67, v30, v31
    ds_write_b64 v18, v[66:67] offset:8
    v_cvt_pk_bf16_f32 v68, v32, v33
    v_cvt_pk_bf16_f32 v69, v34, v35
    ds_write_b64 v18, v[68:69] offset:16
    v_cvt_pk_bf16_f32 v70, v36, v37
    v_cvt_pk_bf16_f32 v71, v38, v39
    ds_write_b64 v18, v[70:71] offset:24
    v_cvt_pk_bf16_f32 v72, v40, v41
    v_cvt_pk_bf16_f32 v73, v42, v43
    ds_write_b64 v18, v[72:73] offset:32
    ds_read_b128 v[44:47], v19
    ds_read_b128 v[48:51], v20
    ds_read_b128 v[52:55], v21
    s_waitcnt lgkmcnt(2)
    buffer_store_dwordx4 v[44:47], v91, s[8:11], s32 offen sc1
    s_waitcnt lgkmcnt(1)
    buffer_store_dwordx4 v[48:51], v92, s[8:11], s32 offen sc1
    s_waitcnt lgkmcnt(0)
    buffer_store_dwordx4 v[52:55], v93, s[8:11], s32 offen sc1
    s_endpgm
h00_slow:
    s_mov_b32 s49, 0
h00_spin:
    v_mov_b32 v5, 0
    buffer_atomic_add v5, v12, s[4:7], s47 offen sc0 sc1
    s_add_u32 s49, s49, 1
    s_waitcnt vmcnt(0)
    v_readfirstlane_b32 s48, v5
    s_nop 1
    s_bitcmp1_b32 s48, 3
    s_cbranch_scc1 h00_ok
    s_cmp_lt_u32 s49, 20000
    s_cbranch_scc1 h00_spin
    s_branch h00_ok
h10_slow:
    s_mov_b32 s49, 0
h10_spin:
    v_mov_b32 v5, 0
    buffer_atomic_add v5, v12, s[4:7], s47 offen sc0 sc1
    s_add_u32 s49, s49, 1
    s_waitcnt vmcnt(0)
    v_readfirstlane_b32 s48, v5
    s_nop 1
    s_bitcmp1_b32 s48, 11
    s_cbranch_scc1 h10_ok
    s_cmp_lt_u32 s49, 20000
    s_cbranch_scc1 h10_spin
    s_branch h10_ok
h20_slow:
    s_mov_b32 s49, 0
h20_spin:
    s_load_dword s48, s[52:53], s47 glc
    s_add_u32 s49, s49, 1
    s_waitcnt lgkmcnt(0)
    s_bitcmp1_b32 s48, 19
    s_cbranch_scc1 h20_ok
    s_cmp_lt_u32 s49, 20000
    s_cbranch_scc1 h20_spin
    s_branch h20_ok
h30_slow:
    s_mov_b32 s49, 0
h30_spin:
    v_mov_b32 v5, 0
    buffer_atomic_add v5, v12, s[4:7], s33 offen sc0 sc1
    s_add_u32 s49, s49, 1
    s_waitcnt vmcnt(0)
    v_readfirstlane_b32 s48, v5
    s_nop 1
    s_bitcmp1_b32 s48, 4
    s_cbranch_scc1 h30_ok
    s_cmp_lt_u32 s49, 20000
    s_cbranch_scc1 h30_spin
    s_branch h30_ok
h01_slow:
    s_mov_b32 s49, 0
h01_spin:
    v_mov_b32 v5, 0
    buffer_atomic_add v5, v12, s[4:7], s47 offen sc0 sc1
    s_add_u32 s49, s49, 1
    s_waitcnt vmcnt(0)
    v_readfirstlane_b32 s48, v5
    s_nop 1
    s_bitcmp1_b32 s48, 3
    s_cbranch_scc1 h01_ok
    s_cmp_lt_u32 s49, 20000
    s_cbranch_scc1 h01_spin
    s_branch h01_ok
h11_slow:
    s_mov_b32 s49, 0
h11_spin:
    v_mov_b32 v5, 0
    buffer_atomic_add v5, v12, s[4:7], s47 offen sc0 sc1
    s_add_u32 s49, s49, 1
    s_waitcnt vmcnt(0)
    v_readfirstlane_b32 s48, v5
    s_nop 1
    s_bitcmp1_b32 s48, 11
    s_cbranch_scc1 h11_ok
    s_cmp_lt_u32 s49, 20000
    s_cbranch_scc1 h11_spin
    s_branch h11_ok
h21_slow:
    s_mov_b32 s49, 0
h21_spin:
    s_load_dword s48, s[52:53], s47 glc
    s_add_u32 s49, s49, 1
    s_waitcnt lgkmcnt(0)
    s_bitcmp1_b32 s48, 19
    s_cbranch_scc1 h21_ok
    s_cmp_lt_u32 s49, 20000
    s_cbranch_scc1 h21_spin
    s_branch h21_ok
h31_slow:
    s_mov_b32 s49, 0
h31_spin:
    v_mov_b32 v5, 0
    buffer_atomic_add v5, v12, s[4:7], s33 offen sc0 sc1
    s_add_u32 s49, s49, 1
    s_waitcnt vmcnt(0)
    v_readfirstlane_b32 s48, v5
    s_nop 1
    s_bitcmp1_b32 s48, 4
    s_cbranch_scc1 h31_ok
    s_cmp_lt_u32 s49, 20000
    s_cbranch_scc1 h31_spin
    s_branch h31_ok
st_slow:
    s_mov_b32 s49, 0
st_spin:
    buffer_load_dwordx2 v[96:97], v21, s[4:7], s35 offen sc1
    buffer_load_dwordx2 v[98:99], v21, s[4:7], s35 offen offset:128 sc1
    s_add_u32 s49, s49, 1
    s_cmp_ge_u32 s49, 20000
    s_waitcnt vmcnt(0)
    s_cbranch_scc1 st_ok
    v_max3_u32 v101, v96, v97, v98
    v_max_u32 v101, v101, v99
    v_cmp_eq_u32 vcc, -1, v101
    s_nop 4
    s_cbranch_vccnz st_spin
    s_branch st_ok
a2a0_slow:
    s_mov_b32 s49, 0
a2a0_spin:
    v_mov_b32 v242, 0
    buffer_atomic_add v242, v12, s[4:7], s37 offen sc0 sc1
    s_waitcnt vmcnt(2)
    v_readfirstlane_b32 s48, v243
    s_nop 1
    s_bitcmp1_b32 s48, 4
    s_cbranch_scc1 a2a0_ok
    v_mov_b32 v243, 0
    buffer_atomic_add v243, v12, s[4:7], s37 offen sc0 sc1
    s_waitcnt vmcnt(2)
    v_readfirstlane_b32 s48, v244
    s_nop 1
    s_bitcmp1_b32 s48, 4
    s_cbranch_scc1 a2a0_ok
    v_mov_b32 v244, 0
    buffer_atomic_add v244, v12, s[4:7], s37 offen sc0 sc1
    s_waitcnt vmcnt(2)
    v_readfirstlane_b32 s48, v242
    s_nop 1
    s_bitcmp1_b32 s48, 4
    s_cbranch_scc1 a2a0_ok
    s_add_u32 s49, s49, 1
    s_cmp_lt_u32 s49, 20000
    s_cbranch_scc1 a2a0_spin
    s_branch a2a0_ok
zf0_slow:
    s_mov_b32 s49, 0
zf0_spin:
    v_mov_b32 v5, 0
    buffer_atomic_add v5, v12, s[4:7], s36 offen sc0 sc1
    s_waitcnt vmcnt(2)
    v_readfirstlane_b32 s48, v8
    s_nop 1
    s_bitcmp1_b32 s48, 2
    s_cbranch_scc1 zf0_ok
    v_mov_b32 v8, 0
    buffer_atomic_add v8, v12, s[4:7], s36 offen sc0 sc1
    s_waitcnt vmcnt(2)
    v_readfirstlane_b32 s48, v9
    s_nop 1
    s_bitcmp1_b32 s48, 2
    s_cbranch_scc1 zf0_ok
    v_mov_b32 v9, 0
    buffer_atomic_add v9, v12, s[4:7], s36 offen sc0 sc1
    s_waitcnt vmcnt(2)
    v_readfirstlane_b32 s48, v5
    s_nop 1
    s_bitcmp1_b32 s48, 2
    s_cbranch_scc1 zf0_ok
    s_add_u32 s49, s49, 1
    s_cmp_lt_u32 s49, 20000
    s_cbranch_scc1 zf0_spin
    s_branch zf0_ok
a2a1_slow:
    s_mov_b32 s49, 0
a2a1_spin:
    v_mov_b32 v242, 0
    buffer_atomic_add v242, v12, s[4:7], s37 offen sc0 sc1
    s_waitcnt vmcnt(2)
    v_readfirstlane_b32 s48, v243
    s_nop 1
    s_bitcmp1_b32 s48, 4
    s_cbranch_scc1 a2a1_ok
    v_mov_b32 v243, 0
    buffer_atomic_add v243, v12, s[4:7], s37 offen sc0 sc1
    s_waitcnt vmcnt(2)
    v_readfirstlane_b32 s48, v244
    s_nop 1
    s_bitcmp1_b32 s48, 4
    s_cbranch_scc1 a2a1_ok
    v_mov_b32 v244, 0
    buffer_atomic_add v244, v12, s[4:7], s37 offen sc0 sc1
    s_waitcnt vmcnt(2)
    v_readfirstlane_b32 s48, v242
    s_nop 1
    s_bitcmp1_b32 s48, 4
    s_cbranch_scc1 a2a1_ok
    s_add_u32 s49, s49, 1
    s_cmp_lt_u32 s49, 20000
    s_cbranch_scc1 a2a1_spin
    s_branch a2a1_ok
zf1_slow:
    s_mov_b32 s49, 0
zf1_spin:
    v_mov_b32 v5, 0
    buffer_atomic_add v5, v12, s[4:7], s36 offen sc0 sc1
    s_waitcnt vmcnt(2)
    v_readfirstlane_b32 s48, v8
    s_nop 1
    s_bitcmp1_b32 s48, 2
    s_cbranch_scc1 zf1_ok
    v_mov_b32 v8, 0
    buffer_atomic_add v8, v12, s[4:7], s36 offen sc0 sc1
    s_waitcnt vmcnt(2)
    v_readfirstlane_b32 s48, v9
    s_nop 1
    s_bitcmp1_b32 s48, 2
    s_cbranch_scc1 zf1_ok
    v_mov_b32 v9, 0
    buffer_atomic_add v9, v12, s[4:7], s36 offen sc0 sc1
    s_waitcnt vmcnt(2)
    v_readfirstlane_b32 s48, v5
    s_nop 1
    s_bitcmp1_b32 s48, 2
    s_cbranch_scc1 zf1_ok
    s_add_u32 s49, s49, 1
    s_cmp_lt_u32 s49, 20000
    s_cbranch_scc1 zf1_spin
    s_branch zf1_ok
g_slow0:
    s_mov_b32 s49, 0
    s_mov_b32 s98, m0
g_spin0:
    s_mov_b32 m0, 0
g_copy0:
    v_add_u32 v190, m0, v252
    buffer_load_dwordx4 v190, s[4:7], 0 offen offset:0 sc1 lds
    buffer_load_dwordx4 v190, s[4:7], 0 offen offset:1024 sc1 lds
    buffer_load_dwordx4 v190, s[4:7], 0 offen offset:2048 sc1 lds
    buffer_load_dwordx4 v190, s[4:7], 0 offen offset:3072 sc1 lds
    s_add_u32 m0, m0, 4096
    s_cmp_lt_u32 m0, 81920
    s_cbranch_scc1 g_copy0
    s_waitcnt vmcnt(0)
    ds_read_b64_tr_b16 v[72:73], v1 offset:0
    ds_read_b64_tr_b16 v[74:75], v1 offset:20480
    ds_read_b64_tr_b16 v[76:77], v1 offset:512
    ds_read_b64_tr_b16 v[78:79], v1 offset:20992
    ds_read_b64_tr_b16 v[80:81], v1 offset:1024
    ds_read_b64_tr_b16 v[82:83], v1 offset:21504
    ds_read_b64_tr_b16 v[84:85], v1 offset:1536
    ds_read_b64_tr_b16 v[86:87], v1 offset:22016
    ds_read_b64_tr_b16 v[88:89], v1 offset:2048
    ds_read_b64_tr_b16 v[90:91], v1 offset:22528
    ds_read_b64_tr_b16 v[92:93], v2 offset:0
    ds_read_b64_tr_b16 v[94:95], v2 offset:20480
    ds_read_b64_tr_b16 v[96:97], v2 offset:512
    ds_read_b64_tr_b16 v[98:99], v2 offset:20992
    ds_read_b64_tr_b16 v[100:101], v2 offset:1024
    ds_read_b64_tr_b16 v[102:103], v2 offset:21504
    ds_read_b64_tr_b16 v[104:105], v2 offset:1536
    ds_read_b64_tr_b16 v[106:107], v2 offset:22016
    ds_read_b64_tr_b16 v[108:109], v2 offset:2048
    ds_read_b64_tr_b16 v[110:111], v2 offset:22528
    s_waitcnt lgkmcnt(14)
    v_mfma_f32_16x16x32_bf16 v[208:211], v[72:75], v[16:19], 0
    v_mfma_f32_16x16x32_bf16 v[212:215], v[76:79], v[16:19], 0
    v_mfma_f32_16x16x32_bf16 v[216:219], v[80:83], v[16:19], 0
    s_waitcnt lgkmcnt(12)
    v_mfma_f32_16x16x32_bf16 v[220:223], v[84:87], v[16:19], 0
    s_waitcnt lgkmcnt(10)
    v_mfma_f32_16x16x32_bf16 v[224:227], v[88:91], v[16:19], 0
    s_waitcnt lgkmcnt(8)
    v_mfma_f32_16x16x32_bf16 v[228:231], v[92:95], v[16:19], 0
    s_waitcnt lgkmcnt(6)
    v_mfma_f32_16x16x32_bf16 v[232:235], v[96:99], v[16:19], 0
    s_waitcnt lgkmcnt(4)
    v_mfma_f32_16x16x32_bf16 v[236:239], v[100:103], v[16:19], 0
    s_waitcnt lgkmcnt(2)
    v_mfma_f32_16x16x32_bf16 v[240:243], v[104:107], v[16:19], 0
    s_waitcnt lgkmcnt(0)
    v_mfma_f32_16x16x32_bf16 v[244:247], v[108:111], v[16:19], 0
    s_nop 7
    ds_read_b64_tr_b16 v[72:73], v1 offset:40960
    ds_read_b64_tr_b16 v[74:75], v1 offset:61440
    ds_read_b64_tr_b16 v[76:77], v1 offset:41472
    ds_read_b64_tr_b16 v[78:79], v1 offset:61952
    ds_read_b64_tr_b16 v[80:81], v1 offset:41984
    ds_read_b64_tr_b16 v[82:83], v1 offset:62464
    ds_read_b64_tr_b16 v[84:85], v1 offset:42496
    ds_read_b64_tr_b16 v[86:87], v1 offset:62976
    ds_read_b64_tr_b16 v[88:89], v1 offset:43008
    ds_read_b64_tr_b16 v[90:91], v1 offset:63488
    ds_read_b64_tr_b16 v[92:93], v2 offset:40960
    ds_read_b64_tr_b16 v[94:95], v2 offset:61440
    ds_read_b64_tr_b16 v[96:97], v2 offset:41472
    ds_read_b64_tr_b16 v[98:99], v2 offset:61952
    ds_read_b64_tr_b16 v[100:101], v2 offset:41984
    ds_read_b64_tr_b16 v[102:103], v2 offset:62464
    ds_read_b64_tr_b16 v[104:105], v2 offset:42496
    ds_read_b64_tr_b16 v[106:107], v2 offset:62976
    ds_read_b64_tr_b16 v[108:109], v2 offset:43008
    ds_read_b64_tr_b16 v[110:111], v2 offset:63488
    s_waitcnt lgkmcnt(14)
    v_mfma_f32_16x16x32_bf16 v[208:211], v[72:75], v[20:23], v[208:211]
    v_mfma_f32_16x16x32_bf16 v[212:215], v[76:79], v[20:23], v[212:215]
    v_mfma_f32_16x16x32_bf16 v[216:219], v[80:83], v[20:23], v[216:219]
    s_waitcnt lgkmcnt(12)
    v_mfma_f32_16x16x32_bf16 v[220:223], v[84:87], v[20:23], v[220:223]
    s_branch .Lps8061
.Lpd8061:
    s_branch hop2_ret
.Lps8061:
    s_waitcnt lgkmcnt(10)
    v_mfma_f32_16x16x32_bf16 v[224:227], v[88:91], v[20:23], v[224:227]
    s_waitcnt lgkmcnt(8)
    v_mfma_f32_16x16x32_bf16 v[228:231], v[92:95], v[20:23], v[228:231]
    s_waitcnt lgkmcnt(6)
    v_mfma_f32_16x16x32_bf16 v[232:235], v[96:99], v[20:23], v[232:235]
    s_waitcnt lgkmcnt(4)
    v_mfma_f32_16x16x32_bf16 v[236:239], v[100:103], v[20:23], v[236:239]
    s_waitcnt lgkmcnt(2)
    v_mfma_f32_16x16x32_bf16 v[240:243], v[104:107], v[20:23], v[240:243]
    s_waitcnt lgkmcnt(0)
    v_mfma_f32_16x16x32_bf16 v[244:247], v[108:111], v[20:23], v[244:247]
    s_nop 7
    v_add_f32 v190, v208, v212
    v_add_f32 v190, v190, v216
    v_add_f32 v190, v190, v220
    v_add_f32 v190, v190, v224
    v_add_f32 v190, v190, v228
    v_add_f32 v190, v190, v232
    v_add_f32 v190, v190, v236
    v_add_f32 v190, v190, v240
    v_cmp_u_f32 vcc, v190, v244
    s_add_u32 s49, s49, 1
    s_cmp_ge_u32 s49, 2000
    s_cbranch_scc1 g_done0
    s_nop 2
    s_cbranch_vccnz g_spin0
g_done0:
    v_cvt_pk_bf16_f32 v72, v208, v212
    v_cvt_pk_bf16_f32 v73, v216, v220
    v_cvt_pk_bf16_f32 v74, v224, 0
    v_cvt_pk_bf16_f32 v76, v209, v213
    v_cvt_pk_bf16_f32 v77, v217, v221
    v_cvt_pk_bf16_f32 v78, v225, 0
    v_cvt_pk_bf16_f32 v80, v210, v214
    v_cvt_pk_bf16_f32 v81, v218, v222
    v_cvt_pk_bf16_f32 v82, v226, 0
    v_cvt_pk_bf16_f32 v84, v211, v215
    v_cvt_pk_bf16_f32 v85, v219, v223
    v_cvt_pk_bf16_f32 v86, v227, 0
    s_mov_b32 m0, s98
    s_nop 1
    s_branch g_ok0
g_slow1:
    s_mov_b32 s49, 0
    s_mov_b32 s98, m0
g_spin1:
    s_mov_b32 m0, 0
g_copy1:
    v_add_u32 v190, m0, v252
    buffer_load_dwordx4 v190, s[4:7], 0 offen offset:0 sc1 lds
    buffer_load_dwordx4 v190, s[4:7], 0 offen offset:1024 sc1 lds
    buffer_load_dwordx4 v190, s[4:7], 0 offen offset:2048 sc1 lds
    buffer_load_dwordx4 v190, s[4:7], 0 offen offset:3072 sc1 lds
    s_add_u32 m0, m0, 4096
    s_cmp_lt_u32 m0, 81920
    s_cbranch_scc1 g_copy1
    s_waitcnt vmcnt(0)
    ds_read_b64_tr_b16 v[72:73], v1 offset:0
    ds_read_b64_tr_b16 v[74:75], v1 offset:20480
    ds_read_b64_tr_b16 v[76:77], v1 offset:512
    ds_read_b64_tr_b16 v[78:79], v1 offset:20992
    ds_read_b64_tr_b16 v[80:81], v1 offset:1024
    ds_read_b64_tr_b16 v[82:83], v1 offset:21504
    ds_read_b64_tr_b16 v[84:85], v1 offset:1536
    ds_read_b64_tr_b16 v[86:87], v1 offset:22016
    ds_read_b64_tr_b16 v[88:89], v1 offset:2048
    ds_read_b64_tr_b16 v[90:91], v1 offset:22528
    ds_read_b64_tr_b16 v[92:93], v2 offset:0
    ds_read_b64_tr_b16 v[94:95], v2 offset:20480
    ds_read_b64_tr_b16 v[96:97], v2 offset:512
    ds_read_b64_tr_b16 v[98:99], v2 offset:20992
    ds_read_b64_tr_b16 v[100:101], v2 offset:1024
    ds_read_b64_tr_b16 v[102:103], v2 offset:21504
    ds_read_b64_tr_b16 v[104:105], v2 offset:1536
    ds_read_b64_tr_b16 v[106:107], v2 offset:22016
    ds_read_b64_tr_b16 v[108:109], v2 offset:2048
    ds_read_b64_tr_b16 v[110:111], v2 offset:22528
    s_waitcnt lgkmcnt(14)
    v_mfma_f32_16x16x32_bf16 v[208:211], v[72:75], v[16:19], 0
    v_mfma_f32_16x16x32_bf16 v[212:215], v[76:79], v[16:19], 0
    v_mfma_f32_16x16x32_bf16 v[216:219], v[80:83], v[16:19], 0
    s_waitcnt lgkmcnt(12)
    v_mfma_f32_16x16x32_bf16 v[220:223], v[84:87], v[16:19], 0
    s_waitcnt lgkmcnt(10)
    v_mfma_f32_16x16x32_bf16 v[224:227], v[88:91], v[16:19], 0
    s_waitcnt lgkmcnt(8)
    v_mfma_f32_16x16x32_bf16 v[228:231], v[92:95], v[16:19], 0
    s_waitcnt lgkmcnt(6)
    v_mfma_f32_16x16x32_bf16 v[232:235], v[96:99], v[16:19], 0
    s_waitcnt lgkmcnt(4)
    v_mfma_f32_16x16x32_bf16 v[236:239], v[100:103], v[16:19], 0
    s_waitcnt lgkmcnt(2)
    v_mfma_f32_16x16x32_bf16 v[240:243], v[104:107], v[16:19], 0
    s_waitcnt lgkmcnt(0)
    v_mfma_f32_16x16x32_bf16 v[244:247], v[108:111], v[16:19], 0
    s_nop 7
    ds_read_b64_tr_b16 v[72:73], v1 offset:40960
    ds_read_b64_tr_b16 v[74:75], v1 offset:61440
    ds_read_b64_tr_b16 v[76:77], v1 offset:41472
    ds_read_b64_tr_b16 v[78:79], v1 offset:61952
    ds_read_b64_tr_b16 v[80:81], v1 offset:41984
    ds_read_b64_tr_b16 v[82:83], v1 offset:62464
    ds_read_b64_tr_b16 v[84:85], v1 offset:42496
    ds_read_b64_tr_b16 v[86:87], v1 offset:62976
    ds_read_b64_tr_b16 v[88:89], v1 offset:43008
    ds_read_b64_tr_b16 v[90:91], v1 offset:63488
    ds_read_b64_tr_b16 v[92:93], v2 offset:40960
    ds_read_b64_tr_b16 v[94:95], v2 offset:61440
    ds_read_b64_tr_b16 v[96:97], v2 offset:41472
    ds_read_b64_tr_b16 v[98:99], v2 offset:61952
    ds_read_b64_tr_b16 v[100:101], v2 offset:41984
    ds_read_b64_tr_b16 v[102:103], v2 offset:62464
    ds_read_b64_tr_b16 v[104:105], v2 offset:42496
    ds_read_b64_tr_b16 v[106:107], v2 offset:62976
    ds_read_b64_tr_b16 v[108:109], v2 offset:43008
    ds_read_b64_tr_b16 v[110:111], v2 offset:63488
    s_waitcnt lgkmcnt(14)
    v_mfma_f32_16x16x32_bf16 v[208:211], v[72:75], v[20:23], v[208:211]
    v_mfma_f32_16x16x32_bf16 v[212:215], v[76:79], v[20:23], v[212:215]
    v_mfma_f32_16x16x32_bf16 v[216:219], v[80:83], v[20:23], v[216:219]
    s_waitcnt lgkmcnt(12)
    v_mfma_f32_16x16x32_bf16 v[220:223], v[84:87], v[20:23], v[220:223]
    s_waitcnt lgkmcnt(10)
    v_mfma_f32_16x16x32_bf16 v[224:227], v[88:91], v[20:23], v[224:227]
    s_waitcnt lgkmcnt(8)
    v_mfma_f32_16x16x32_bf16 v[228:231], v[92:95], v[20:23], v[228:231]
    s_waitcnt lgkmcnt(6)
    v_mfma_f32_16x16x32_bf16 v[232:235], v[96:99], v[20:23], v[232:235]
    s_waitcnt lgkmcnt(4)
    v_mfma_f32_16x16x32_bf16 v[236:239], v[100:103], v[20:23], v[236:239]
    s_waitcnt lgkmcnt(2)
    v_mfma_f32_16x16x32_bf16 v[240:243], v[104:107], v[20:23], v[240:243]
    s_waitcnt lgkmcnt(0)
    v_mfma_f32_16x16x32_bf16 v[244:247], v[108:111], v[20:23], v[244:247]
    s_nop 7
    v_add_f32 v190, v208, v212
    v_add_f32 v190, v190, v216
    v_add_f32 v190, v190, v220
    v_add_f32 v190, v190, v224
    v_add_f32 v190, v190, v228
    v_add_f32 v190, v190, v232
    v_add_f32 v190, v190, v236
    v_add_f32 v190, v190, v240
    v_cmp_u_f32 vcc, v190, v244
    s_add_u32 s49, s49, 1
    s_cmp_ge_u32 s49, 2000
    s_cbranch_scc1 g_done1
    s_nop 2
    s_cbranch_vccnz g_spin1
g_done1:
    v_cvt_pk_bf16_f32 v72, v208, v212
    v_cvt_pk_bf16_f32 v73, v216, v220
    v_cvt_pk_bf16_f32 v74, v224, 0
    v_cvt_pk_bf16_f32 v76, v209, v213
    v_cvt_pk_bf16_f32 v77, v217, v221
    v_cvt_pk_bf16_f32 v78, v225, 0
    v_cvt_pk_bf16_f32 v80, v210, v214
    v_cvt_pk_bf16_f32 v81, v218, v222
    v_cvt_pk_bf16_f32 v82, v226, 0
    v_cvt_pk_bf16_f32 v84, v211, v215
    v_cvt_pk_bf16_f32 v85, v219, v223
    v_cvt_pk_bf16_f32 v86, v227, 0
    s_mov_b32 m0, s98
    s_nop 1
    s_branch g_ok1
zrel1:
    s_mov_b32 s49, 0
zrel_spin1:
    v_mov_b32 v88, 0
    buffer_atomic_add v88, v12, s[4:7], s25 offen offset:8 sc0 sc1
    s_add_u32 s49, s49, 1
    s_waitcnt vmcnt(0)
    v_readfirstlane_b32 s48, v88
    s_nop 1
    s_bitcmp1_b32 s48, 4
    s_cbranch_scc1 zrel_go1
    s_cmp_lt_u32 s49, 20000
    s_cbranch_scc1 zrel_spin1
zrel_go1:
    v_lshrrev_b32 v88, 4, v0
    v_and_b32 v89, 15, v0
    v_lshlrev_b32 v89, 4, v89
    v_lshl_add_u32 v88, v88, 9, v89
    v_add_u32 v88, s24, v88
    buffer_load_dwordx4 v[96:99], v88, s[4:7], 0 offen offset:0 sc1
    buffer_load_dwordx4 v[100:103], v88, s[4:7], 0 offen offset:256 sc1
    buffer_load_dwordx4 v[104:107], v88, s[4:7], 0 offen offset:2048 sc1
    buffer_load_dwordx4 v[108:111], v88, s[4:7], 0 offen offset:2304 sc1
    v_add_u32 v88, 4096, v88
    buffer_load_dwordx4 v[112:115], v88, s[4:7], 0 offen offset:0 sc1
    buffer_load_dwordx4 v[116:119], v88, s[4:7], 0 offen offset:256 sc1
    buffer_load_dwordx4 v[120:123], v88, s[4:7], 0 offen offset:2048 sc1
    buffer_load_dwordx4 v[124:127], v88, s[4:7], 0 offen offset:2304 sc1
    v_add_u32 v88, 4096, v88
    buffer_load_dwordx4 v[128:131], v88, s[4:7], 0 offen offset:0 sc1
    buffer_load_dwordx4 v[132:135], v88, s[4:7], 0 offen offset:256 sc1
    buffer_load_dwordx4 v[136:139], v88, s[4:7], 0 offen offset:2048 sc1
    buffer_load_dwordx4 v[140:143], v88, s[4:7], 0 offen offset:2304 sc1
    v_add_u32 v88, 4096, v88
    buffer_load_dwordx4 v[144:147], v88, s[4:7], 0 offen offset:0 sc1
    buffer_load_dwordx4 v[148:151], v88, s[4:7], 0 offen offset:256 sc1
    buffer_load_dwordx4 v[152:155], v88, s[4:7], 0 offen offset:2048 sc1
    buffer_load_dwordx4 v[156:159], v88, s[4:7], 0 offen offset:2304 sc1
    v_add_u32 v88, 4096, v88
    buffer_load_dwordx4 v[160:163], v88, s[4:7], 0 offen offset:0 sc1
    buffer_load_dwordx4 v[164:167], v88, s[4:7], 0 offen offset:256 sc1
    buffer_load_dwordx4 v[168:171], v88, s[4:7], 0 offen offset:2048 sc1
    buffer_load_dwordx4 v[172:175], v88, s[4:7], 0 offen offset:2304 sc1
    v_add_u32 v88, 4096, v88
    buffer_load_dwordx4 v[176:179], v88, s[4:7], 0 offen offset:0 sc1
    buffer_load_dwordx4 v[180:183], v88, s[4:7], 0 offen offset:256 sc1
    buffer_load_dwordx4 v[184:187], v88, s[4:7], 0 offen offset:2048 sc1
    buffer_load_dwordx4 v[188:191], v88, s[4:7], 0 offen offset:2304 sc1
    v_add_u32 v88, 4096, v88
    buffer_load_dwordx4 v[192:195], v88, s[4:7], 0 offen offset:0 sc1
    buffer_load_dwordx4 v[196:199], v88, s[4:7], 0 offen offset:256 sc1
    buffer_load_dwordx4 v[200:203], v88, s[4:7], 0 offen offset:2048 sc1
    buffer_load_dwordx4 v[204:207], v88, s[4:7], 0 offen offset:2304 sc1
    v_add_u32 v88, 4096, v88
    buffer_load_dwordx4 v[208:211], v88, s[4:7], 0 offen offset:0 sc1
    buffer_load_dwordx4 v[212:215], v88, s[4:7], 0 offen offset:256 sc1
    buffer_load_dwordx4 v[216:219], v88, s[4:7], 0 offen offset:2048 sc1
    buffer_load_dwordx4 v[220:223], v88, s[4:7], 0 offen offset:2304 sc1
    v_add_u32 v88, 4096, v88
    buffer_load_dwordx4 v[224:227], v88, s[4:7], 0 offen offset:0 sc1
    buffer_load_dwordx4 v[228:231], v88, s[4:7], 0 offen offset:256 sc1
    buffer_load_dwordx4 v[232:235], v88, s[4:7], 0 offen offset:2048 sc1
    buffer_load_dwordx4 v[236:239], v88, s[4:7], 0 offen offset:2304 sc1
    v_add_u32 v88, 4096, v88
    buffer_load_dwordx4 v[240:243], v88, s[4:7], 0 offen offset:0 sc1
    buffer_load_dwordx4 v[244:247], v88, s[4:7], 0 offen offset:256 sc1
    buffer_load_dwordx4 v[248:251], v88, s[4:7], 0 offen offset:2048 sc1
    buffer_load_dwordx4 v[252:255], v88, s[4:7], 0 offen offset:2304 sc1
    s_waitcnt vmcnt(0)
    s_setpc_b64 s[98:99]
zv1_1_slow:
    s_call_b64 s[98:99], zrel1
    s_branch zv1_1_ok
zv1_2_slow:
    s_call_b64 s[98:99], zrel1
    s_branch zv1_2_ok
zv1_3_slow:
    s_call_b64 s[98:99], zrel1
    s_branch zv1_3_ok
zv1_4_slow:
    s_call_b64 s[98:99], zrel1
    s_branch zv1_4_ok
zv1_5_slow:
    s_call_b64 s[98:99], zrel1
    s_branch zv1_5_ok
zv1_6_slow:
    s_call_b64 s[98:99], zrel1
    s_branch zv1_6_ok
zv1_7_slow:
    s_call_b64 s[98:99], zrel1
    s_branch zv1_7_ok
zv1_8_slow:
    s_call_b64 s[98:99], zrel1
    s_branch zv1_8_ok
zv1_9_slow:
    s_call_b64 s[98:99], zrel1
    s_branch zv1_9_ok
zv1_10_slow:
    s_call_b64 s[98:99], zrel1
    s_branch zv1_10_ok
zv1_11_slow:
    s_call_b64 s[98:99], zrel1
    s_branch zv1_11_ok
zv1_12_slow:
    s_call_b64 s[98:99], zrel1
    s_branch zv1_12_ok
zv1_13_slow:
    s_call_b64 s[98:99], zrel1
    s_branch zv1_13_ok
zv1_14_slow:
    s_call_b64 s[98:99], zrel1
    s_branch zv1_14_ok
zv1_15_slow:
    s_call_b64 s[98:99], zrel1
    s_branch zv1_15_ok
zv1_16_slow:
    s_call_b64 s[98:99], zrel1
    s_branch zv1_16_ok
rdy_slow:
    s_mov_b32 s49, 0
rdy_spin:
    v_mov_b32 v246, 0
    global_load_dword v247, v246, s[22:23] sc1
    s_add_u32 s49, s49, 1
    s_waitcnt vmcnt(0)
    v_readfirstlane_b32 s43, v247
    s_nop 1
    s_cmp_ge_u32 s43, 16
    s_cbranch_scc1 rdy_ok
    s_cmp_lt_u32 s49, 20000
    s_cbranch_scc1 rdy_spin
    s_branch rdy_ok
ffn_end:
    s_endpgm
.section .rodata,"a"
.p2align 6
.amdhsa_kernel interleave_layers__spectral_fnet__swiglu_ffn__prompt_kernel
  .amdhsa_next_free_vgpr 512
  .amdhsa_next_free_sgpr 100
  .amdhsa_accum_offset 256
  .amdhsa_group_segment_fixed_size 0
  .amdhsa_kernarg_size 96
  .amdhsa_user_sgpr_count 2
  .amdhsa_user_sgpr_kernarg_segment_ptr 1
  .amdhsa_system_sgpr_workgroup_id_x 1
  .amdhsa_float_denorm_mode_32 3
.end_amdhsa_kernel
```
